```python
import torch

def _softmax(x, axis=-1):
    return torch.softmax(x, dim=axis)
def _gelu(x):
    return torch.nn.functional.gelu(x, approximate="tanh")
def _silu(x):
    return torch.nn.functional.silu(x)
def _sigmoid(x):
    return torch.sigmoid(x)
def _layernorm(x, axis=-1, eps=1e-5):
    m = x.mean(dim=axis, keepdim=True)
    v = x.var(dim=axis, keepdim=True, unbiased=False)
    return (x - m) / torch.sqrt(v + eps)
def _scatter_add(tgt, idx, src, axis=0):
    return tgt.clone().index_add_(axis, idx, src)
def _segment_sum(src, seg, n):
    out = torch.zeros((n,) + src.shape[1:], dtype=src.dtype)
    return out.index_add_(0, seg, src)
def _pad(x, pw):
    flat = tuple(v for pair in reversed(pw) for v in pair)
    return torch.nn.functional.pad(x, flat)

kernel_name = 'standalone__mha_softmax__near_ridge'

def setup_inputs():

    _w = (lambda a: (lambda t: t.to(torch.bfloat16) if t.is_floating_point() else t)(torch.as_tensor(a)))
    B, H, Sq, Sk, D = 16, 32, 768, 512, 128
    return {
        "q": _w((lambda *s: torch.randn(*s, dtype=torch.bfloat16) * 0.8)(B, H, Sq, D)),
        "k": _w((lambda *s: torch.randn(*s, dtype=torch.bfloat16) * 0.8)(B, H, Sk, D)),
        "v": _w((lambda *s: torch.randn(*s, dtype=torch.bfloat16) * 0.05)(B, H, Sk, D)),
    }

def reference(q, k, v):
    scale = q.shape[-1] ** -0.5
    scores = torch.einsum("bhqd,bhkd->bhqk", q, k) * scale
    p = _softmax(scores, axis=-1)
    return torch.einsum("bhqk,bhkd->bhqd", p, v)
```

```asm
; @launch grid=(256,1,1) block=(256,1,1) lds=163840
.amdgcn_target "amdgcn-amd-amdhsa--gfx950"
.text
.globl standalone__mha_softmax__near_ridge_kernel
.p2align 8
.type standalone__mha_softmax__near_ridge_kernel,@function
standalone__mha_softmax__near_ridge_kernel:
s_cmp_ge_u32 s2, 256
s_cbranch_scc1 L_end
s_load_dwordx4 s[4:7], s[0:1], 0
s_load_dwordx4 s[8:11], s[0:1], 16
v_and_b32 v32, 63, v0
v_lshrrev_b32 v33, 6, v0
v_lshrrev_b32 v34, 4, v32
v_readfirstlane_b32 s30, v33
v_and_b32 v35, 15, v32
s_getpc_b64 s[48:49]
L_pc:
s_bfe_u32 s50, s2, 0x20003
s_mul_i32 s50, s50, 12288
v_mul_u32_u24 v40, 3072, v33
v_lshl_add_u32 v40, v32, 4, v40
v_add_u32 v40, s50, v40
v_add_u32 v41, 0, v40
v_min_u32 v41, (L_main_end-L_pc-16), v41
global_load_dwordx4 v[44:47], v41, s[48:49]
v_add_u32 v41, 1024, v40
v_min_u32 v41, (L_main_end-L_pc-16), v41
global_load_dwordx4 v[48:51], v41, s[48:49]
v_add_u32 v41, 2048, v40
v_min_u32 v41, (L_main_end-L_pc-16), v41
global_load_dwordx4 v[52:55], v41, s[48:49]
v_xor_b32 v36, v35, v34
v_lshlrev_b32 v36, 4, v36
v_lshl_add_u32 v6, v34, 8, v36
v_lshlrev_b32 v36, 2, v34
v_xor_b32 v36, v35, v36
v_lshlrev_b32 v36, 4, v36
v_lshl_add_u32 v7, v34, 8, v36
v_lshrrev_b32 v36, 2, v35
v_and_b32 v37, 3, v35
v_xor_b32 v38, v37, v34
v_lshlrev_b32 v38, 4, v38
v_lshl_add_u32 v38, v37, 8, v38
v_mul_u32_u24 v39, 1088, v36
v_add_u32 v1, v39, v38
v_lshl_add_u32 v38, v36, 10, v38
v_mul_u32_u24 v39, 20480, v33
v_add_u32 v38, v38, v39
v_add_u32 v8, 67840, v38
v_mul_u32_u24 v38, 1032, v34
v_lshl_add_u32 v38, v36, 8, v38
v_lshl_add_u32 v38, v37, 4, v38
v_add_u32 v38, 34816, v38
v_xor_b32 v39, 0, v36
v_lshl_add_u32 v2, v39, 6, v38
v_xor_b32 v39, 1, v36
v_lshl_add_u32 v3, v39, 6, v38
v_xor_b32 v39, 2, v36
v_lshl_add_u32 v4, v39, 6, v38
v_xor_b32 v39, 3, v36
v_lshl_add_u32 v5, v39, 6, v38
v_lshlrev_b32 v38, 4, v34
v_lshl_add_u32 v9, v35, 8, v38
v_mul_u32_u24 v39, 20480, v33
v_lshl_add_u32 v39, v32, 4, v39
v_add_u32 v0, 67840, v39
v_mov_b32 v38, 0x3f803f80
v_accvgpr_write_b32 a128, v38
v_accvgpr_write_b32 a129, v38
v_accvgpr_write_b32 a130, v38
v_accvgpr_write_b32 a131, v38
s_waitcnt lgkmcnt(0)
s_mov_b32 s12, s4
s_mov_b32 s13, s5
s_mov_b32 s14, 100663296
s_mov_b32 s15, 0x20000
s_mov_b32 s16, s6
s_mov_b32 s17, s7
s_mov_b32 s18, 67108864
s_mov_b32 s19, 0x20000
s_mov_b32 s20, s8
s_mov_b32 s21, s9
s_mov_b32 s22, 67108864
s_mov_b32 s23, 0x20000
s_mov_b32 s24, s10
s_mov_b32 s25, s11
s_mov_b32 s26, 100663296
s_mov_b32 s27, 0x20000
s_mov_b32 s57, 0x00000000
s_mov_b32 s31, 0x3e0293ee
s_mov_b32 s44, 0x5d800000
s_and_b32 s4, s2, 7
s_lshl_b32 s4, s4, 6
s_lshr_b32 s5, s2, 4
s_add_u32 s4, s4, s5
s_bfe_u32 s5, s2, 0x10003
s_lshl_b32 s6, s30, 11
s_lshl_b32 s52, s4, 17
s_add_u32 s32, s52, s6
s_add_u32 s33, s32, 2097152
s_mul_i32 s6, s4, 768
s_mul_i32 s7, s5, 384
s_add_u32 s6, s6, s7
s_mul_i32 s7, s30, 96
s_add_u32 s6, s6, s7
s_lshl_b32 s35, s6, 8
s_mov_b32 s45, 0x20000000
s_mov_b32 s53, s35
s_add_u32 s34, s35, 3145728
s_mul_i32 s37, s30, 2176
s_mul_i32 s38, s30, 2064
s_add_u32 s38, s38, 34816
s_mul_i32 s39, s30, 20480
s_add_u32 s39, s39, 67840
s_mov_b32 s42, 0
s_mov_b32 s43, 0
s_mov_b32 s47, 1
s_add_u32 m0, s37, 0
s_add_u32 s40, s32, 0
buffer_load_dwordx4 v6, s[16:19], s40 offen nt lds
s_add_u32 m0, s37, 64
s_nop 0
buffer_load_dwordx4 v6, s[16:19], s40 offen offset:1024 nt lds
s_add_u32 s41, s35, 0
s_add_u32 m0, s39, 0
s_nop 0
buffer_load_dwordx4 v6, s[12:15], s41 offen offset:0 nt lds
v_xor_b32 v13, 64, v6
buffer_load_dwordx4 v13, s[12:15], s41 offen offset:1024 nt lds
v_xor_b32 v12, 128, v6
buffer_load_dwordx4 v12, s[12:15], s41 offen offset:2048 nt lds
v_xor_b32 v13, 192, v6
buffer_load_dwordx4 v13, s[12:15], s41 offen offset:3072 nt lds
s_add_u32 m0, s37, 8704
s_add_u32 s40, s32, 8192
buffer_load_dwordx4 v6, s[16:19], s40 offen nt lds
s_add_u32 m0, s37, 8768
s_nop 0
buffer_load_dwordx4 v6, s[16:19], s40 offen offset:1024 nt lds
s_add_u32 s41, s35, 4096
s_add_u32 m0, s39, 4096
s_nop 0
buffer_load_dwordx4 v6, s[12:15], s41 offen offset:0 nt lds
v_xor_b32 v13, 64, v6
buffer_load_dwordx4 v13, s[12:15], s41 offen offset:1024 nt lds
v_xor_b32 v12, 128, v6
buffer_load_dwordx4 v12, s[12:15], s41 offen offset:2048 nt lds
v_xor_b32 v13, 192, v6
buffer_load_dwordx4 v13, s[12:15], s41 offen offset:3072 nt lds
s_add_u32 s41, s35, 8192
s_add_u32 m0, s39, 8192
s_nop 0
buffer_load_dwordx4 v6, s[12:15], s41 offen offset:0 nt lds
v_xor_b32 v13, 64, v6
buffer_load_dwordx4 v13, s[12:15], s41 offen offset:1024 nt lds
v_xor_b32 v12, 128, v6
buffer_load_dwordx4 v12, s[12:15], s41 offen offset:2048 nt lds
v_xor_b32 v13, 192, v6
buffer_load_dwordx4 v13, s[12:15], s41 offen offset:3072 nt lds
s_add_u32 s41, s35, 12288
s_add_u32 m0, s39, 12288
s_nop 0
buffer_load_dwordx4 v6, s[12:15], s41 offen offset:0 nt lds
v_xor_b32 v13, 64, v6
buffer_load_dwordx4 v13, s[12:15], s41 offen offset:1024 nt lds
v_xor_b32 v12, 128, v6
buffer_load_dwordx4 v12, s[12:15], s41 offen offset:2048 nt lds
v_xor_b32 v13, 192, v6
buffer_load_dwordx4 v13, s[12:15], s41 offen offset:3072 nt lds
s_add_u32 s41, s35, 16384
s_add_u32 m0, s39, 16384
s_nop 0
buffer_load_dwordx4 v6, s[12:15], s41 offen offset:0 nt lds
v_xor_b32 v13, 64, v6
buffer_load_dwordx4 v13, s[12:15], s41 offen offset:1024 nt lds
v_xor_b32 v12, 128, v6
buffer_load_dwordx4 v12, s[12:15], s41 offen offset:2048 nt lds
v_xor_b32 v13, 192, v6
buffer_load_dwordx4 v13, s[12:15], s41 offen offset:3072 nt lds
s_add_u32 s41, s35, 20480
buffer_load_dwordx4 a[112:115], v9, s[12:15], s41 offen offset:0 nt
buffer_load_dwordx4 a[116:119], v9, s[12:15], s41 offen offset:64 nt
buffer_load_dwordx4 a[120:123], v9, s[12:15], s41 offen offset:128 nt
buffer_load_dwordx4 a[124:127], v9, s[12:15], s41 offen offset:192 nt
s_waitcnt vmcnt(26)
s_barrier
ds_read_b128 a[0:3], v1 offset:0
ds_read_b128 a[4:7], v1 offset:64
ds_read_b128 a[8:11], v1 offset:128
ds_read_b128 a[12:15], v1 offset:192
v_mbcnt_lo_u32_b32 v28, -1, 0
v_mbcnt_hi_u32_b32 v28, -1, v28
v_bfe_u32 v28, v28, 2, 2
v_lshl_add_u32 v28, v28, 6, v8
v_xor_b32 v29, 64, v28
v_xor_b32 v30, 128, v28
v_xor_b32 v31, 192, v28
s_waitcnt vmcnt(22)
ds_read_b128 a[32:35], v28 offset:0
ds_read_b128 a[36:39], v29 offset:0
ds_read_b128 a[40:43], v30 offset:0
ds_read_b128 a[44:47], v31 offset:0
s_waitcnt vmcnt(16)
ds_read_b128 a[48:51], v28 offset:4096
ds_read_b128 a[52:55], v29 offset:4096
ds_read_b128 a[56:59], v30 offset:4096
ds_read_b128 a[60:63], v31 offset:4096
s_waitcnt lgkmcnt(4)
v_mfma_f32_16x16x32_bf16 v[32:35], a[0:3], a[32:35], 0
s_waitcnt vmcnt(12)
ds_read_b128 a[64:67], v28 offset:8192
ds_read_b128 a[68:71], v29 offset:8192
ds_read_b128 a[72:75], v30 offset:8192
ds_read_b128 a[76:79], v31 offset:8192
v_mfma_f32_16x16x32_bf16 v[32:35], a[4:7], a[36:39], v[32:35]
s_waitcnt vmcnt(8)
ds_read_b128 a[80:83], v28 offset:12288
ds_read_b128 a[84:87], v29 offset:12288
ds_read_b128 a[88:91], v30 offset:12288
ds_read_b128 a[92:95], v31 offset:12288
v_mfma_f32_16x16x32_bf16 v[32:35], a[8:11], a[40:43], v[32:35]
s_waitcnt vmcnt(4)
ds_read_b128 a[96:99], v28 offset:16384
ds_read_b128 a[100:103], v29 offset:16384
ds_read_b128 a[104:107], v30 offset:16384
ds_read_b128 a[108:111], v31 offset:16384
v_mfma_f32_16x16x32_bf16 v[32:35], a[12:15], a[44:47], v[32:35]
ds_read_b128 a[16:19], v1 offset:4352
ds_read_b128 a[20:23], v1 offset:4416
ds_read_b128 a[24:27], v1 offset:4480
ds_read_b128 a[28:31], v1 offset:4544
s_waitcnt lgkmcnt(15)
v_mfma_f32_16x16x32_bf16 v[36:39], a[0:3], a[48:51], 0
v_mfma_f32_16x16x32_bf16 v[36:39], a[4:7], a[52:55], v[36:39]
v_mfma_f32_16x16x32_bf16 v[36:39], a[8:11], a[56:59], v[36:39]
v_mfma_f32_16x16x32_bf16 v[36:39], a[12:15], a[60:63], v[36:39]
v_mfma_f32_16x16x32_bf16 v[40:43], a[0:3], a[64:67], 0
v_max3_f32 v12, v32, v33, v34
v_max_f32 v12, v12, v35
v_mov_b32 v13, v12
s_waitcnt lgkmcnt(12)
v_mfma_f32_16x16x32_bf16 v[40:43], a[4:7], a[68:71], v[40:43]
v_permlane32_swap_b32 v12, v13
v_max_f32 v12, v12, v13
v_mov_b32 v13, v12
v_mfma_f32_16x16x32_bf16 v[40:43], a[8:11], a[72:75], v[40:43]
s_nop 0
v_permlane16_swap_b32 v12, v13
v_max_f32 v12, v12, v13
v_sub_f32 v104, s57, v12
v_sub_f32 v105, s57, v12
v_sub_f32 v106, s57, v12
v_sub_f32 v107, s57, v12
v_add_f32 v32, v32, v104
v_mfma_f32_16x16x32_bf16 v[40:43], a[12:15], a[76:79], v[40:43]
v_add_f32 v33, v33, v104
v_add_f32 v34, v34, v104
v_add_f32 v35, v35, v104
v_mul_f32 v32, s31, v32
v_mul_f32 v33, s31, v33
v_mul_f32 v34, s31, v34
v_mul_f32 v35, s31, v35
s_waitcnt lgkmcnt(8)
v_mfma_f32_16x16x32_bf16 v[44:47], a[0:3], a[80:83], 0
v_max3_f32 v12, v36, v37, v38
v_max_f32 v12, v12, v39
v_mov_b32 v13, v12
v_exp_f32 v32, v32
s_nop 0
v_permlane32_swap_b32 v12, v13
v_max_f32 v12, v12, v13
v_mfma_f32_16x16x32_bf16 v[44:47], a[4:7], a[84:87], v[44:47]
v_mov_b32 v13, v12
v_exp_f32 v33, v33
s_nop 0
v_permlane16_swap_b32 v12, v13
v_max_f32 v12, v12, v13
v_sub_f32 v108, s57, v12
v_sub_f32 v109, s57, v12
v_mfma_f32_16x16x32_bf16 v[44:47], a[8:11], a[88:91], v[44:47]
v_sub_f32 v110, s57, v12
v_sub_f32 v111, s57, v12
v_exp_f32 v34, v34
v_exp_f32 v35, v35
v_cvt_pk_bf16_f32 v32, v32, v33
v_mfma_f32_16x16x32_bf16 v[44:47], a[12:15], a[92:95], v[44:47]
v_cvt_pk_bf16_f32 v33, v34, v35
v_add_f32 v36, v36, v108
v_add_f32 v37, v37, v108
v_add_f32 v38, v38, v108
v_add_f32 v39, v39, v108
v_mul_f32 v36, s31, v36
v_mul_f32 v37, s31, v37
s_waitcnt lgkmcnt(4)
v_mfma_f32_16x16x32_bf16 v[48:51], a[0:3], a[96:99], 0
v_max3_f32 v12, v40, v41, v42
v_max_f32 v12, v12, v43
v_mov_b32 v13, v12
v_mul_f32 v38, s31, v38
s_nop 0
v_permlane32_swap_b32 v12, v13
v_max_f32 v12, v12, v13
v_mov_b32 v13, v12
v_mfma_f32_16x16x32_bf16 v[48:51], a[4:7], a[100:103], v[48:51]
s_nop 0
v_permlane16_swap_b32 v12, v13
v_max_f32 v12, v12, v13
v_sub_f32 v112, s57, v12
v_sub_f32 v113, s57, v12
v_sub_f32 v114, s57, v12
v_sub_f32 v115, s57, v12
v_mul_f32 v39, s31, v39
v_mfma_f32_16x16x32_bf16 v[48:51], a[8:11], a[104:107], v[48:51]
v_exp_f32 v36, v36
v_exp_f32 v37, v37
v_exp_f32 v38, v38
v_cvt_pk_bf16_f32 v36, v36, v37
v_mfma_f32_16x16x32_bf16 v[48:51], a[12:15], a[108:111], v[48:51]
v_exp_f32 v39, v39
v_add_f32 v40, v40, v112
v_cvt_pk_bf16_f32 v37, v38, v39
v_add_f32 v41, v41, v112
v_add_f32 v42, v42, v112
v_add_f32 v43, v43, v112
s_waitcnt vmcnt(3)
v_mfma_f32_16x16x32_bf16 v[52:55], a[0:3], a[112:115], 0
v_max3_f32 v12, v44, v45, v46
v_max_f32 v12, v12, v47
v_mov_b32 v13, v12
v_mul_f32 v40, s31, v40
s_nop 0
v_permlane32_swap_b32 v12, v13
v_max_f32 v12, v12, v13
v_mov_b32 v13, v12
s_waitcnt vmcnt(2)
v_mfma_f32_16x16x32_bf16 v[52:55], a[4:7], a[116:119], v[52:55]
v_permlane16_swap_b32 v12, v13
v_max_f32 v12, v12, v13
v_sub_f32 v116, s57, v12
v_sub_f32 v117, s57, v12
v_sub_f32 v118, s57, v12
v_sub_f32 v119, s57, v12
v_mul_f32 v41, s31, v41
s_waitcnt vmcnt(1)
v_mfma_f32_16x16x32_bf16 v[52:55], a[8:11], a[120:123], v[52:55]
v_mul_f32 v42, s31, v42
v_mul_f32 v43, s31, v43
v_exp_f32 v40, v40
v_exp_f32 v41, v41
s_nop 0
v_cvt_pk_bf16_f32 v40, v40, v41
s_waitcnt vmcnt(0)
v_mfma_f32_16x16x32_bf16 v[52:55], a[12:15], a[124:127], v[52:55]
v_exp_f32 v42, v42
v_exp_f32 v43, v43
v_add_f32 v44, v44, v116
v_cvt_pk_bf16_f32 v41, v42, v43
v_add_f32 v45, v45, v116
s_waitcnt lgkmcnt(0)
v_mfma_f32_16x16x32_bf16 v[80:83], a[16:19], a[32:35], v[104:107]
s_add_u32 m0, s38, 0
s_add_u32 s40, s32, 0
buffer_load_dwordx4 v7, s[20:23], s40 offen nt lds
s_add_u32 m0, s38, 8
s_nop 0
buffer_load_dwordx4 v7, s[20:23], s40 offen offset:1024 nt lds
v_mfma_f32_16x16x32_bf16 v[80:83], a[20:23], a[36:39], v[80:83]
v_max3_f32 v12, v48, v49, v50
v_max_f32 v12, v12, v51
v_mov_b32 v13, v12
v_add_f32 v46, v46, v116
s_nop 0
v_permlane32_swap_b32 v12, v13
v_max_f32 v12, v12, v13
v_mov_b32 v13, v12
v_mfma_f32_16x16x32_bf16 v[80:83], a[24:27], a[40:43], v[80:83]
s_nop 0
v_permlane16_swap_b32 v12, v13
v_max_f32 v12, v12, v13
v_sub_f32 v120, s57, v12
v_sub_f32 v121, s57, v12
v_sub_f32 v122, s57, v12
v_sub_f32 v123, s57, v12
v_add_f32 v47, v47, v116
v_mfma_f32_16x16x32_bf16 v[80:83], a[28:31], a[44:47], v[80:83]
v_mul_f32 v44, s31, v44
v_mul_f32 v45, s31, v45
v_mul_f32 v46, s31, v46
v_mul_f32 v47, s31, v47
v_exp_f32 v44, v44
v_add_f32 v48, v48, v120
v_mfma_f32_16x16x32_bf16 v[84:87], a[16:19], a[48:51], v[108:111]
s_add_u32 m0, s37, 17408
s_add_u32 s40, s32, 16384
buffer_load_dwordx4 v6, s[16:19], s40 offen nt lds
s_add_u32 m0, s37, 17472
s_nop 0
buffer_load_dwordx4 v6, s[16:19], s40 offen offset:1024 nt lds
v_mfma_f32_16x16x32_bf16 v[84:87], a[20:23], a[52:55], v[84:87]
v_max3_f32 v12, v52, v53, v54
v_max_f32 v12, v12, v55
v_mov_b32 v13, v12
v_exp_f32 v45, v45
s_nop 0
v_permlane32_swap_b32 v12, v13
v_max_f32 v12, v12, v13
v_mfma_f32_16x16x32_bf16 v[84:87], a[24:27], a[56:59], v[84:87]
v_mov_b32 v13, v12
v_exp_f32 v46, v46
s_nop 0
v_permlane16_swap_b32 v12, v13
v_max_f32 v12, v12, v13
v_sub_f32 v124, s57, v12
v_sub_f32 v125, s57, v12
v_mfma_f32_16x16x32_bf16 v[84:87], a[28:31], a[60:63], v[84:87]
v_sub_f32 v126, s57, v12
v_sub_f32 v127, s57, v12
v_exp_f32 v47, v47
v_cvt_pk_bf16_f32 v44, v44, v45
v_cvt_pk_bf16_f32 v45, v46, v47
v_add_f32 v49, v49, v120
v_mfma_f32_16x16x32_bf16 v[88:91], a[16:19], a[64:67], v[112:115]
s_add_u32 m0, s38, 8256
s_add_u32 s40, s32, 8192
buffer_load_dwordx4 v7, s[20:23], s40 offen nt lds
s_add_u32 m0, s38, 8264
s_nop 0
buffer_load_dwordx4 v7, s[20:23], s40 offen offset:1024 nt lds
v_mfma_f32_16x16x32_bf16 v[88:91], a[20:23], a[68:71], v[88:91]
v_add_f32 v50, v50, v120
v_add_f32 v51, v51, v120
v_mul_f32 v48, s31, v48
v_mul_f32 v49, s31, v49
v_mul_f32 v50, s31, v50
v_mul_f32 v51, s31, v51
v_add_f32 v52, v52, v124
v_mfma_f32_16x16x32_bf16 v[88:91], a[24:27], a[72:75], v[88:91]
v_exp_f32 v48, v48
v_exp_f32 v49, v49
v_exp_f32 v50, v50
v_cvt_pk_bf16_f32 v48, v48, v49
v_mfma_f32_16x16x32_bf16 v[88:91], a[28:31], a[76:79], v[88:91]
v_exp_f32 v51, v51
v_add_f32 v53, v53, v124
v_cvt_pk_bf16_f32 v49, v50, v51
v_add_f32 v54, v54, v124
v_add_f32 v55, v55, v124
v_mul_f32 v52, s31, v52
v_mfma_f32_16x16x32_bf16 v[92:95], a[16:19], a[80:83], v[116:119]
s_add_u32 m0, s37, 26112
s_add_u32 s40, s32, 24576
buffer_load_dwordx4 v6, s[16:19], s40 offen nt lds
s_add_u32 m0, s37, 26176
s_nop 0
buffer_load_dwordx4 v6, s[16:19], s40 offen offset:1024 nt lds
v_mfma_f32_16x16x32_bf16 v[92:95], a[20:23], a[84:87], v[92:95]
v_mul_f32 v53, s31, v53
v_mul_f32 v54, s31, v54
v_mul_f32 v55, s31, v55
v_exp_f32 v52, v52
v_exp_f32 v53, v53
s_nop 0
v_cvt_pk_bf16_f32 v52, v52, v53
v_mfma_f32_16x16x32_bf16 v[92:95], a[24:27], a[88:91], v[92:95]
v_exp_f32 v54, v54
v_exp_f32 v55, v55
v_mul_f32 v80, s31, v80
v_cvt_pk_bf16_f32 v53, v54, v55
v_mul_f32 v81, s31, v81
v_mfma_f32_16x16x32_bf16 v[92:95], a[28:31], a[92:95], v[92:95]
v_mul_f32 v82, s31, v82
v_mul_f32 v83, s31, v83
v_exp_f32 v80, v80
v_exp_f32 v81, v81
v_exp_f32 v82, v82
v_mfma_f32_16x16x32_bf16 v[96:99], a[16:19], a[96:99], v[120:123]
s_add_u32 m0, s38, 16512
s_add_u32 s40, s32, 16384
buffer_load_dwordx4 v7, s[20:23], s40 offen nt lds
s_add_u32 m0, s38, 16520
s_nop 0
buffer_load_dwordx4 v7, s[20:23], s40 offen offset:1024 nt lds
v_mfma_f32_16x16x32_bf16 v[96:99], a[20:23], a[100:103], v[96:99]
v_exp_f32 v83, v83
v_cvt_pk_bf16_f32 v34, v80, v81
v_cvt_pk_bf16_f32 v35, v82, v83
v_mul_f32 v84, s31, v84
v_mul_f32 v85, s31, v85
v_mul_f32 v86, s31, v86
v_mfma_f32_16x16x32_bf16 v[96:99], a[24:27], a[104:107], v[96:99]
v_mul_f32 v87, s31, v87
v_exp_f32 v84, v84
v_exp_f32 v85, v85
v_exp_f32 v86, v86
v_cvt_pk_bf16_f32 v38, v84, v85
v_mfma_f32_16x16x32_bf16 v[96:99], a[28:31], a[108:111], v[96:99]
v_exp_f32 v87, v87
v_mul_f32 v88, s31, v88
v_cvt_pk_bf16_f32 v39, v86, v87
v_mul_f32 v89, s31, v89
v_mul_f32 v90, s31, v90
v_mul_f32 v91, s31, v91
v_mfma_f32_16x16x32_bf16 v[100:103], a[16:19], a[112:115], v[124:127]
v_exp_f32 v88, v88
v_exp_f32 v89, v89
v_exp_f32 v90, v90
v_exp_f32 v91, v91
v_mfma_f32_16x16x32_bf16 v[100:103], a[20:23], a[116:119], v[100:103]
v_cvt_pk_bf16_f32 v42, v88, v89
v_cvt_pk_bf16_f32 v43, v90, v91
v_mul_f32 v92, s31, v92
v_mul_f32 v93, s31, v93
v_mul_f32 v94, s31, v94
v_mul_f32 v95, s31, v95
v_mfma_f32_16x16x32_bf16 v[100:103], a[24:27], a[120:123], v[100:103]
v_exp_f32 v92, v92
v_exp_f32 v93, v93
v_exp_f32 v94, v94
v_exp_f32 v95, v95
v_mfma_f32_16x16x32_bf16 v[100:103], a[28:31], a[124:127], v[100:103]
v_cvt_pk_bf16_f32 v46, v92, v93
v_cvt_pk_bf16_f32 v47, v94, v95
s_barrier
ds_read_b128 a[0:3], v1 offset:8704
ds_read_b128 a[4:7], v1 offset:8768
ds_read_b128 a[8:11], v1 offset:8832
ds_read_b128 a[12:15], v1 offset:8896
s_waitcnt lgkmcnt(0)
ds_read_b128 a[16:19], v1 offset:13056
ds_read_b128 a[20:23], v1 offset:13120
v_mfma_f32_16x16x32_bf16 v[56:59], a[0:3], a[32:35], v[104:107]
v_mul_f32 v96, s31, v96
v_mul_f32 v97, s31, v97
v_mfma_f32_16x16x32_bf16 v[56:59], a[4:7], a[36:39], v[56:59]
v_mul_f32 v98, s31, v98
v_mul_f32 v99, s31, v99
v_mfma_f32_16x16x32_bf16 v[56:59], a[8:11], a[40:43], v[56:59]
ds_read_b128 a[24:27], v1 offset:13184
ds_read_b128 a[28:31], v1 offset:13248
v_mfma_f32_16x16x32_bf16 v[56:59], a[12:15], a[44:47], v[56:59]
v_exp_f32 v96, v96
v_mfma_f32_16x16x32_bf16 v[60:63], a[0:3], a[48:51], v[108:111]
v_exp_f32 v97, v97
v_mfma_f32_16x16x32_bf16 v[60:63], a[4:7], a[52:55], v[60:63]
v_exp_f32 v98, v98
v_mfma_f32_16x16x32_bf16 v[60:63], a[8:11], a[56:59], v[60:63]
v_exp_f32 v99, v99
v_mfma_f32_16x16x32_bf16 v[60:63], a[12:15], a[60:63], v[60:63]
v_cvt_pk_bf16_f32 v50, v96, v97
v_cvt_pk_bf16_f32 v51, v98, v99
v_mfma_f32_16x16x32_bf16 v[64:67], a[0:3], a[64:67], v[112:115]
v_mul_f32 v100, s31, v100
v_mul_f32 v101, s31, v101
v_mfma_f32_16x16x32_bf16 v[64:67], a[4:7], a[68:71], v[64:67]
v_mul_f32 v102, s31, v102
v_mul_f32 v103, s31, v103
v_mfma_f32_16x16x32_bf16 v[64:67], a[8:11], a[72:75], v[64:67]
v_exp_f32 v100, v100
v_mfma_f32_16x16x32_bf16 v[64:67], a[12:15], a[76:79], v[64:67]
v_exp_f32 v101, v101
s_waitcnt vmcnt(6)
s_barrier
v_mfma_f32_16x16x32_bf16 v[68:71], a[0:3], a[80:83], v[116:119]
v_exp_f32 v102, v102
v_mfma_f32_16x16x32_bf16 v[68:71], a[4:7], a[84:87], v[68:71]
s_add_u32 m0, s37, 0
s_add_u32 s40, s32, 32768
buffer_load_dwordx4 v6, s[16:19], s40 offen nt lds
v_mfma_f32_16x16x32_bf16 v[68:71], a[8:11], a[88:91], v[68:71]
v_exp_f32 v103, v103
v_mfma_f32_16x16x32_bf16 v[68:71], a[12:15], a[92:95], v[68:71]
v_cvt_pk_bf16_f32 v54, v100, v101
v_cvt_pk_bf16_f32 v55, v102, v103
v_mfma_f32_16x16x32_bf16 v[72:75], a[0:3], a[96:99], v[120:123]
s_add_u32 m0, s37, 64
s_nop 0
buffer_load_dwordx4 v6, s[16:19], s40 offen offset:1024 nt lds
v_mfma_f32_16x16x32_bf16 v[72:75], a[4:7], a[100:103], v[72:75]
v_mul_f32 v56, s31, v56
v_mul_f32 v57, s31, v57
v_mfma_f32_16x16x32_bf16 v[72:75], a[8:11], a[104:107], v[72:75]
v_mul_f32 v58, s31, v58
v_mul_f32 v59, s31, v59
v_mfma_f32_16x16x32_bf16 v[72:75], a[12:15], a[108:111], v[72:75]
v_exp_f32 v56, v56
v_mfma_f32_16x16x32_bf16 v[76:79], a[0:3], a[112:115], v[124:127]
v_exp_f32 v57, v57
v_mfma_f32_16x16x32_bf16 v[76:79], a[4:7], a[116:119], v[76:79]
v_exp_f32 v58, v58
v_mfma_f32_16x16x32_bf16 v[76:79], a[8:11], a[120:123], v[76:79]
v_exp_f32 v59, v59
v_mfma_f32_16x16x32_bf16 v[76:79], a[12:15], a[124:127], v[76:79]
s_waitcnt lgkmcnt(0)
ds_read_b64_tr_b16 a[0:1], v2 offset:0
ds_read_b64_tr_b16 a[2:3], v2 offset:4128
v_mfma_f32_16x16x32_bf16 v[80:83], a[16:19], a[32:35], v[104:107]
v_cvt_pk_bf16_f32 v56, v56, v57
v_cvt_pk_bf16_f32 v57, v58, v59
v_mfma_f32_16x16x32_bf16 v[80:83], a[20:23], a[36:39], v[80:83]
v_mul_f32 v60, s31, v60
v_mul_f32 v61, s31, v61
v_mfma_f32_16x16x32_bf16 v[80:83], a[24:27], a[40:43], v[80:83]
ds_read_b64_tr_b16 a[4:5], v2 offset:8
ds_read_b64_tr_b16 a[6:7], v2 offset:4136
v_mfma_f32_16x16x32_bf16 v[80:83], a[28:31], a[44:47], v[80:83]
v_mul_f32 v62, s31, v62
v_mul_f32 v63, s31, v63
v_mfma_f32_16x16x32_bf16 v[84:87], a[16:19], a[48:51], v[108:111]
v_exp_f32 v60, v60
v_mfma_f32_16x16x32_bf16 v[84:87], a[20:23], a[52:55], v[84:87]
ds_read_b64_tr_b16 a[8:9], v3 offset:0
ds_read_b64_tr_b16 a[10:11], v3 offset:4128
v_mfma_f32_16x16x32_bf16 v[84:87], a[24:27], a[56:59], v[84:87]
v_exp_f32 v61, v61
v_mfma_f32_16x16x32_bf16 v[84:87], a[28:31], a[60:63], v[84:87]
v_exp_f32 v62, v62
v_mfma_f32_16x16x32_bf16 v[88:91], a[16:19], a[64:67], v[112:115]
ds_read_b64_tr_b16 a[12:13], v3 offset:8
ds_read_b64_tr_b16 a[14:15], v3 offset:4136
v_mfma_f32_16x16x32_bf16 v[88:91], a[20:23], a[68:71], v[88:91]
v_exp_f32 v63, v63
v_mfma_f32_16x16x32_bf16 v[88:91], a[24:27], a[72:75], v[88:91]
v_cvt_pk_bf16_f32 v60, v60, v61
v_cvt_pk_bf16_f32 v61, v62, v63
v_mfma_f32_16x16x32_bf16 v[88:91], a[28:31], a[76:79], v[88:91]
s_add_u32 m0, s38, 24768
s_add_u32 s40, s32, 24576
buffer_load_dwordx4 v7, s[20:23], s40 offen nt lds
v_mfma_f32_16x16x32_bf16 v[92:95], a[16:19], a[80:83], v[116:119]
v_mul_f32 v64, s31, v64
v_mul_f32 v65, s31, v65
v_mfma_f32_16x16x32_bf16 v[92:95], a[20:23], a[84:87], v[92:95]
v_mul_f32 v66, s31, v66
v_mul_f32 v67, s31, v67
v_mfma_f32_16x16x32_bf16 v[92:95], a[24:27], a[88:91], v[92:95]
s_add_u32 m0, s38, 24776
s_nop 0
buffer_load_dwordx4 v7, s[20:23], s40 offen offset:1024 nt lds
v_mfma_f32_16x16x32_bf16 v[92:95], a[28:31], a[92:95], v[92:95]
v_exp_f32 v64, v64
v_mfma_f32_16x16x32_bf16 v[96:99], a[16:19], a[96:99], v[120:123]
v_exp_f32 v65, v65
v_mfma_f32_16x16x32_bf16 v[96:99], a[20:23], a[100:103], v[96:99]
v_exp_f32 v66, v66
v_mfma_f32_16x16x32_bf16 v[96:99], a[24:27], a[104:107], v[96:99]
v_exp_f32 v67, v67
v_mfma_f32_16x16x32_bf16 v[96:99], a[28:31], a[108:111], v[96:99]
v_cvt_pk_bf16_f32 v64, v64, v65
v_cvt_pk_bf16_f32 v65, v66, v67
v_mfma_f32_16x16x32_bf16 v[100:103], a[16:19], a[112:115], v[124:127]
v_mul_f32 v68, s31, v68
v_mul_f32 v69, s31, v69
v_mfma_f32_16x16x32_bf16 v[100:103], a[20:23], a[116:119], v[100:103]
v_mul_f32 v70, s31, v70
v_mul_f32 v71, s31, v71
v_mfma_f32_16x16x32_bf16 v[100:103], a[24:27], a[120:123], v[100:103]
v_exp_f32 v68, v68
v_mfma_f32_16x16x32_bf16 v[100:103], a[28:31], a[124:127], v[100:103]
s_waitcnt lgkmcnt(0)
ds_read_b64_tr_b16 a[16:17], v4 offset:0
ds_read_b64_tr_b16 a[18:19], v4 offset:4128
v_mfma_f32_16x16x32_bf16 a[132:135], a[128:131], v[32:35], 0
v_exp_f32 v69, v69
v_mfma_f32_16x16x32_bf16 a[136:139], a[128:131], v[36:39], 0
v_exp_f32 v70, v70
v_mfma_f32_16x16x32_bf16 a[140:143], a[128:131], v[40:43], 0
ds_read_b64_tr_b16 a[20:21], v4 offset:8
ds_read_b64_tr_b16 a[22:23], v4 offset:4136
v_mfma_f32_16x16x32_bf16 a[144:147], a[128:131], v[44:47], 0
v_exp_f32 v71, v71
v_mfma_f32_16x16x32_bf16 a[148:151], a[128:131], v[48:51], 0
v_cvt_pk_bf16_f32 v68, v68, v69
v_cvt_pk_bf16_f32 v69, v70, v71
v_mfma_f32_16x16x32_bf16 a[152:155], a[128:131], v[52:55], 0
v_mul_f32 v72, s31, v72
v_mul_f32 v73, s31, v73
v_mfma_f32_16x16x32_bf16 v[128:131], a[0:3], v[32:35], 0
v_mul_f32 v74, s31, v74
v_mul_f32 v75, s31, v75
v_mfma_f32_16x16x32_bf16 v[160:163], a[0:3], v[36:39], 0
ds_read_b64_tr_b16 a[24:25], v5 offset:0
ds_read_b64_tr_b16 a[26:27], v5 offset:4128
v_mfma_f32_16x16x32_bf16 v[192:195], a[0:3], v[40:43], 0
v_exp_f32 v72, v72
v_mfma_f32_16x16x32_bf16 v[224:227], a[0:3], v[44:47], 0
v_exp_f32 v73, v73
v_mfma_f32_16x16x32_bf16 a[156:159], a[0:3], v[48:51], 0
ds_read_b64_tr_b16 a[28:29], v5 offset:8
ds_read_b64_tr_b16 a[30:31], v5 offset:4136
v_mfma_f32_16x16x32_bf16 a[188:191], a[0:3], v[52:55], 0
v_exp_f32 v74, v74
v_mfma_f32_16x16x32_bf16 v[132:135], a[4:7], v[32:35], 0
v_exp_f32 v75, v75
v_mfma_f32_16x16x32_bf16 v[164:167], a[4:7], v[36:39], 0
v_cvt_pk_bf16_f32 v72, v72, v73
v_cvt_pk_bf16_f32 v73, v74, v75
v_mfma_f32_16x16x32_bf16 v[196:199], a[4:7], v[40:43], 0
v_mul_f32 v76, s31, v76
v_mul_f32 v77, s31, v77
v_mfma_f32_16x16x32_bf16 v[228:231], a[4:7], v[44:47], 0
v_mul_f32 v78, s31, v78
v_mul_f32 v79, s31, v79
v_mfma_f32_16x16x32_bf16 a[160:163], a[4:7], v[48:51], 0
v_exp_f32 v76, v76
v_mfma_f32_16x16x32_bf16 a[192:195], a[4:7], v[52:55], 0
v_exp_f32 v77, v77
v_mfma_f32_16x16x32_bf16 v[136:139], a[8:11], v[32:35], 0
v_exp_f32 v78, v78
v_mfma_f32_16x16x32_bf16 v[168:171], a[8:11], v[36:39], 0
v_exp_f32 v79, v79
v_mfma_f32_16x16x32_bf16 v[200:203], a[8:11], v[40:43], 0
v_cvt_pk_bf16_f32 v76, v76, v77
v_cvt_pk_bf16_f32 v77, v78, v79
v_mfma_f32_16x16x32_bf16 v[232:235], a[8:11], v[44:47], 0
v_mul_f32 v80, s31, v80
v_mul_f32 v81, s31, v81
v_mfma_f32_16x16x32_bf16 a[164:167], a[8:11], v[48:51], 0
v_mul_f32 v82, s31, v82
v_mul_f32 v83, s31, v83
v_mfma_f32_16x16x32_bf16 a[196:199], a[8:11], v[52:55], 0
v_exp_f32 v80, v80
v_mfma_f32_16x16x32_bf16 v[140:143], a[12:15], v[32:35], 0
v_exp_f32 v81, v81
v_mfma_f32_16x16x32_bf16 v[172:175], a[12:15], v[36:39], 0
v_exp_f32 v82, v82
v_mfma_f32_16x16x32_bf16 v[204:207], a[12:15], v[40:43], 0
v_exp_f32 v83, v83
v_mfma_f32_16x16x32_bf16 v[236:239], a[12:15], v[44:47], 0
v_cvt_pk_bf16_f32 v58, v80, v81
v_cvt_pk_bf16_f32 v59, v82, v83
v_mfma_f32_16x16x32_bf16 a[168:171], a[12:15], v[48:51], 0
v_mul_f32 v84, s31, v84
v_mul_f32 v85, s31, v85
v_mfma_f32_16x16x32_bf16 a[200:203], a[12:15], v[52:55], 0
s_waitcnt lgkmcnt(0)
ds_read_b128 a[0:3], v1 offset:17408
ds_read_b128 a[4:7], v1 offset:17472
v_mfma_f32_16x16x32_bf16 v[144:147], a[16:19], v[32:35], 0
v_mul_f32 v86, s31, v86
v_mul_f32 v87, s31, v87
v_mfma_f32_16x16x32_bf16 v[176:179], a[16:19], v[36:39], 0
v_exp_f32 v84, v84
v_mfma_f32_16x16x32_bf16 v[208:211], a[16:19], v[40:43], 0
ds_read_b128 a[8:11], v1 offset:17536
ds_read_b128 a[12:15], v1 offset:17600
v_mfma_f32_16x16x32_bf16 v[240:243], a[16:19], v[44:47], 0
v_exp_f32 v85, v85
v_mfma_f32_16x16x32_bf16 a[172:175], a[16:19], v[48:51], 0
v_exp_f32 v86, v86
v_mfma_f32_16x16x32_bf16 a[204:207], a[16:19], v[52:55], 0
v_exp_f32 v87, v87
v_mfma_f32_16x16x32_bf16 v[148:151], a[20:23], v[32:35], 0
v_cvt_pk_bf16_f32 v62, v84, v85
v_cvt_pk_bf16_f32 v63, v86, v87
v_mfma_f32_16x16x32_bf16 v[180:183], a[20:23], v[36:39], 0
v_mul_f32 v88, s31, v88
v_mul_f32 v89, s31, v89
v_mfma_f32_16x16x32_bf16 v[212:215], a[20:23], v[40:43], 0
v_mul_f32 v90, s31, v90
v_mul_f32 v91, s31, v91
v_mfma_f32_16x16x32_bf16 v[244:247], a[20:23], v[44:47], 0
v_exp_f32 v88, v88
v_mfma_f32_16x16x32_bf16 a[176:179], a[20:23], v[48:51], 0
v_exp_f32 v89, v89
v_mfma_f32_16x16x32_bf16 a[208:211], a[20:23], v[52:55], 0
v_exp_f32 v90, v90
v_mfma_f32_16x16x32_bf16 v[152:155], a[24:27], v[32:35], 0
v_exp_f32 v91, v91
v_mfma_f32_16x16x32_bf16 v[184:187], a[24:27], v[36:39], 0
v_cvt_pk_bf16_f32 v66, v88, v89
v_cvt_pk_bf16_f32 v67, v90, v91
v_mfma_f32_16x16x32_bf16 v[216:219], a[24:27], v[40:43], 0
v_mul_f32 v92, s31, v92
v_mul_f32 v93, s31, v93
v_mfma_f32_16x16x32_bf16 v[248:251], a[24:27], v[44:47], 0
v_mul_f32 v94, s31, v94
v_mul_f32 v95, s31, v95
v_mfma_f32_16x16x32_bf16 a[180:183], a[24:27], v[48:51], 0
v_exp_f32 v92, v92
v_mfma_f32_16x16x32_bf16 a[212:215], a[24:27], v[52:55], 0
v_exp_f32 v93, v93
v_mfma_f32_16x16x32_bf16 v[156:159], a[28:31], v[32:35], 0
v_exp_f32 v94, v94
v_mfma_f32_16x16x32_bf16 v[188:191], a[28:31], v[36:39], 0
v_exp_f32 v95, v95
v_mfma_f32_16x16x32_bf16 v[220:223], a[28:31], v[40:43], 0
v_cvt_pk_bf16_f32 v70, v92, v93
v_cvt_pk_bf16_f32 v71, v94, v95
v_mfma_f32_16x16x32_bf16 v[252:255], a[28:31], v[44:47], 0
v_mfma_f32_16x16x32_bf16 a[184:187], a[28:31], v[48:51], 0
v_mfma_f32_16x16x32_bf16 a[216:219], a[28:31], v[52:55], 0
s_branch L_it1
.p2align 6
L_it0:
s_waitcnt lgkmcnt(3)
ds_read_b128 a[16:19], v1 offset:13056
ds_read_b128 a[20:23], v1 offset:13120
v_mfma_f32_16x16x32_bf16 v[56:59], a[0:3], a[32:35], v[104:107]
v_mul_f32 v96, s31, v96
v_mul_f32 v97, s31, v97
v_mul_f32 v98, s31, v98
v_mul_f32 v99, s31, v99
v_exp_f32 v96, v96
v_mul_f32 v100, s31, v100
v_mfma_f32_16x16x32_bf16 v[56:59], a[4:7], a[36:39], v[56:59]
v_exp_f32 v97, v97
v_exp_f32 v98, v98
v_exp_f32 v99, v99
v_cvt_pk_bf16_f32 v50, v96, v97
v_mfma_f32_16x16x32_bf16 v[56:59], a[8:11], a[40:43], v[56:59]
ds_read_b128 a[24:27], v1 offset:13184
ds_read_b128 a[28:31], v1 offset:13248
v_mfma_f32_16x16x32_bf16 v[56:59], a[12:15], a[44:47], v[56:59]
v_cvt_pk_bf16_f32 v51, v98, v99
v_mul_f32 v101, s31, v101
v_mul_f32 v102, s31, v102
v_mul_f32 v103, s31, v103
v_exp_f32 v100, v100
v_accvgpr_read_b32 v10, a132
v_mfma_f32_16x16x32_bf16 v[60:63], a[0:3], a[48:51], v[108:111]
v_exp_f32 v101, v101
v_exp_f32 v102, v102
v_exp_f32 v103, v103
v_cvt_pk_bf16_f32 v54, v100, v101
v_mfma_f32_16x16x32_bf16 v[60:63], a[4:7], a[52:55], v[60:63]
v_cvt_pk_bf16_f32 v55, v102, v103
v_accvgpr_read_b32 v11, a136
v_rcp_f32 v10, v10
v_mfma_f32_16x16x32_bf16 v[60:63], a[8:11], a[56:59], v[60:63]
v_mul_f32 v136, v136, v10
v_mul_f32 v137, v137, v10
v_mul_f32 v138, v138, v10
v_mul_f32 v139, v139, v10
v_mul_f32 v140, v140, v10
v_mul_f32 v141, v141, v10
v_mul_f32 v142, v142, v10
v_mfma_f32_16x16x32_bf16 v[60:63], a[12:15], a[60:63], v[60:63]
v_mul_f32 v143, v143, v10
v_mul_f32 v144, v144, v10
v_mul_f32 v145, v145, v10
v_mul_f32 v146, v146, v10
v_mul_f32 v147, v147, v10
v_mul_f32 v148, v148, v10
v_mul_f32 v149, v149, v10
v_mfma_f32_16x16x32_bf16 v[64:67], a[0:3], a[64:67], v[112:115]
v_mul_f32 v150, v150, v10
v_mul_f32 v151, v151, v10
v_mul_f32 v152, v152, v10
v_mul_f32 v153, v153, v10
v_mul_f32 v154, v154, v10
v_mul_f32 v155, v155, v10
v_mul_f32 v156, v156, v10
v_mfma_f32_16x16x32_bf16 v[64:67], a[4:7], a[68:71], v[64:67]
v_mul_f32 v157, v157, v10
v_mul_f32 v158, v158, v10
v_mul_f32 v159, v159, v10
v_accvgpr_read_b32 v10, a140
v_rcp_f32 v11, v11
v_mfma_f32_16x16x32_bf16 v[64:67], a[8:11], a[72:75], v[64:67]
v_mul_f32 v168, v168, v11
v_mul_f32 v169, v169, v11
v_mul_f32 v170, v170, v11
v_mul_f32 v171, v171, v11
v_mul_f32 v172, v172, v11
v_mul_f32 v173, v173, v11
v_mul_f32 v174, v174, v11
v_mfma_f32_16x16x32_bf16 v[64:67], a[12:15], a[76:79], v[64:67]
v_mul_f32 v175, v175, v11
v_mul_f32 v176, v176, v11
v_mul_f32 v177, v177, v11
v_mul_f32 v178, v178, v11
v_mul_f32 v179, v179, v11
v_mul_f32 v180, v180, v11
v_mul_f32 v181, v181, v11
s_waitcnt vmcnt(7)
s_barrier
v_mfma_f32_16x16x32_bf16 v[68:71], a[0:3], a[80:83], v[116:119]
v_mul_f32 v182, v182, v11
v_mul_f32 v183, v183, v11
v_mul_f32 v184, v184, v11
v_mul_f32 v185, v185, v11
v_mul_f32 v186, v186, v11
v_mul_f32 v187, v187, v11
v_mul_f32 v188, v188, v11
v_mfma_f32_16x16x32_bf16 v[68:71], a[4:7], a[84:87], v[68:71]
s_add_u32 m0, s37, 0
s_add_u32 s40, s32, 32768
buffer_load_dwordx4 v6, s[16:19], s40 offen nt lds
v_mfma_f32_16x16x32_bf16 v[68:71], a[8:11], a[88:91], v[68:71]
v_mul_f32 v189, v189, v11
v_mul_f32 v190, v190, v11
v_mul_f32 v191, v191, v11
v_accvgpr_read_b32 v11, a144
v_rcp_f32 v10, v10
v_mfma_f32_16x16x32_bf16 v[68:71], a[12:15], a[92:95], v[68:71]
v_mul_f32 v200, v200, v10
v_mul_f32 v201, v201, v10
v_mul_f32 v202, v202, v10
v_mul_f32 v203, v203, v10
v_mul_f32 v204, v204, v10
v_mul_f32 v205, v205, v10
v_mul_f32 v206, v206, v10
v_mfma_f32_16x16x32_bf16 v[72:75], a[0:3], a[96:99], v[120:123]
s_add_u32 m0, s37, 64
s_nop 0
buffer_load_dwordx4 v6, s[16:19], s40 offen offset:1024 nt lds
v_mfma_f32_16x16x32_bf16 v[72:75], a[4:7], a[100:103], v[72:75]
v_mul_f32 v207, v207, v10
v_mul_f32 v208, v208, v10
v_mul_f32 v209, v209, v10
v_mul_f32 v210, v210, v10
v_mul_f32 v211, v211, v10
v_mul_f32 v212, v212, v10
v_mul_f32 v213, v213, v10
v_mfma_f32_16x16x32_bf16 v[72:75], a[8:11], a[104:107], v[72:75]
v_mul_f32 v214, v214, v10
v_mul_f32 v215, v215, v10
v_mul_f32 v216, v216, v10
v_mul_f32 v217, v217, v10
v_mul_f32 v218, v218, v10
v_mul_f32 v219, v219, v10
v_mul_f32 v220, v220, v10
v_mfma_f32_16x16x32_bf16 v[72:75], a[12:15], a[108:111], v[72:75]
v_mul_f32 v221, v221, v10
v_mul_f32 v222, v222, v10
v_mul_f32 v223, v223, v10
v_accvgpr_read_b32 v10, a148
v_rcp_f32 v11, v11
v_mfma_f32_16x16x32_bf16 v[76:79], a[0:3], a[112:115], v[124:127]
v_mul_f32 v232, v232, v11
v_mul_f32 v233, v233, v11
v_mul_f32 v234, v234, v11
v_mul_f32 v235, v235, v11
v_mul_f32 v236, v236, v11
v_mul_f32 v237, v237, v11
v_mul_f32 v238, v238, v11
v_mfma_f32_16x16x32_bf16 v[76:79], a[4:7], a[116:119], v[76:79]
v_mul_f32 v239, v239, v11
v_mul_f32 v240, v240, v11
v_mul_f32 v241, v241, v11
v_mul_f32 v242, v242, v11
v_mul_f32 v243, v243, v11
v_mul_f32 v244, v244, v11
v_mul_f32 v245, v245, v11
v_mfma_f32_16x16x32_bf16 v[76:79], a[8:11], a[120:123], v[76:79]
v_mul_f32 v246, v246, v11
v_mul_f32 v247, v247, v11
v_mul_f32 v248, v248, v11
v_mul_f32 v249, v249, v11
v_mul_f32 v250, v250, v11
v_mul_f32 v251, v251, v11
v_mul_f32 v252, v252, v11
v_mfma_f32_16x16x32_bf16 v[76:79], a[12:15], a[124:127], v[76:79]
s_waitcnt lgkmcnt(0)
ds_read_b64_tr_b16 a[0:1], v2 offset:0
ds_read_b64_tr_b16 a[2:3], v2 offset:4128
v_mfma_f32_16x16x32_bf16 v[80:83], a[16:19], a[32:35], v[104:107]
v_mul_f32 v253, v253, v11
v_mul_f32 v254, v254, v11
v_mul_f32 v255, v255, v11
v_accvgpr_read_b32 v11, a152
v_cvt_pk_bf16_f32 v20, v136, v137
v_cvt_pk_bf16_f32 v21, v138, v139
v_cvt_pk_bf16_f32 v24, v144, v145
v_mfma_f32_16x16x32_bf16 v[80:83], a[20:23], a[36:39], v[80:83]
v_cvt_pk_bf16_f32 v25, v146, v147
v_cvt_pk_bf16_f32 v26, v148, v149
v_cvt_pk_bf16_f32 v27, v150, v151
v_cvt_pk_bf16_f32 v22, v140, v141
v_cvt_pk_bf16_f32 v23, v142, v143
v_accvgpr_read_b32 v28, a164
v_accvgpr_read_b32 v29, a165
v_mfma_f32_16x16x32_bf16 v[80:83], a[24:27], a[40:43], v[80:83]
ds_read_b64_tr_b16 a[4:5], v2 offset:8
ds_read_b64_tr_b16 a[6:7], v2 offset:4136
v_mfma_f32_16x16x32_bf16 v[80:83], a[28:31], a[44:47], v[80:83]
ds_write_b128 v8, v[24:27] offset:128
v_mfma_f32_16x16x32_bf16 v[84:87], a[16:19], a[48:51], v[108:111]
v_cvt_pk_bf16_f32 v24, v168, v169
v_cvt_pk_bf16_f32 v25, v170, v171
v_cvt_pk_bf16_f32 v26, v172, v173
v_cvt_pk_bf16_f32 v27, v174, v175
v_accvgpr_read_b32 v30, a166
v_accvgpr_read_b32 v31, a167
s_add_u32 s36, s45, 20480
v_mfma_f32_16x16x32_bf16 v[84:87], a[20:23], a[52:55], v[84:87]
ds_read_b64_tr_b16 a[8:9], v3 offset:0
ds_read_b64_tr_b16 a[10:11], v3 offset:4128
v_mfma_f32_16x16x32_bf16 v[84:87], a[24:27], a[56:59], v[84:87]
ds_write_b128 v8, v[20:23] offset:64
v_mfma_f32_16x16x32_bf16 v[84:87], a[28:31], a[60:63], v[84:87]
v_cvt_pk_bf16_f32 v20, v152, v153
v_cvt_pk_bf16_f32 v21, v154, v155
v_cvt_pk_bf16_f32 v22, v156, v157
v_cvt_pk_bf16_f32 v23, v158, v159
v_rcp_f32 v10, v10
s_nop 0
v_mul_f32 v28, v28, v10
v_mfma_f32_16x16x32_bf16 v[88:91], a[16:19], a[64:67], v[112:115]
ds_read_b64_tr_b16 a[12:13], v3 offset:8
ds_read_b64_tr_b16 a[14:15], v3 offset:4136
v_mfma_f32_16x16x32_bf16 v[88:91], a[20:23], a[68:71], v[88:91]
ds_write_b128 v8, v[20:23] offset:192
v_mfma_f32_16x16x32_bf16 v[88:91], a[24:27], a[72:75], v[88:91]
v_cvt_pk_bf16_f32 v20, v176, v177
v_cvt_pk_bf16_f32 v21, v178, v179
v_cvt_pk_bf16_f32 v22, v180, v181
v_cvt_pk_bf16_f32 v23, v182, v183
v_mul_f32 v29, v29, v10
v_mul_f32 v30, v30, v10
v_mul_f32 v31, v31, v10
v_mfma_f32_16x16x32_bf16 v[88:91], a[28:31], a[76:79], v[88:91]
s_add_u32 m0, s38, 24768
s_add_u32 s40, s32, 24576
buffer_load_dwordx4 v7, s[20:23], s40 offen nt lds
v_mfma_f32_16x16x32_bf16 v[92:95], a[16:19], a[80:83], v[116:119]
ds_write_b128 v8, v[20:23] offset:4224
v_mfma_f32_16x16x32_bf16 v[92:95], a[20:23], a[84:87], v[92:95]
v_cvt_pk_bf16_f32 v20, v200, v201
v_cvt_pk_bf16_f32 v21, v202, v203
v_cvt_pk_bf16_f32 v22, v204, v205
v_cvt_pk_bf16_f32 v23, v206, v207
v_rcp_f32 v11, v11
v_mul_f32 v56, s31, v56
v_mfma_f32_16x16x32_bf16 v[92:95], a[24:27], a[88:91], v[92:95]
s_add_u32 m0, s38, 24776
s_nop 0
buffer_load_dwordx4 v7, s[20:23], s40 offen offset:1024 nt lds
v_mfma_f32_16x16x32_bf16 v[92:95], a[28:31], a[92:95], v[92:95]
ds_write_b128 v8, v[24:27] offset:4160
v_mfma_f32_16x16x32_bf16 v[96:99], a[16:19], a[96:99], v[120:123]
v_cvt_pk_bf16_f32 v24, v184, v185
v_cvt_pk_bf16_f32 v25, v186, v187
v_cvt_pk_bf16_f32 v26, v188, v189
v_cvt_pk_bf16_f32 v27, v190, v191
v_mul_f32 v57, s31, v57
v_mul_f32 v58, s31, v58
v_mul_f32 v59, s31, v59
v_mfma_f32_16x16x32_bf16 v[96:99], a[20:23], a[100:103], v[96:99]
ds_write_b128 v8, v[24:27] offset:4288
v_mfma_f32_16x16x32_bf16 v[96:99], a[24:27], a[104:107], v[96:99]
v_cvt_pk_bf16_f32 v24, v208, v209
v_cvt_pk_bf16_f32 v25, v210, v211
v_cvt_pk_bf16_f32 v26, v212, v213
v_cvt_pk_bf16_f32 v27, v214, v215
v_exp_f32 v56, v56
v_mul_f32 v60, s31, v60
v_mfma_f32_16x16x32_bf16 v[96:99], a[28:31], a[108:111], v[96:99]
ds_write_b128 v8, v[24:27] offset:8320
v_mfma_f32_16x16x32_bf16 v[100:103], a[16:19], a[112:115], v[124:127]
v_cvt_pk_bf16_f32 v24, v232, v233
v_cvt_pk_bf16_f32 v25, v234, v235
v_cvt_pk_bf16_f32 v26, v236, v237
v_cvt_pk_bf16_f32 v27, v238, v239
v_exp_f32 v57, v57
s_nop 0
v_cvt_pk_bf16_f32 v56, v56, v57
v_mfma_f32_16x16x32_bf16 v[100:103], a[20:23], a[116:119], v[100:103]
ds_write_b128 v8, v[20:23] offset:8256
v_mfma_f32_16x16x32_bf16 v[100:103], a[24:27], a[120:123], v[100:103]
v_cvt_pk_bf16_f32 v20, v216, v217
v_cvt_pk_bf16_f32 v21, v218, v219
v_cvt_pk_bf16_f32 v22, v220, v221
v_cvt_pk_bf16_f32 v23, v222, v223
v_exp_f32 v58, v58
v_mul_f32 v61, s31, v61
v_mfma_f32_16x16x32_bf16 v[100:103], a[28:31], a[124:127], v[100:103]
s_waitcnt lgkmcnt(6)
ds_read_b64_tr_b16 a[16:17], v4 offset:0
ds_read_b64_tr_b16 a[18:19], v4 offset:4128
v_mfma_f32_16x16x32_bf16 a[132:135], a[128:131], v[32:35], 0
ds_write_b128 v8, v[20:23] offset:8384
v_mfma_f32_16x16x32_bf16 a[136:139], a[128:131], v[36:39], 0
ds_write_b128 v8, v[24:27] offset:12352
v_mfma_f32_16x16x32_bf16 a[140:143], a[128:131], v[40:43], 0
ds_read_b64_tr_b16 a[20:21], v4 offset:8
ds_read_b64_tr_b16 a[22:23], v4 offset:4136
v_mfma_f32_16x16x32_bf16 a[144:147], a[128:131], v[44:47], 0
v_cvt_pk_bf16_f32 v20, v240, v241
v_cvt_pk_bf16_f32 v21, v242, v243
v_cvt_pk_bf16_f32 v22, v244, v245
v_cvt_pk_bf16_f32 v23, v246, v247
v_cvt_pk_bf16_f32 v24, v248, v249
v_cvt_pk_bf16_f32 v25, v250, v251
v_mfma_f32_16x16x32_bf16 a[148:151], a[128:131], v[48:51], 0
ds_write_b128 v8, v[20:23] offset:12416
v_mfma_f32_16x16x32_bf16 a[152:155], a[128:131], v[52:55], 0
v_cvt_pk_bf16_f32 v26, v252, v253
v_cvt_pk_bf16_f32 v27, v254, v255
v_cvt_pk_bf16_f32 v20, v28, v29
v_cvt_pk_bf16_f32 v21, v30, v31
v_accvgpr_read_b32 v28, a168
v_accvgpr_read_b32 v29, a169
v_mfma_f32_16x16x32_bf16 v[128:131], a[0:3], v[32:35], 0
ds_write_b128 v8, v[24:27] offset:12480
v_mfma_f32_16x16x32_bf16 v[160:163], a[0:3], v[36:39], 0
ds_read_b64_tr_b16 a[24:25], v5 offset:0
ds_read_b64_tr_b16 a[26:27], v5 offset:4128
v_mfma_f32_16x16x32_bf16 v[192:195], a[0:3], v[40:43], 0
v_accvgpr_read_b32 v30, a170
v_accvgpr_read_b32 v31, a171
v_mul_f32 v28, v28, v10
v_mul_f32 v29, v29, v10
v_mul_f32 v30, v30, v10
v_mul_f32 v31, v31, v10
v_mfma_f32_16x16x32_bf16 v[224:227], a[0:3], v[44:47], 0
v_cvt_pk_bf16_f32 v22, v28, v29
v_cvt_pk_bf16_f32 v23, v30, v31
v_accvgpr_read_b32 v28, a172
v_accvgpr_read_b32 v29, a173
v_accvgpr_read_b32 v30, a174
v_accvgpr_read_b32 v31, a175
v_mul_f32 v28, v28, v10
v_mfma_f32_16x16x32_bf16 a[156:159], a[0:3], v[48:51], 0
ds_read_b64_tr_b16 a[28:29], v5 offset:8
ds_read_b64_tr_b16 a[30:31], v5 offset:4136
v_mfma_f32_16x16x32_bf16 a[188:191], a[0:3], v[52:55], 0
ds_write_b128 v8, v[20:23] offset:16448
v_mfma_f32_16x16x32_bf16 v[132:135], a[4:7], v[32:35], 0
v_mul_f32 v29, v29, v10
v_mul_f32 v30, v30, v10
v_mul_f32 v31, v31, v10
v_cvt_pk_bf16_f32 v24, v28, v29
v_cvt_pk_bf16_f32 v25, v30, v31
v_accvgpr_read_b32 v28, a176
v_mfma_f32_16x16x32_bf16 v[164:167], a[4:7], v[36:39], 0
v_accvgpr_read_b32 v29, a177
v_accvgpr_read_b32 v30, a178
v_accvgpr_read_b32 v31, a179
v_mul_f32 v28, v28, v10
v_mul_f32 v29, v29, v10
v_mul_f32 v30, v30, v10
v_mfma_f32_16x16x32_bf16 v[196:199], a[4:7], v[40:43], 0
v_mul_f32 v31, v31, v10
v_cvt_pk_bf16_f32 v26, v28, v29
v_cvt_pk_bf16_f32 v27, v30, v31
v_accvgpr_read_b32 v28, a180
v_accvgpr_read_b32 v29, a181
v_accvgpr_read_b32 v30, a182
v_accvgpr_read_b32 v31, a183
v_mfma_f32_16x16x32_bf16 v[228:231], a[4:7], v[44:47], 0
v_mul_f32 v28, v28, v10
v_mul_f32 v29, v29, v10
v_mul_f32 v30, v30, v10
v_mul_f32 v31, v31, v10
v_cvt_pk_bf16_f32 v20, v28, v29
v_cvt_pk_bf16_f32 v21, v30, v31
v_mfma_f32_16x16x32_bf16 a[160:163], a[4:7], v[48:51], 0
v_accvgpr_read_b32 v28, a184
v_accvgpr_read_b32 v29, a185
v_accvgpr_read_b32 v30, a186
v_accvgpr_read_b32 v31, a187
v_mul_f32 v28, v28, v10
v_mul_f32 v29, v29, v10
v_mul_f32 v30, v30, v10
v_mfma_f32_16x16x32_bf16 a[192:195], a[4:7], v[52:55], 0
v_mul_f32 v31, v31, v10
v_cvt_pk_bf16_f32 v22, v28, v29
v_cvt_pk_bf16_f32 v23, v30, v31
v_accvgpr_read_b32 v28, a196
v_accvgpr_read_b32 v29, a197
v_accvgpr_read_b32 v30, a198
v_mfma_f32_16x16x32_bf16 v[136:139], a[8:11], v[32:35], 0
v_accvgpr_read_b32 v31, a199
v_mul_f32 v28, v28, v11
v_mul_f32 v29, v29, v11
v_mul_f32 v30, v30, v11
v_mul_f32 v31, v31, v11
v_exp_f32 v59, v59
v_mfma_f32_16x16x32_bf16 v[168:171], a[8:11], v[36:39], 0
ds_write_b128 v8, v[24:27] offset:16512
v_mfma_f32_16x16x32_bf16 v[200:203], a[8:11], v[40:43], 0
v_cvt_pk_bf16_f32 v24, v28, v29
v_cvt_pk_bf16_f32 v25, v30, v31
v_accvgpr_read_b32 v28, a200
v_accvgpr_read_b32 v29, a201
v_accvgpr_read_b32 v30, a202
v_accvgpr_read_b32 v31, a203
v_mfma_f32_16x16x32_bf16 v[232:235], a[8:11], v[44:47], 0
v_mul_f32 v28, v28, v11
v_mul_f32 v29, v29, v11
v_mul_f32 v30, v30, v11
v_mul_f32 v31, v31, v11
v_cvt_pk_bf16_f32 v26, v28, v29
v_cvt_pk_bf16_f32 v27, v30, v31
v_mfma_f32_16x16x32_bf16 a[164:167], a[8:11], v[48:51], 0
v_accvgpr_read_b32 v28, a204
v_accvgpr_read_b32 v29, a205
v_accvgpr_read_b32 v30, a206
v_accvgpr_read_b32 v31, a207
v_mul_f32 v28, v28, v11
v_mul_f32 v29, v29, v11
v_mul_f32 v30, v30, v11
v_mfma_f32_16x16x32_bf16 a[196:199], a[8:11], v[52:55], 0
ds_write_b128 v8, v[20:23] offset:16576
v_mfma_f32_16x16x32_bf16 v[140:143], a[12:15], v[32:35], 0
v_mul_f32 v31, v31, v11
v_cvt_pk_bf16_f32 v20, v28, v29
v_cvt_pk_bf16_f32 v21, v30, v31
v_accvgpr_read_b32 v28, a208
v_accvgpr_read_b32 v29, a209
v_accvgpr_read_b32 v30, a210
v_mfma_f32_16x16x32_bf16 v[172:175], a[12:15], v[36:39], 0
v_accvgpr_read_b32 v31, a211
v_mul_f32 v28, v28, v11
v_mul_f32 v29, v29, v11
v_mul_f32 v30, v30, v11
v_mul_f32 v31, v31, v11
v_cvt_pk_bf16_f32 v22, v28, v29
v_mfma_f32_16x16x32_bf16 v[204:207], a[12:15], v[40:43], 0
v_cvt_pk_bf16_f32 v23, v30, v31
v_accvgpr_read_b32 v28, a212
v_accvgpr_read_b32 v29, a213
v_accvgpr_read_b32 v30, a214
v_accvgpr_read_b32 v31, a215
v_mul_f32 v28, v28, v11
v_mul_f32 v29, v29, v11
v_mfma_f32_16x16x32_bf16 v[236:239], a[12:15], v[44:47], 0
buffer_store_dwordx4 v[24:27], v9, s[24:27], s36 offen offset:64
v_mfma_f32_16x16x32_bf16 a[168:171], a[12:15], v[48:51], 0
v_mul_f32 v30, v30, v11
v_mul_f32 v31, v31, v11
v_cvt_pk_bf16_f32 v24, v28, v29
v_cvt_pk_bf16_f32 v25, v30, v31
v_accvgpr_read_b32 v28, a216
v_accvgpr_read_b32 v29, a217
v_mfma_f32_16x16x32_bf16 a[200:203], a[12:15], v[52:55], 0
s_waitcnt lgkmcnt(3)
ds_read_b128 a[0:3], v1 offset:17408
ds_read_b128 a[4:7], v1 offset:17472
v_mfma_f32_16x16x32_bf16 v[144:147], a[16:19], v[32:35], 0
v_accvgpr_read_b32 v30, a218
v_accvgpr_read_b32 v31, a219
v_cvt_pk_bf16_f32 v57, v58, v59
v_mul_f32 v62, s31, v62
v_mul_f32 v63, s31, v63
v_mul_f32 v64, s31, v64
v_mfma_f32_16x16x32_bf16 v[176:179], a[16:19], v[36:39], 0
v_exp_f32 v60, v60
v_exp_f32 v61, v61
v_exp_f32 v62, v62
v_cvt_pk_bf16_f32 v60, v60, v61
v_mfma_f32_16x16x32_bf16 v[208:211], a[16:19], v[40:43], 0
ds_read_b128 a[8:11], v1 offset:17536
ds_read_b128 a[12:15], v1 offset:17600
v_mfma_f32_16x16x32_bf16 v[240:243], a[16:19], v[44:47], 0
v_exp_f32 v63, v63
v_mul_f32 v65, s31, v65
v_cvt_pk_bf16_f32 v61, v62, v63
v_mul_f32 v66, s31, v66
v_mul_f32 v67, s31, v67
v_mfma_f32_16x16x32_bf16 a[172:175], a[16:19], v[48:51], 0
v_exp_f32 v64, v64
v_exp_f32 v65, v65
v_exp_f32 v66, v66
v_cvt_pk_bf16_f32 v64, v64, v65
v_mfma_f32_16x16x32_bf16 a[204:207], a[16:19], v[52:55], 0
v_exp_f32 v67, v67
v_mul_f32 v68, s31, v68
v_cvt_pk_bf16_f32 v65, v66, v67
v_mul_f32 v69, s31, v69
v_mul_f32 v70, s31, v70
v_mfma_f32_16x16x32_bf16 v[148:151], a[20:23], v[32:35], 0
v_mul_f32 v71, s31, v71
v_exp_f32 v68, v68
v_exp_f32 v69, v69
v_exp_f32 v70, v70
v_mfma_f32_16x16x32_bf16 v[180:183], a[20:23], v[36:39], 0
v_exp_f32 v71, v71
v_cvt_pk_bf16_f32 v68, v68, v69
v_cvt_pk_bf16_f32 v69, v70, v71
v_mul_f32 v72, s31, v72
v_mul_f32 v73, s31, v73
v_mfma_f32_16x16x32_bf16 v[212:215], a[20:23], v[40:43], 0
v_mul_f32 v74, s31, v74
v_mul_f32 v75, s31, v75
v_exp_f32 v72, v72
v_exp_f32 v73, v73
s_nop 0
v_cvt_pk_bf16_f32 v72, v72, v73
v_mfma_f32_16x16x32_bf16 v[244:247], a[20:23], v[44:47], 0
v_exp_f32 v74, v74
v_exp_f32 v75, v75
v_mul_f32 v76, s31, v76
v_cvt_pk_bf16_f32 v73, v74, v75
v_mfma_f32_16x16x32_bf16 a[176:179], a[20:23], v[48:51], 0
v_mul_f32 v77, s31, v77
v_mul_f32 v78, s31, v78
v_mul_f32 v79, s31, v79
v_exp_f32 v76, v76
v_exp_f32 v77, v77
v_mfma_f32_16x16x32_bf16 a[208:211], a[20:23], v[52:55], 0
v_exp_f32 v78, v78
v_exp_f32 v79, v79
v_cvt_pk_bf16_f32 v76, v76, v77
v_cvt_pk_bf16_f32 v77, v78, v79
v_mfma_f32_16x16x32_bf16 v[152:155], a[24:27], v[32:35], 0
v_mul_f32 v80, s31, v80
v_mul_f32 v81, s31, v81
v_mul_f32 v82, s31, v82
v_mul_f32 v83, s31, v83
v_exp_f32 v80, v80
v_mul_f32 v84, s31, v84
v_mfma_f32_16x16x32_bf16 v[184:187], a[24:27], v[36:39], 0
v_exp_f32 v81, v81
v_exp_f32 v82, v82
v_exp_f32 v83, v83
v_mfma_f32_16x16x32_bf16 v[216:219], a[24:27], v[40:43], 0
v_cvt_pk_bf16_f32 v58, v80, v81
v_cvt_pk_bf16_f32 v59, v82, v83
v_mul_f32 v85, s31, v85
v_mul_f32 v86, s31, v86
v_mul_f32 v87, s31, v87
v_exp_f32 v84, v84
v_mfma_f32_16x16x32_bf16 v[248:251], a[24:27], v[44:47], 0
v_exp_f32 v85, v85
v_exp_f32 v86, v86
v_exp_f32 v87, v87
v_mfma_f32_16x16x32_bf16 a[180:183], a[24:27], v[48:51], 0
v_cvt_pk_bf16_f32 v62, v84, v85
v_cvt_pk_bf16_f32 v63, v86, v87
v_mul_f32 v88, s31, v88
v_mul_f32 v89, s31, v89
v_mul_f32 v90, s31, v90
v_mul_f32 v91, s31, v91
v_mul_f32 v92, s31, v92
v_mfma_f32_16x16x32_bf16 a[212:215], a[24:27], v[52:55], 0
v_exp_f32 v88, v88
v_exp_f32 v89, v89
v_exp_f32 v90, v90
v_mfma_f32_16x16x32_bf16 v[156:159], a[28:31], v[32:35], 0
v_exp_f32 v91, v91
v_cvt_pk_bf16_f32 v66, v88, v89
v_cvt_pk_bf16_f32 v67, v90, v91
v_mul_f32 v93, s31, v93
v_mul_f32 v94, s31, v94
v_mul_f32 v95, s31, v95
v_mfma_f32_16x16x32_bf16 v[188:191], a[28:31], v[36:39], 0
v_exp_f32 v92, v92
v_exp_f32 v93, v93
v_exp_f32 v94, v94
v_mfma_f32_16x16x32_bf16 v[220:223], a[28:31], v[40:43], 0
v_exp_f32 v95, v95
v_cvt_pk_bf16_f32 v70, v92, v93
v_cvt_pk_bf16_f32 v71, v94, v95
s_add_u32 s36, s45, 20480
v_mul_f32 v28, v28, v11
v_mul_f32 v29, v29, v11
v_mfma_f32_16x16x32_bf16 v[252:255], a[28:31], v[44:47], 0
buffer_store_dwordx4 v[20:23], v9, s[24:27], s36 offen offset:128
v_mfma_f32_16x16x32_bf16 a[184:187], a[28:31], v[48:51], 0
v_mul_f32 v30, v30, v11
v_mul_f32 v31, v31, v11
v_cvt_pk_bf16_f32 v26, v28, v29
v_cvt_pk_bf16_f32 v27, v30, v31
s_add_u32 s36, s45, 20480
v_mfma_f32_16x16x32_bf16 a[216:219], a[28:31], v[52:55], 0
buffer_store_dwordx4 v[24:27], v9, s[24:27], s36 offen offset:192
L_it1:
s_waitcnt lgkmcnt(0)
ds_read_b128 a[16:19], v1 offset:21760
ds_read_b128 a[20:23], v1 offset:21824
v_mfma_f32_16x16x32_bf16 v[32:35], a[0:3], a[32:35], v[104:107]
v_mul_f32 v96, s31, v96
v_mul_f32 v97, s31, v97
v_mfma_f32_16x16x32_bf16 v[32:35], a[4:7], a[36:39], v[32:35]
v_mul_f32 v98, s31, v98
v_mul_f32 v99, s31, v99
v_mfma_f32_16x16x32_bf16 v[32:35], a[8:11], a[40:43], v[32:35]
ds_read_b128 a[24:27], v1 offset:21888
ds_read_b128 a[28:31], v1 offset:21952
v_mfma_f32_16x16x32_bf16 v[32:35], a[12:15], a[44:47], v[32:35]
v_exp_f32 v96, v96
v_mfma_f32_16x16x32_bf16 v[36:39], a[0:3], a[48:51], v[108:111]
v_exp_f32 v97, v97
v_mfma_f32_16x16x32_bf16 v[36:39], a[4:7], a[52:55], v[36:39]
v_exp_f32 v98, v98
v_mfma_f32_16x16x32_bf16 v[36:39], a[8:11], a[56:59], v[36:39]
ds_read_b128 v[20:23], v0 offset:0
ds_read_b128 v[24:27], v0 offset:1024
ds_read_b128 v[28:31], v0 offset:2048
v_mfma_f32_16x16x32_bf16 v[36:39], a[12:15], a[60:63], v[36:39]
v_exp_f32 v99, v99
v_mfma_f32_16x16x32_bf16 v[40:43], a[0:3], a[64:67], v[112:115]
v_cvt_pk_bf16_f32 v74, v96, v97
v_cvt_pk_bf16_f32 v75, v98, v99
v_mfma_f32_16x16x32_bf16 v[40:43], a[4:7], a[68:71], v[40:43]
v_mul_f32 v100, s31, v100
v_mul_f32 v101, s31, v101
v_mfma_f32_16x16x32_bf16 v[40:43], a[8:11], a[72:75], v[40:43]
v_mul_f32 v102, s31, v102
v_mul_f32 v103, s31, v103
v_mfma_f32_16x16x32_bf16 v[40:43], a[12:15], a[76:79], v[40:43]
v_exp_f32 v100, v100
s_waitcnt vmcnt(6)
s_barrier
v_mfma_f32_16x16x32_bf16 v[44:47], a[0:3], a[80:83], v[116:119]
v_exp_f32 v101, v101
v_mfma_f32_16x16x32_bf16 v[44:47], a[4:7], a[84:87], v[44:47]
s_add_u32 m0, s37, 8704
s_add_u32 s40, s32, 40960
buffer_load_dwordx4 v6, s[16:19], s40 offen nt lds
v_mfma_f32_16x16x32_bf16 v[44:47], a[8:11], a[88:91], v[44:47]
v_exp_f32 v102, v102
v_mfma_f32_16x16x32_bf16 v[44:47], a[12:15], a[92:95], v[44:47]
v_exp_f32 v103, v103
v_mfma_f32_16x16x32_bf16 v[48:51], a[0:3], a[96:99], v[120:123]
s_add_u32 m0, s37, 8768
s_nop 0
buffer_load_dwordx4 v6, s[16:19], s40 offen offset:1024 nt lds
v_mfma_f32_16x16x32_bf16 v[48:51], a[4:7], a[100:103], v[48:51]
v_cvt_pk_bf16_f32 v78, v100, v101
v_cvt_pk_bf16_f32 v79, v102, v103
v_mfma_f32_16x16x32_bf16 v[48:51], a[8:11], a[104:107], v[48:51]
v_mul_f32 v32, s31, v32
v_mul_f32 v33, s31, v33
v_mfma_f32_16x16x32_bf16 v[48:51], a[12:15], a[108:111], v[48:51]
v_mul_f32 v34, s31, v34
v_mul_f32 v35, s31, v35
v_mfma_f32_16x16x32_bf16 v[52:55], a[0:3], a[112:115], v[124:127]
v_exp_f32 v32, v32
v_mfma_f32_16x16x32_bf16 v[52:55], a[4:7], a[116:119], v[52:55]
v_exp_f32 v33, v33
v_mfma_f32_16x16x32_bf16 v[52:55], a[8:11], a[120:123], v[52:55]
v_exp_f32 v34, v34
v_mfma_f32_16x16x32_bf16 v[52:55], a[12:15], a[124:127], v[52:55]
s_waitcnt lgkmcnt(3)
s_add_u32 s36, s45, 0
s_waitcnt lgkmcnt(2)
buffer_store_dwordx4 v[20:23], v6, s[24:27], s36 offen offset:0
ds_read_b64_tr_b16 a[0:1], v2 offset:8256
ds_read_b64_tr_b16 a[2:3], v2 offset:12384
v_mfma_f32_16x16x32_bf16 v[80:83], a[16:19], a[32:35], v[104:107]
v_exp_f32 v35, v35
v_mfma_f32_16x16x32_bf16 v[80:83], a[20:23], a[36:39], v[80:83]
v_cvt_pk_bf16_f32 v32, v32, v33
v_cvt_pk_bf16_f32 v33, v34, v35
v_mfma_f32_16x16x32_bf16 v[80:83], a[24:27], a[40:43], v[80:83]
ds_read_b64_tr_b16 a[4:5], v2 offset:8264
ds_read_b64_tr_b16 a[6:7], v2 offset:12392
v_mfma_f32_16x16x32_bf16 v[80:83], a[28:31], a[44:47], v[80:83]
v_mul_f32 v36, s31, v36
v_mul_f32 v37, s31, v37
v_mfma_f32_16x16x32_bf16 v[84:87], a[16:19], a[48:51], v[108:111]
v_mul_f32 v38, s31, v38
v_mul_f32 v39, s31, v39
v_mfma_f32_16x16x32_bf16 v[84:87], a[20:23], a[52:55], v[84:87]
v_mfma_f32_16x16x32_bf16 v[84:87], a[24:27], a[56:59], v[84:87]
v_exp_f32 v36, v36
v_mfma_f32_16x16x32_bf16 v[84:87], a[28:31], a[60:63], v[84:87]
s_add_u32 s36, s45, 0
s_waitcnt lgkmcnt(5)
buffer_store_dwordx4 v[24:27], v6, s[24:27], s36 offen offset:1024
ds_read_b64_tr_b16 a[8:9], v3 offset:8256
ds_read_b64_tr_b16 a[10:11], v3 offset:12384
v_mfma_f32_16x16x32_bf16 v[88:91], a[16:19], a[64:67], v[112:115]
ds_read_b64_tr_b16 a[12:13], v3 offset:8264
ds_read_b64_tr_b16 a[14:15], v3 offset:12392
v_mfma_f32_16x16x32_bf16 v[88:91], a[20:23], a[68:71], v[88:91]
v_exp_f32 v37, v37
v_mfma_f32_16x16x32_bf16 v[88:91], a[24:27], a[72:75], v[88:91]
v_exp_f32 v38, v38
v_mfma_f32_16x16x32_bf16 v[88:91], a[28:31], a[76:79], v[88:91]
s_add_u32 m0, s38, 0
s_add_u32 s40, s32, 32768
buffer_load_dwordx4 v7, s[20:23], s40 offen nt lds
ds_read_b128 v[20:23], v0 offset:3072
v_mfma_f32_16x16x32_bf16 v[92:95], a[16:19], a[80:83], v[116:119]
v_exp_f32 v39, v39
v_mfma_f32_16x16x32_bf16 v[92:95], a[20:23], a[84:87], v[92:95]
v_cvt_pk_bf16_f32 v36, v36, v37
v_cvt_pk_bf16_f32 v37, v38, v39
v_mfma_f32_16x16x32_bf16 v[92:95], a[24:27], a[88:91], v[92:95]
s_add_u32 m0, s38, 8
s_nop 0
buffer_load_dwordx4 v7, s[20:23], s40 offen offset:1024 nt lds
v_mfma_f32_16x16x32_bf16 v[92:95], a[28:31], a[92:95], v[92:95]
v_mul_f32 v40, s31, v40
v_mul_f32 v41, s31, v41
v_mfma_f32_16x16x32_bf16 v[96:99], a[16:19], a[96:99], v[120:123]
v_mul_f32 v42, s31, v42
v_mul_f32 v43, s31, v43
v_mfma_f32_16x16x32_bf16 v[96:99], a[20:23], a[100:103], v[96:99]
v_exp_f32 v40, v40
v_mfma_f32_16x16x32_bf16 v[96:99], a[24:27], a[104:107], v[96:99]
v_exp_f32 v41, v41
v_mfma_f32_16x16x32_bf16 v[96:99], a[28:31], a[108:111], v[96:99]
v_exp_f32 v42, v42
v_mfma_f32_16x16x32_bf16 v[100:103], a[16:19], a[112:115], v[124:127]
v_exp_f32 v43, v43
v_mfma_f32_16x16x32_bf16 v[100:103], a[20:23], a[116:119], v[100:103]
v_cvt_pk_bf16_f32 v40, v40, v41
v_cvt_pk_bf16_f32 v41, v42, v43
v_mfma_f32_16x16x32_bf16 v[100:103], a[24:27], a[120:123], v[100:103]
v_mul_f32 v44, s31, v44
v_mul_f32 v45, s31, v45
v_mfma_f32_16x16x32_bf16 v[100:103], a[28:31], a[124:127], v[100:103]
s_waitcnt lgkmcnt(1)
s_add_u32 s36, s45, 0
buffer_store_dwordx4 v[28:31], v6, s[24:27], s36 offen offset:2048
ds_read_b64_tr_b16 a[16:17], v4 offset:8256
ds_read_b64_tr_b16 a[18:19], v4 offset:12384
v_mfma_f32_16x16x32_bf16 a[132:135], a[128:131], v[56:59], a[132:135]
v_mul_f32 v46, s31, v46
v_mul_f32 v47, s31, v47
v_mfma_f32_16x16x32_bf16 a[136:139], a[128:131], v[60:63], a[136:139]
v_exp_f32 v44, v44
v_mfma_f32_16x16x32_bf16 a[140:143], a[128:131], v[64:67], a[140:143]
ds_read_b64_tr_b16 a[20:21], v4 offset:8264
ds_read_b64_tr_b16 a[22:23], v4 offset:12392
v_mfma_f32_16x16x32_bf16 a[144:147], a[128:131], v[68:71], a[144:147]
v_exp_f32 v45, v45
v_mfma_f32_16x16x32_bf16 a[148:151], a[128:131], v[72:75], a[148:151]
v_exp_f32 v46, v46
v_mfma_f32_16x16x32_bf16 a[152:155], a[128:131], v[76:79], a[152:155]
v_exp_f32 v47, v47
v_mfma_f32_16x16x32_bf16 v[128:131], a[0:3], v[56:59], v[128:131]
v_cvt_pk_bf16_f32 v44, v44, v45
v_cvt_pk_bf16_f32 v45, v46, v47
v_mfma_f32_16x16x32_bf16 v[160:163], a[0:3], v[60:63], v[160:163]
s_add_u32 s36, s45, 0
s_waitcnt lgkmcnt(4)
buffer_store_dwordx4 v[20:23], v6, s[24:27], s36 offen offset:3072
ds_read_b64_tr_b16 a[24:25], v5 offset:8256
ds_read_b64_tr_b16 a[26:27], v5 offset:12384
v_mfma_f32_16x16x32_bf16 v[192:195], a[0:3], v[64:67], v[192:195]
v_mul_f32 v48, s31, v48
v_mul_f32 v49, s31, v49
v_mfma_f32_16x16x32_bf16 v[224:227], a[0:3], v[68:71], v[224:227]
v_mul_f32 v50, s31, v50
v_mul_f32 v51, s31, v51
v_mfma_f32_16x16x32_bf16 a[156:159], a[0:3], v[72:75], a[156:159]
ds_read_b64_tr_b16 a[28:29], v5 offset:8264
ds_read_b64_tr_b16 a[30:31], v5 offset:12392
v_mfma_f32_16x16x32_bf16 a[188:191], a[0:3], v[76:79], a[188:191]
v_exp_f32 v48, v48
v_mfma_f32_16x16x32_bf16 v[132:135], a[4:7], v[56:59], v[132:135]
v_exp_f32 v49, v49
v_mfma_f32_16x16x32_bf16 v[164:167], a[4:7], v[60:63], v[164:167]
v_exp_f32 v50, v50
v_mfma_f32_16x16x32_bf16 v[196:199], a[4:7], v[64:67], v[196:199]
v_exp_f32 v51, v51
v_mfma_f32_16x16x32_bf16 v[228:231], a[4:7], v[68:71], v[228:231]
v_cvt_pk_bf16_f32 v48, v48, v49
v_cvt_pk_bf16_f32 v49, v50, v51
v_mfma_f32_16x16x32_bf16 a[160:163], a[4:7], v[72:75], a[160:163]
v_mul_f32 v52, s31, v52
v_mul_f32 v53, s31, v53
v_mfma_f32_16x16x32_bf16 a[192:195], a[4:7], v[76:79], a[192:195]
v_mul_f32 v54, s31, v54
v_mul_f32 v55, s31, v55
v_mfma_f32_16x16x32_bf16 v[136:139], a[8:11], v[56:59], v[136:139]
v_exp_f32 v52, v52
v_mfma_f32_16x16x32_bf16 v[168:171], a[8:11], v[60:63], v[168:171]
v_exp_f32 v53, v53
v_mfma_f32_16x16x32_bf16 v[200:203], a[8:11], v[64:67], v[200:203]
v_exp_f32 v54, v54
v_mfma_f32_16x16x32_bf16 v[232:235], a[8:11], v[68:71], v[232:235]
v_exp_f32 v55, v55
v_mfma_f32_16x16x32_bf16 a[164:167], a[8:11], v[72:75], a[164:167]
v_cvt_pk_bf16_f32 v52, v52, v53
v_cvt_pk_bf16_f32 v53, v54, v55
v_mfma_f32_16x16x32_bf16 a[196:199], a[8:11], v[76:79], a[196:199]
v_mul_f32 v80, s31, v80
v_mul_f32 v81, s31, v81
v_mfma_f32_16x16x32_bf16 v[140:143], a[12:15], v[56:59], v[140:143]
v_mul_f32 v82, s31, v82
v_mul_f32 v83, s31, v83
v_mfma_f32_16x16x32_bf16 v[172:175], a[12:15], v[60:63], v[172:175]
v_exp_f32 v80, v80
v_mfma_f32_16x16x32_bf16 v[204:207], a[12:15], v[64:67], v[204:207]
v_exp_f32 v81, v81
v_mfma_f32_16x16x32_bf16 v[236:239], a[12:15], v[68:71], v[236:239]
v_exp_f32 v82, v82
v_mfma_f32_16x16x32_bf16 a[168:171], a[12:15], v[72:75], a[168:171]
v_exp_f32 v83, v83
v_mfma_f32_16x16x32_bf16 a[200:203], a[12:15], v[76:79], a[200:203]
s_waitcnt lgkmcnt(0)
ds_read_b128 a[0:3], v1 offset:26112
ds_read_b128 a[4:7], v1 offset:26176
v_mfma_f32_16x16x32_bf16 v[144:147], a[16:19], v[56:59], v[144:147]
v_cvt_pk_bf16_f32 v34, v80, v81
v_cvt_pk_bf16_f32 v35, v82, v83
v_mfma_f32_16x16x32_bf16 v[176:179], a[16:19], v[60:63], v[176:179]
v_mul_f32 v84, s31, v84
v_mul_f32 v85, s31, v85
v_mfma_f32_16x16x32_bf16 v[208:211], a[16:19], v[64:67], v[208:211]
ds_read_b128 a[8:11], v1 offset:26240
ds_read_b128 a[12:15], v1 offset:26304
v_mfma_f32_16x16x32_bf16 v[240:243], a[16:19], v[68:71], v[240:243]
v_mul_f32 v86, s31, v86
v_mul_f32 v87, s31, v87
v_mfma_f32_16x16x32_bf16 a[172:175], a[16:19], v[72:75], a[172:175]
v_exp_f32 v84, v84
v_mfma_f32_16x16x32_bf16 a[204:207], a[16:19], v[76:79], a[204:207]
v_exp_f32 v85, v85
v_mfma_f32_16x16x32_bf16 v[148:151], a[20:23], v[56:59], v[148:151]
v_exp_f32 v86, v86
v_mfma_f32_16x16x32_bf16 v[180:183], a[20:23], v[60:63], v[180:183]
v_exp_f32 v87, v87
v_mfma_f32_16x16x32_bf16 v[212:215], a[20:23], v[64:67], v[212:215]
v_cvt_pk_bf16_f32 v38, v84, v85
v_cvt_pk_bf16_f32 v39, v86, v87
v_mfma_f32_16x16x32_bf16 v[244:247], a[20:23], v[68:71], v[244:247]
v_mul_f32 v88, s31, v88
v_mul_f32 v89, s31, v89
v_mfma_f32_16x16x32_bf16 a[176:179], a[20:23], v[72:75], a[176:179]
v_mul_f32 v90, s31, v90
v_mul_f32 v91, s31, v91
v_mfma_f32_16x16x32_bf16 a[208:211], a[20:23], v[76:79], a[208:211]
v_exp_f32 v88, v88
v_mfma_f32_16x16x32_bf16 v[152:155], a[24:27], v[56:59], v[152:155]
v_exp_f32 v89, v89
v_mfma_f32_16x16x32_bf16 v[184:187], a[24:27], v[60:63], v[184:187]
v_exp_f32 v90, v90
v_mfma_f32_16x16x32_bf16 v[216:219], a[24:27], v[64:67], v[216:219]
v_exp_f32 v91, v91
v_mfma_f32_16x16x32_bf16 v[248:251], a[24:27], v[68:71], v[248:251]
v_cvt_pk_bf16_f32 v42, v88, v89
v_cvt_pk_bf16_f32 v43, v90, v91
v_mfma_f32_16x16x32_bf16 a[180:183], a[24:27], v[72:75], a[180:183]
v_mul_f32 v92, s31, v92
v_mul_f32 v93, s31, v93
v_mfma_f32_16x16x32_bf16 a[212:215], a[24:27], v[76:79], a[212:215]
v_mul_f32 v94, s31, v94
v_mul_f32 v95, s31, v95
v_mfma_f32_16x16x32_bf16 v[156:159], a[28:31], v[56:59], v[156:159]
v_exp_f32 v92, v92
v_mfma_f32_16x16x32_bf16 v[188:191], a[28:31], v[60:63], v[188:191]
v_exp_f32 v93, v93
v_mfma_f32_16x16x32_bf16 v[220:223], a[28:31], v[64:67], v[220:223]
v_exp_f32 v94, v94
v_mfma_f32_16x16x32_bf16 v[252:255], a[28:31], v[68:71], v[252:255]
v_exp_f32 v95, v95
v_mfma_f32_16x16x32_bf16 a[184:187], a[28:31], v[72:75], a[184:187]
v_cvt_pk_bf16_f32 v46, v92, v93
v_cvt_pk_bf16_f32 v47, v94, v95
v_mfma_f32_16x16x32_bf16 a[216:219], a[28:31], v[76:79], a[216:219]
s_waitcnt lgkmcnt(0)
ds_read_b128 a[16:19], v1 offset:30464
ds_read_b128 a[20:23], v1 offset:30528
v_mfma_f32_16x16x32_bf16 v[56:59], a[0:3], a[32:35], v[104:107]
v_mul_f32 v96, s31, v96
v_mul_f32 v97, s31, v97
v_mfma_f32_16x16x32_bf16 v[56:59], a[4:7], a[36:39], v[56:59]
v_mul_f32 v98, s31, v98
v_mul_f32 v99, s31, v99
v_mfma_f32_16x16x32_bf16 v[56:59], a[8:11], a[40:43], v[56:59]
ds_read_b128 a[24:27], v1 offset:30592
ds_read_b128 a[28:31], v1 offset:30656
v_mfma_f32_16x16x32_bf16 v[56:59], a[12:15], a[44:47], v[56:59]
v_exp_f32 v96, v96
v_mfma_f32_16x16x32_bf16 v[60:63], a[0:3], a[48:51], v[108:111]
v_exp_f32 v97, v97
v_mfma_f32_16x16x32_bf16 v[60:63], a[4:7], a[52:55], v[60:63]
v_exp_f32 v98, v98
v_mfma_f32_16x16x32_bf16 v[60:63], a[8:11], a[56:59], v[60:63]
ds_read_b128 v[20:23], v0 offset:4096
ds_read_b128 v[24:27], v0 offset:5120
ds_read_b128 v[28:31], v0 offset:6144
v_mfma_f32_16x16x32_bf16 v[60:63], a[12:15], a[60:63], v[60:63]
v_exp_f32 v99, v99
v_mfma_f32_16x16x32_bf16 v[64:67], a[0:3], a[64:67], v[112:115]
v_cvt_pk_bf16_f32 v50, v96, v97
v_cvt_pk_bf16_f32 v51, v98, v99
v_mfma_f32_16x16x32_bf16 v[64:67], a[4:7], a[68:71], v[64:67]
v_mul_f32 v100, s31, v100
v_mul_f32 v101, s31, v101
v_mfma_f32_16x16x32_bf16 v[64:67], a[8:11], a[72:75], v[64:67]
v_mul_f32 v102, s31, v102
v_mul_f32 v103, s31, v103
v_mfma_f32_16x16x32_bf16 v[64:67], a[12:15], a[76:79], v[64:67]
v_exp_f32 v100, v100
s_waitcnt vmcnt(10)
s_barrier
v_mfma_f32_16x16x32_bf16 v[68:71], a[0:3], a[80:83], v[116:119]
v_exp_f32 v101, v101
v_mfma_f32_16x16x32_bf16 v[68:71], a[4:7], a[84:87], v[68:71]
s_add_u32 m0, s37, 17408
s_add_u32 s40, s32, 49152
buffer_load_dwordx4 v6, s[16:19], s40 offen nt lds
v_mfma_f32_16x16x32_bf16 v[68:71], a[8:11], a[88:91], v[68:71]
v_exp_f32 v102, v102
v_mfma_f32_16x16x32_bf16 v[68:71], a[12:15], a[92:95], v[68:71]
v_exp_f32 v103, v103
v_mfma_f32_16x16x32_bf16 v[72:75], a[0:3], a[96:99], v[120:123]
s_add_u32 m0, s37, 17472
s_nop 0
buffer_load_dwordx4 v6, s[16:19], s40 offen offset:1024 nt lds
v_mfma_f32_16x16x32_bf16 v[72:75], a[4:7], a[100:103], v[72:75]
v_cvt_pk_bf16_f32 v54, v100, v101
v_cvt_pk_bf16_f32 v55, v102, v103
v_mfma_f32_16x16x32_bf16 v[72:75], a[8:11], a[104:107], v[72:75]
v_mul_f32 v56, s31, v56
v_mul_f32 v57, s31, v57
v_mfma_f32_16x16x32_bf16 v[72:75], a[12:15], a[108:111], v[72:75]
v_mul_f32 v58, s31, v58
v_mul_f32 v59, s31, v59
v_mfma_f32_16x16x32_bf16 v[76:79], a[0:3], a[112:115], v[124:127]
v_exp_f32 v56, v56
v_mfma_f32_16x16x32_bf16 v[76:79], a[4:7], a[116:119], v[76:79]
v_exp_f32 v57, v57
v_mfma_f32_16x16x32_bf16 v[76:79], a[8:11], a[120:123], v[76:79]
v_exp_f32 v58, v58
v_mfma_f32_16x16x32_bf16 v[76:79], a[12:15], a[124:127], v[76:79]
s_waitcnt lgkmcnt(3)
s_add_u32 s36, s45, 4096
s_waitcnt lgkmcnt(2)
buffer_store_dwordx4 v[20:23], v6, s[24:27], s36 offen offset:0
ds_read_b64_tr_b16 a[0:1], v2 offset:16512
ds_read_b64_tr_b16 a[2:3], v2 offset:20640
v_mfma_f32_16x16x32_bf16 v[80:83], a[16:19], a[32:35], v[104:107]
v_exp_f32 v59, v59
v_mfma_f32_16x16x32_bf16 v[80:83], a[20:23], a[36:39], v[80:83]
v_cvt_pk_bf16_f32 v56, v56, v57
v_cvt_pk_bf16_f32 v57, v58, v59
v_mfma_f32_16x16x32_bf16 v[80:83], a[24:27], a[40:43], v[80:83]
ds_read_b64_tr_b16 a[4:5], v2 offset:16520
ds_read_b64_tr_b16 a[6:7], v2 offset:20648
v_mfma_f32_16x16x32_bf16 v[80:83], a[28:31], a[44:47], v[80:83]
v_mul_f32 v60, s31, v60
v_mul_f32 v61, s31, v61
v_mfma_f32_16x16x32_bf16 v[84:87], a[16:19], a[48:51], v[108:111]
v_mul_f32 v62, s31, v62
v_mul_f32 v63, s31, v63
v_mfma_f32_16x16x32_bf16 v[84:87], a[20:23], a[52:55], v[84:87]
v_mfma_f32_16x16x32_bf16 v[84:87], a[24:27], a[56:59], v[84:87]
v_exp_f32 v60, v60
v_mfma_f32_16x16x32_bf16 v[84:87], a[28:31], a[60:63], v[84:87]
s_add_u32 s36, s45, 4096
s_waitcnt lgkmcnt(5)
buffer_store_dwordx4 v[24:27], v6, s[24:27], s36 offen offset:1024
ds_read_b64_tr_b16 a[8:9], v3 offset:16512
ds_read_b64_tr_b16 a[10:11], v3 offset:20640
v_mfma_f32_16x16x32_bf16 v[88:91], a[16:19], a[64:67], v[112:115]
ds_read_b64_tr_b16 a[12:13], v3 offset:16520
ds_read_b64_tr_b16 a[14:15], v3 offset:20648
v_mfma_f32_16x16x32_bf16 v[88:91], a[20:23], a[68:71], v[88:91]
v_exp_f32 v61, v61
v_mfma_f32_16x16x32_bf16 v[88:91], a[24:27], a[72:75], v[88:91]
v_exp_f32 v62, v62
v_mfma_f32_16x16x32_bf16 v[88:91], a[28:31], a[76:79], v[88:91]
s_add_u32 m0, s38, 8256
s_add_u32 s40, s32, 40960
buffer_load_dwordx4 v7, s[20:23], s40 offen nt lds
ds_read_b128 v[20:23], v0 offset:7168
v_mfma_f32_16x16x32_bf16 v[92:95], a[16:19], a[80:83], v[116:119]
v_exp_f32 v63, v63
v_mfma_f32_16x16x32_bf16 v[92:95], a[20:23], a[84:87], v[92:95]
v_cvt_pk_bf16_f32 v60, v60, v61
v_cvt_pk_bf16_f32 v61, v62, v63
v_mfma_f32_16x16x32_bf16 v[92:95], a[24:27], a[88:91], v[92:95]
s_add_u32 m0, s38, 8264
s_nop 0
buffer_load_dwordx4 v7, s[20:23], s40 offen offset:1024 nt lds
v_mfma_f32_16x16x32_bf16 v[92:95], a[28:31], a[92:95], v[92:95]
v_mul_f32 v64, s31, v64
v_mul_f32 v65, s31, v65
v_mfma_f32_16x16x32_bf16 v[96:99], a[16:19], a[96:99], v[120:123]
v_mul_f32 v66, s31, v66
v_mul_f32 v67, s31, v67
v_mfma_f32_16x16x32_bf16 v[96:99], a[20:23], a[100:103], v[96:99]
v_exp_f32 v64, v64
v_mfma_f32_16x16x32_bf16 v[96:99], a[24:27], a[104:107], v[96:99]
v_exp_f32 v65, v65
v_mfma_f32_16x16x32_bf16 v[96:99], a[28:31], a[108:111], v[96:99]
v_exp_f32 v66, v66
v_mfma_f32_16x16x32_bf16 v[100:103], a[16:19], a[112:115], v[124:127]
v_exp_f32 v67, v67
v_mfma_f32_16x16x32_bf16 v[100:103], a[20:23], a[116:119], v[100:103]
v_cvt_pk_bf16_f32 v64, v64, v65
v_cvt_pk_bf16_f32 v65, v66, v67
v_mfma_f32_16x16x32_bf16 v[100:103], a[24:27], a[120:123], v[100:103]
v_mul_f32 v68, s31, v68
v_mul_f32 v69, s31, v69
v_mfma_f32_16x16x32_bf16 v[100:103], a[28:31], a[124:127], v[100:103]
s_waitcnt lgkmcnt(1)
s_add_u32 s36, s45, 4096
buffer_store_dwordx4 v[28:31], v6, s[24:27], s36 offen offset:2048
ds_read_b64_tr_b16 a[16:17], v4 offset:16512
ds_read_b64_tr_b16 a[18:19], v4 offset:20640
v_mfma_f32_16x16x32_bf16 a[132:135], a[128:131], v[32:35], a[132:135]
v_mul_f32 v70, s31, v70
v_mul_f32 v71, s31, v71
v_mfma_f32_16x16x32_bf16 a[136:139], a[128:131], v[36:39], a[136:139]
v_exp_f32 v68, v68
v_mfma_f32_16x16x32_bf16 a[140:143], a[128:131], v[40:43], a[140:143]
ds_read_b64_tr_b16 a[20:21], v4 offset:16520
ds_read_b64_tr_b16 a[22:23], v4 offset:20648
v_mfma_f32_16x16x32_bf16 a[144:147], a[128:131], v[44:47], a[144:147]
v_exp_f32 v69, v69
v_mfma_f32_16x16x32_bf16 a[148:151], a[128:131], v[48:51], a[148:151]
v_exp_f32 v70, v70
v_mfma_f32_16x16x32_bf16 a[152:155], a[128:131], v[52:55], a[152:155]
v_exp_f32 v71, v71
v_mfma_f32_16x16x32_bf16 v[128:131], a[0:3], v[32:35], v[128:131]
v_cvt_pk_bf16_f32 v68, v68, v69
v_cvt_pk_bf16_f32 v69, v70, v71
v_mfma_f32_16x16x32_bf16 v[160:163], a[0:3], v[36:39], v[160:163]
s_add_u32 s36, s45, 4096
s_waitcnt lgkmcnt(4)
buffer_store_dwordx4 v[20:23], v6, s[24:27], s36 offen offset:3072
ds_read_b64_tr_b16 a[24:25], v5 offset:16512
ds_read_b64_tr_b16 a[26:27], v5 offset:20640
v_mfma_f32_16x16x32_bf16 v[192:195], a[0:3], v[40:43], v[192:195]
v_mul_f32 v72, s31, v72
v_mul_f32 v73, s31, v73
v_mfma_f32_16x16x32_bf16 v[224:227], a[0:3], v[44:47], v[224:227]
v_mul_f32 v74, s31, v74
v_mul_f32 v75, s31, v75
v_mfma_f32_16x16x32_bf16 a[156:159], a[0:3], v[48:51], a[156:159]
ds_read_b64_tr_b16 a[28:29], v5 offset:16520
ds_read_b64_tr_b16 a[30:31], v5 offset:20648
v_mfma_f32_16x16x32_bf16 a[188:191], a[0:3], v[52:55], a[188:191]
v_exp_f32 v72, v72
v_mfma_f32_16x16x32_bf16 v[132:135], a[4:7], v[32:35], v[132:135]
v_exp_f32 v73, v73
v_mfma_f32_16x16x32_bf16 v[164:167], a[4:7], v[36:39], v[164:167]
v_exp_f32 v74, v74
v_mfma_f32_16x16x32_bf16 v[196:199], a[4:7], v[40:43], v[196:199]
v_exp_f32 v75, v75
v_mfma_f32_16x16x32_bf16 v[228:231], a[4:7], v[44:47], v[228:231]
v_cvt_pk_bf16_f32 v72, v72, v73
v_cvt_pk_bf16_f32 v73, v74, v75
v_mfma_f32_16x16x32_bf16 a[160:163], a[4:7], v[48:51], a[160:163]
v_mul_f32 v76, s31, v76
v_mul_f32 v77, s31, v77
v_mfma_f32_16x16x32_bf16 a[192:195], a[4:7], v[52:55], a[192:195]
v_mul_f32 v78, s31, v78
v_mul_f32 v79, s31, v79
v_mfma_f32_16x16x32_bf16 v[136:139], a[8:11], v[32:35], v[136:139]
v_exp_f32 v76, v76
v_mfma_f32_16x16x32_bf16 v[168:171], a[8:11], v[36:39], v[168:171]
v_exp_f32 v77, v77
v_mfma_f32_16x16x32_bf16 v[200:203], a[8:11], v[40:43], v[200:203]
v_exp_f32 v78, v78
v_mfma_f32_16x16x32_bf16 v[232:235], a[8:11], v[44:47], v[232:235]
v_exp_f32 v79, v79
v_mfma_f32_16x16x32_bf16 a[164:167], a[8:11], v[48:51], a[164:167]
v_cvt_pk_bf16_f32 v76, v76, v77
v_cvt_pk_bf16_f32 v77, v78, v79
v_mfma_f32_16x16x32_bf16 a[196:199], a[8:11], v[52:55], a[196:199]
v_mul_f32 v80, s31, v80
v_mul_f32 v81, s31, v81
v_mfma_f32_16x16x32_bf16 v[140:143], a[12:15], v[32:35], v[140:143]
v_mul_f32 v82, s31, v82
v_mul_f32 v83, s31, v83
v_mfma_f32_16x16x32_bf16 v[172:175], a[12:15], v[36:39], v[172:175]
v_exp_f32 v80, v80
v_mfma_f32_16x16x32_bf16 v[204:207], a[12:15], v[40:43], v[204:207]
v_exp_f32 v81, v81
v_mfma_f32_16x16x32_bf16 v[236:239], a[12:15], v[44:47], v[236:239]
v_exp_f32 v82, v82
v_mfma_f32_16x16x32_bf16 a[168:171], a[12:15], v[48:51], a[168:171]
v_exp_f32 v83, v83
v_mfma_f32_16x16x32_bf16 a[200:203], a[12:15], v[52:55], a[200:203]
s_waitcnt lgkmcnt(0)
ds_read_b128 a[0:3], v1 offset:0
ds_read_b128 a[4:7], v1 offset:64
v_mfma_f32_16x16x32_bf16 v[144:147], a[16:19], v[32:35], v[144:147]
v_cvt_pk_bf16_f32 v58, v80, v81
v_cvt_pk_bf16_f32 v59, v82, v83
v_mfma_f32_16x16x32_bf16 v[176:179], a[16:19], v[36:39], v[176:179]
v_mul_f32 v84, s31, v84
v_mul_f32 v85, s31, v85
v_mfma_f32_16x16x32_bf16 v[208:211], a[16:19], v[40:43], v[208:211]
ds_read_b128 a[8:11], v1 offset:128
ds_read_b128 a[12:15], v1 offset:192
v_mfma_f32_16x16x32_bf16 v[240:243], a[16:19], v[44:47], v[240:243]
v_mul_f32 v86, s31, v86
v_mul_f32 v87, s31, v87
v_mfma_f32_16x16x32_bf16 a[172:175], a[16:19], v[48:51], a[172:175]
v_exp_f32 v84, v84
v_mfma_f32_16x16x32_bf16 a[204:207], a[16:19], v[52:55], a[204:207]
v_exp_f32 v85, v85
v_mfma_f32_16x16x32_bf16 v[148:151], a[20:23], v[32:35], v[148:151]
v_exp_f32 v86, v86
v_mfma_f32_16x16x32_bf16 v[180:183], a[20:23], v[36:39], v[180:183]
v_exp_f32 v87, v87
v_mfma_f32_16x16x32_bf16 v[212:215], a[20:23], v[40:43], v[212:215]
v_cvt_pk_bf16_f32 v62, v84, v85
v_cvt_pk_bf16_f32 v63, v86, v87
v_mfma_f32_16x16x32_bf16 v[244:247], a[20:23], v[44:47], v[244:247]
v_mul_f32 v88, s31, v88
v_mul_f32 v89, s31, v89
v_mfma_f32_16x16x32_bf16 a[176:179], a[20:23], v[48:51], a[176:179]
v_mul_f32 v90, s31, v90
v_mul_f32 v91, s31, v91
v_mfma_f32_16x16x32_bf16 a[208:211], a[20:23], v[52:55], a[208:211]
v_exp_f32 v88, v88
v_mfma_f32_16x16x32_bf16 v[152:155], a[24:27], v[32:35], v[152:155]
v_exp_f32 v89, v89
v_mfma_f32_16x16x32_bf16 v[184:187], a[24:27], v[36:39], v[184:187]
v_exp_f32 v90, v90
v_mfma_f32_16x16x32_bf16 v[216:219], a[24:27], v[40:43], v[216:219]
v_exp_f32 v91, v91
v_mfma_f32_16x16x32_bf16 v[248:251], a[24:27], v[44:47], v[248:251]
v_cvt_pk_bf16_f32 v66, v88, v89
v_cvt_pk_bf16_f32 v67, v90, v91
v_mfma_f32_16x16x32_bf16 a[180:183], a[24:27], v[48:51], a[180:183]
v_mul_f32 v92, s31, v92
v_mul_f32 v93, s31, v93
v_mfma_f32_16x16x32_bf16 a[212:215], a[24:27], v[52:55], a[212:215]
v_mul_f32 v94, s31, v94
v_mul_f32 v95, s31, v95
v_mfma_f32_16x16x32_bf16 v[156:159], a[28:31], v[32:35], v[156:159]
v_exp_f32 v92, v92
v_mfma_f32_16x16x32_bf16 v[188:191], a[28:31], v[36:39], v[188:191]
v_exp_f32 v93, v93
v_mfma_f32_16x16x32_bf16 v[220:223], a[28:31], v[40:43], v[220:223]
v_exp_f32 v94, v94
v_mfma_f32_16x16x32_bf16 v[252:255], a[28:31], v[44:47], v[252:255]
v_exp_f32 v95, v95
v_mfma_f32_16x16x32_bf16 a[184:187], a[28:31], v[48:51], a[184:187]
v_cvt_pk_bf16_f32 v70, v92, v93
v_cvt_pk_bf16_f32 v71, v94, v95
v_mfma_f32_16x16x32_bf16 a[216:219], a[28:31], v[52:55], a[216:219]
s_waitcnt lgkmcnt(0)
ds_read_b128 a[16:19], v1 offset:4352
ds_read_b128 a[20:23], v1 offset:4416
v_mfma_f32_16x16x32_bf16 v[32:35], a[0:3], a[32:35], v[104:107]
v_mul_f32 v96, s31, v96
v_mul_f32 v97, s31, v97
v_mfma_f32_16x16x32_bf16 v[32:35], a[4:7], a[36:39], v[32:35]
v_mul_f32 v98, s31, v98
v_mul_f32 v99, s31, v99
v_mfma_f32_16x16x32_bf16 v[32:35], a[8:11], a[40:43], v[32:35]
ds_read_b128 a[24:27], v1 offset:4480
ds_read_b128 a[28:31], v1 offset:4544
v_mfma_f32_16x16x32_bf16 v[32:35], a[12:15], a[44:47], v[32:35]
v_exp_f32 v96, v96
v_mfma_f32_16x16x32_bf16 v[36:39], a[0:3], a[48:51], v[108:111]
v_exp_f32 v97, v97
v_mfma_f32_16x16x32_bf16 v[36:39], a[4:7], a[52:55], v[36:39]
v_exp_f32 v98, v98
v_mfma_f32_16x16x32_bf16 v[36:39], a[8:11], a[56:59], v[36:39]
v_exp_f32 v99, v99
v_mfma_f32_16x16x32_bf16 v[36:39], a[12:15], a[60:63], v[36:39]
v_cvt_pk_bf16_f32 v74, v96, v97
v_cvt_pk_bf16_f32 v75, v98, v99
v_mfma_f32_16x16x32_bf16 v[40:43], a[0:3], a[64:67], v[112:115]
v_mul_f32 v100, s31, v100
v_mul_f32 v101, s31, v101
v_mfma_f32_16x16x32_bf16 v[40:43], a[4:7], a[68:71], v[40:43]
v_mul_f32 v102, s31, v102
v_mul_f32 v103, s31, v103
v_mfma_f32_16x16x32_bf16 v[40:43], a[8:11], a[72:75], v[40:43]
v_exp_f32 v100, v100
v_mfma_f32_16x16x32_bf16 v[40:43], a[12:15], a[76:79], v[40:43]
v_exp_f32 v101, v101
s_waitcnt vmcnt(14)
s_barrier
v_mfma_f32_16x16x32_bf16 v[44:47], a[0:3], a[80:83], v[116:119]
v_exp_f32 v102, v102
v_mfma_f32_16x16x32_bf16 v[44:47], a[4:7], a[84:87], v[44:47]
s_add_u32 m0, s37, 26112
s_add_u32 s40, s32, 57344
buffer_load_dwordx4 v6, s[16:19], s40 offen nt lds
v_mfma_f32_16x16x32_bf16 v[44:47], a[8:11], a[88:91], v[44:47]
v_exp_f32 v103, v103
v_mfma_f32_16x16x32_bf16 v[44:47], a[12:15], a[92:95], v[44:47]
v_cvt_pk_bf16_f32 v78, v100, v101
v_cvt_pk_bf16_f32 v79, v102, v103
v_mfma_f32_16x16x32_bf16 v[48:51], a[0:3], a[96:99], v[120:123]
s_add_u32 m0, s37, 26176
s_nop 0
buffer_load_dwordx4 v6, s[16:19], s40 offen offset:1024 nt lds
v_mfma_f32_16x16x32_bf16 v[48:51], a[4:7], a[100:103], v[48:51]
v_xor_b32 v12, 64, v6
v_xor_b32 v13, 128, v6
v_mfma_f32_16x16x32_bf16 v[48:51], a[8:11], a[104:107], v[48:51]
v_xor_b32 v28, 192, v6
v_mul_f32 v32, s31, v32
v_mfma_f32_16x16x32_bf16 v[48:51], a[12:15], a[108:111], v[48:51]
v_mul_f32 v33, s31, v33
v_mul_f32 v34, s31, v34
v_mfma_f32_16x16x32_bf16 v[52:55], a[0:3], a[112:115], v[124:127]
v_mul_f32 v35, s31, v35
v_mul_f32 v36, s31, v36
v_mfma_f32_16x16x32_bf16 v[52:55], a[4:7], a[116:119], v[52:55]
v_exp_f32 v32, v32
v_mfma_f32_16x16x32_bf16 v[52:55], a[8:11], a[120:123], v[52:55]
v_exp_f32 v33, v33
v_mfma_f32_16x16x32_bf16 v[52:55], a[12:15], a[124:127], v[52:55]
s_waitcnt lgkmcnt(0)
ds_read_b64_tr_b16 a[0:1], v2 offset:24768
ds_read_b64_tr_b16 a[2:3], v2 offset:28896
v_mfma_f32_16x16x32_bf16 v[80:83], a[16:19], a[32:35], v[104:107]
v_exp_f32 v34, v34
v_mfma_f32_16x16x32_bf16 v[80:83], a[20:23], a[36:39], v[80:83]
v_exp_f32 v35, v35
v_mfma_f32_16x16x32_bf16 v[80:83], a[24:27], a[40:43], v[80:83]
ds_read_b64_tr_b16 a[4:5], v2 offset:24776
ds_read_b64_tr_b16 a[6:7], v2 offset:28904
v_mfma_f32_16x16x32_bf16 v[80:83], a[28:31], a[44:47], v[80:83]
v_cvt_pk_bf16_f32 v32, v32, v33
v_cvt_pk_bf16_f32 v33, v34, v35
v_mfma_f32_16x16x32_bf16 v[84:87], a[16:19], a[48:51], v[108:111]
v_mul_f32 v37, s31, v37
v_mul_f32 v38, s31, v38
v_mfma_f32_16x16x32_bf16 v[84:87], a[20:23], a[52:55], v[84:87]
ds_read_b64_tr_b16 a[8:9], v3 offset:24768
ds_read_b64_tr_b16 a[10:11], v3 offset:28896
v_mfma_f32_16x16x32_bf16 v[84:87], a[24:27], a[56:59], v[84:87]
v_mul_f32 v39, s31, v39
v_mul_f32 v40, s31, v40
v_mfma_f32_16x16x32_bf16 v[84:87], a[28:31], a[60:63], v[84:87]
v_exp_f32 v36, v36
v_mfma_f32_16x16x32_bf16 v[88:91], a[16:19], a[64:67], v[112:115]
ds_read_b64_tr_b16 a[12:13], v3 offset:24776
ds_read_b64_tr_b16 a[14:15], v3 offset:28904
v_mfma_f32_16x16x32_bf16 v[88:91], a[20:23], a[68:71], v[88:91]
v_exp_f32 v37, v37
v_mfma_f32_16x16x32_bf16 v[88:91], a[24:27], a[72:75], v[88:91]
v_exp_f32 v38, v38
v_mfma_f32_16x16x32_bf16 v[88:91], a[28:31], a[76:79], v[88:91]
s_add_u32 m0, s38, 16512
s_add_u32 s40, s32, 49152
buffer_load_dwordx4 v7, s[20:23], s40 offen nt lds
v_mfma_f32_16x16x32_bf16 v[92:95], a[16:19], a[80:83], v[116:119]
v_exp_f32 v39, v39
v_mfma_f32_16x16x32_bf16 v[92:95], a[20:23], a[84:87], v[92:95]
v_cvt_pk_bf16_f32 v36, v36, v37
v_cvt_pk_bf16_f32 v37, v38, v39
v_mfma_f32_16x16x32_bf16 v[92:95], a[24:27], a[88:91], v[92:95]
s_add_u32 m0, s38, 16520
s_nop 0
buffer_load_dwordx4 v7, s[20:23], s40 offen offset:1024 nt lds
v_mfma_f32_16x16x32_bf16 v[92:95], a[28:31], a[92:95], v[92:95]
v_mul_f32 v41, s31, v41
v_mul_f32 v42, s31, v42
v_mfma_f32_16x16x32_bf16 v[96:99], a[16:19], a[96:99], v[120:123]
v_mul_f32 v43, s31, v43
v_mul_f32 v44, s31, v44
v_mfma_f32_16x16x32_bf16 v[96:99], a[20:23], a[100:103], v[96:99]
v_exp_f32 v40, v40
v_mfma_f32_16x16x32_bf16 v[96:99], a[24:27], a[104:107], v[96:99]
v_exp_f32 v41, v41
v_mfma_f32_16x16x32_bf16 v[96:99], a[28:31], a[108:111], v[96:99]
v_exp_f32 v42, v42
v_mfma_f32_16x16x32_bf16 v[100:103], a[16:19], a[112:115], v[124:127]
v_exp_f32 v43, v43
v_mfma_f32_16x16x32_bf16 v[100:103], a[20:23], a[116:119], v[100:103]
v_cvt_pk_bf16_f32 v40, v40, v41
v_cvt_pk_bf16_f32 v41, v42, v43
v_mfma_f32_16x16x32_bf16 v[100:103], a[24:27], a[120:123], v[100:103]
v_mul_f32 v45, s31, v45
v_mul_f32 v46, s31, v46
v_mfma_f32_16x16x32_bf16 v[100:103], a[28:31], a[124:127], v[100:103]
s_waitcnt lgkmcnt(0)
ds_read_b64_tr_b16 a[16:17], v4 offset:24768
ds_read_b64_tr_b16 a[18:19], v4 offset:28896
v_mfma_f32_16x16x32_bf16 a[132:135], a[128:131], v[56:59], a[132:135]
v_mul_f32 v47, s31, v47
v_mul_f32 v48, s31, v48
v_mfma_f32_16x16x32_bf16 a[136:139], a[128:131], v[60:63], a[136:139]
v_exp_f32 v44, v44
v_mfma_f32_16x16x32_bf16 a[140:143], a[128:131], v[64:67], a[140:143]
ds_read_b64_tr_b16 a[20:21], v4 offset:24776
ds_read_b64_tr_b16 a[22:23], v4 offset:28904
v_mfma_f32_16x16x32_bf16 a[144:147], a[128:131], v[68:71], a[144:147]
v_exp_f32 v45, v45
v_mfma_f32_16x16x32_bf16 a[148:151], a[128:131], v[72:75], a[148:151]
v_exp_f32 v46, v46
v_mfma_f32_16x16x32_bf16 a[152:155], a[128:131], v[76:79], a[152:155]
v_exp_f32 v47, v47
v_mfma_f32_16x16x32_bf16 v[128:131], a[0:3], v[56:59], v[128:131]
v_cvt_pk_bf16_f32 v44, v44, v45
v_cvt_pk_bf16_f32 v45, v46, v47
v_mfma_f32_16x16x32_bf16 v[160:163], a[0:3], v[60:63], v[160:163]
ds_read_b64_tr_b16 a[24:25], v5 offset:24768
ds_read_b64_tr_b16 a[26:27], v5 offset:28896
v_mfma_f32_16x16x32_bf16 v[192:195], a[0:3], v[64:67], v[192:195]
v_mul_f32 v49, s31, v49
v_mul_f32 v50, s31, v50
v_mfma_f32_16x16x32_bf16 v[224:227], a[0:3], v[68:71], v[224:227]
v_mul_f32 v51, s31, v51
v_mul_f32 v52, s31, v52
v_mfma_f32_16x16x32_bf16 a[156:159], a[0:3], v[72:75], a[156:159]
ds_read_b64_tr_b16 a[28:29], v5 offset:24776
ds_read_b64_tr_b16 a[30:31], v5 offset:28904
v_mfma_f32_16x16x32_bf16 a[188:191], a[0:3], v[76:79], a[188:191]
v_exp_f32 v48, v48
v_mfma_f32_16x16x32_bf16 v[132:135], a[4:7], v[56:59], v[132:135]
v_exp_f32 v49, v49
v_mfma_f32_16x16x32_bf16 v[164:167], a[4:7], v[60:63], v[164:167]
v_exp_f32 v50, v50
v_mfma_f32_16x16x32_bf16 v[196:199], a[4:7], v[64:67], v[196:199]
v_exp_f32 v51, v51
v_mfma_f32_16x16x32_bf16 v[228:231], a[4:7], v[68:71], v[228:231]
s_add_u32 m0, s39, 0
s_add_u32 s41, s34, 0
buffer_load_dwordx4 v6, s[12:15], s41 offen offset:0 nt lds
buffer_load_dwordx4 v12, s[12:15], s41 offen offset:1024 nt lds
buffer_load_dwordx4 v13, s[12:15], s41 offen offset:2048 nt lds
buffer_load_dwordx4 v28, s[12:15], s41 offen offset:3072 nt lds
v_mfma_f32_16x16x32_bf16 a[160:163], a[4:7], v[72:75], a[160:163]
v_cvt_pk_bf16_f32 v48, v48, v49
v_cvt_pk_bf16_f32 v49, v50, v51
v_mfma_f32_16x16x32_bf16 a[192:195], a[4:7], v[76:79], a[192:195]
v_mul_f32 v53, s31, v53
v_mul_f32 v54, s31, v54
v_mfma_f32_16x16x32_bf16 v[136:139], a[8:11], v[56:59], v[136:139]
v_mul_f32 v55, s31, v55
v_mul_f32 v80, s31, v80
v_mfma_f32_16x16x32_bf16 v[168:171], a[8:11], v[60:63], v[168:171]
v_exp_f32 v52, v52
v_mfma_f32_16x16x32_bf16 v[200:203], a[8:11], v[64:67], v[200:203]
v_exp_f32 v53, v53
v_mfma_f32_16x16x32_bf16 v[232:235], a[8:11], v[68:71], v[232:235]
v_exp_f32 v54, v54
v_mfma_f32_16x16x32_bf16 a[164:167], a[8:11], v[72:75], a[164:167]
v_exp_f32 v55, v55
v_mfma_f32_16x16x32_bf16 a[196:199], a[8:11], v[76:79], a[196:199]
v_cvt_pk_bf16_f32 v52, v52, v53
v_cvt_pk_bf16_f32 v53, v54, v55
v_mfma_f32_16x16x32_bf16 v[140:143], a[12:15], v[56:59], v[140:143]
v_mul_f32 v81, s31, v81
v_mul_f32 v82, s31, v82
v_mfma_f32_16x16x32_bf16 v[172:175], a[12:15], v[60:63], v[172:175]
v_mul_f32 v83, s31, v83
v_mul_f32 v84, s31, v84
v_mfma_f32_16x16x32_bf16 v[204:207], a[12:15], v[64:67], v[204:207]
v_exp_f32 v80, v80
v_mfma_f32_16x16x32_bf16 v[236:239], a[12:15], v[68:71], v[236:239]
v_exp_f32 v81, v81
v_mfma_f32_16x16x32_bf16 a[168:171], a[12:15], v[72:75], a[168:171]
v_exp_f32 v82, v82
v_mfma_f32_16x16x32_bf16 a[200:203], a[12:15], v[76:79], a[200:203]
s_waitcnt lgkmcnt(0)
ds_read_b128 a[0:3], v1 offset:8704
ds_read_b128 a[4:7], v1 offset:8768
v_mfma_f32_16x16x32_bf16 v[144:147], a[16:19], v[56:59], v[144:147]
v_exp_f32 v83, v83
v_mfma_f32_16x16x32_bf16 v[176:179], a[16:19], v[60:63], v[176:179]
v_cvt_pk_bf16_f32 v34, v80, v81
v_cvt_pk_bf16_f32 v35, v82, v83
v_mfma_f32_16x16x32_bf16 v[208:211], a[16:19], v[64:67], v[208:211]
ds_read_b128 a[8:11], v1 offset:8832
ds_read_b128 a[12:15], v1 offset:8896
v_mfma_f32_16x16x32_bf16 v[240:243], a[16:19], v[68:71], v[240:243]
v_mul_f32 v85, s31, v85
v_mul_f32 v86, s31, v86
v_mfma_f32_16x16x32_bf16 a[172:175], a[16:19], v[72:75], a[172:175]
v_mul_f32 v87, s31, v87
v_mul_f32 v88, s31, v88
v_mfma_f32_16x16x32_bf16 a[204:207], a[16:19], v[76:79], a[204:207]
v_exp_f32 v84, v84
v_mfma_f32_16x16x32_bf16 v[148:151], a[20:23], v[56:59], v[148:151]
v_exp_f32 v85, v85
v_mfma_f32_16x16x32_bf16 v[180:183], a[20:23], v[60:63], v[180:183]
v_exp_f32 v86, v86
v_mfma_f32_16x16x32_bf16 v[212:215], a[20:23], v[64:67], v[212:215]
v_exp_f32 v87, v87
v_mfma_f32_16x16x32_bf16 v[244:247], a[20:23], v[68:71], v[244:247]
v_cvt_pk_bf16_f32 v38, v84, v85
v_cvt_pk_bf16_f32 v39, v86, v87
v_mfma_f32_16x16x32_bf16 a[176:179], a[20:23], v[72:75], a[176:179]
v_mul_f32 v89, s31, v89
v_mul_f32 v90, s31, v90
v_mfma_f32_16x16x32_bf16 a[208:211], a[20:23], v[76:79], a[208:211]
v_mul_f32 v91, s31, v91
v_mul_f32 v92, s31, v92
v_mfma_f32_16x16x32_bf16 v[152:155], a[24:27], v[56:59], v[152:155]
v_exp_f32 v88, v88
v_mfma_f32_16x16x32_bf16 v[184:187], a[24:27], v[60:63], v[184:187]
v_exp_f32 v89, v89
v_mfma_f32_16x16x32_bf16 v[216:219], a[24:27], v[64:67], v[216:219]
v_exp_f32 v90, v90
v_mfma_f32_16x16x32_bf16 v[248:251], a[24:27], v[68:71], v[248:251]
v_exp_f32 v91, v91
v_mfma_f32_16x16x32_bf16 a[180:183], a[24:27], v[72:75], a[180:183]
v_cvt_pk_bf16_f32 v42, v88, v89
v_cvt_pk_bf16_f32 v43, v90, v91
v_mfma_f32_16x16x32_bf16 a[212:215], a[24:27], v[76:79], a[212:215]
v_mul_f32 v93, s31, v93
v_mul_f32 v94, s31, v94
v_mfma_f32_16x16x32_bf16 v[156:159], a[28:31], v[56:59], v[156:159]
v_mul_f32 v95, s31, v95
v_mfma_f32_16x16x32_bf16 v[188:191], a[28:31], v[60:63], v[188:191]
v_exp_f32 v92, v92
v_mfma_f32_16x16x32_bf16 v[220:223], a[28:31], v[64:67], v[220:223]
v_exp_f32 v93, v93
v_mfma_f32_16x16x32_bf16 v[252:255], a[28:31], v[68:71], v[252:255]
v_exp_f32 v94, v94
v_mfma_f32_16x16x32_bf16 a[184:187], a[28:31], v[72:75], a[184:187]
v_exp_f32 v95, v95
v_mfma_f32_16x16x32_bf16 a[216:219], a[28:31], v[76:79], a[216:219]
v_cvt_pk_bf16_f32 v46, v92, v93
v_cvt_pk_bf16_f32 v47, v94, v95
s_waitcnt lgkmcnt(0)
ds_read_b128 a[16:19], v1 offset:13056
ds_read_b128 a[20:23], v1 offset:13120
v_mfma_f32_16x16x32_bf16 v[56:59], a[0:3], a[32:35], v[104:107]
v_mul_f32 v96, s31, v96
v_mul_f32 v97, s31, v97
v_mfma_f32_16x16x32_bf16 v[56:59], a[4:7], a[36:39], v[56:59]
v_mul_f32 v98, s31, v98
v_mul_f32 v99, s31, v99
v_mfma_f32_16x16x32_bf16 v[56:59], a[8:11], a[40:43], v[56:59]
ds_read_b128 a[24:27], v1 offset:13184
ds_read_b128 a[28:31], v1 offset:13248
v_mfma_f32_16x16x32_bf16 v[56:59], a[12:15], a[44:47], v[56:59]
v_exp_f32 v96, v96
v_mfma_f32_16x16x32_bf16 v[60:63], a[0:3], a[48:51], v[108:111]
v_exp_f32 v97, v97
v_mfma_f32_16x16x32_bf16 v[60:63], a[4:7], a[52:55], v[60:63]
v_exp_f32 v98, v98
v_mfma_f32_16x16x32_bf16 v[60:63], a[8:11], a[56:59], v[60:63]
ds_read_b128 v[20:23], v0 offset:8192
ds_read_b128 v[24:27], v0 offset:9216
ds_read_b128 v[28:31], v0 offset:10240
v_mfma_f32_16x16x32_bf16 v[60:63], a[12:15], a[60:63], v[60:63]
v_exp_f32 v99, v99
v_mfma_f32_16x16x32_bf16 v[64:67], a[0:3], a[64:67], v[112:115]
v_cvt_pk_bf16_f32 v50, v96, v97
v_cvt_pk_bf16_f32 v51, v98, v99
v_mfma_f32_16x16x32_bf16 v[64:67], a[4:7], a[68:71], v[64:67]
v_mul_f32 v100, s31, v100
v_mul_f32 v101, s31, v101
v_mfma_f32_16x16x32_bf16 v[64:67], a[8:11], a[72:75], v[64:67]
v_mul_f32 v102, s31, v102
v_mul_f32 v103, s31, v103
v_mfma_f32_16x16x32_bf16 v[64:67], a[12:15], a[76:79], v[64:67]
v_exp_f32 v100, v100
s_waitcnt vmcnt(14)
s_barrier
v_mfma_f32_16x16x32_bf16 v[68:71], a[0:3], a[80:83], v[116:119]
v_exp_f32 v101, v101
v_mfma_f32_16x16x32_bf16 v[68:71], a[4:7], a[84:87], v[68:71]
s_add_u32 m0, s37, 0
s_add_u32 s40, s32, 65536
buffer_load_dwordx4 v6, s[16:19], s40 offen nt lds
v_mfma_f32_16x16x32_bf16 v[68:71], a[8:11], a[88:91], v[68:71]
v_exp_f32 v102, v102
v_mfma_f32_16x16x32_bf16 v[68:71], a[12:15], a[92:95], v[68:71]
v_exp_f32 v103, v103
v_mfma_f32_16x16x32_bf16 v[72:75], a[0:3], a[96:99], v[120:123]
s_add_u32 m0, s37, 64
s_nop 0
buffer_load_dwordx4 v6, s[16:19], s40 offen offset:1024 nt lds
v_mfma_f32_16x16x32_bf16 v[72:75], a[4:7], a[100:103], v[72:75]
v_cvt_pk_bf16_f32 v54, v100, v101
v_cvt_pk_bf16_f32 v55, v102, v103
v_mfma_f32_16x16x32_bf16 v[72:75], a[8:11], a[104:107], v[72:75]
v_mul_f32 v56, s31, v56
v_mul_f32 v57, s31, v57
v_mfma_f32_16x16x32_bf16 v[72:75], a[12:15], a[108:111], v[72:75]
v_mul_f32 v58, s31, v58
v_mul_f32 v59, s31, v59
v_mfma_f32_16x16x32_bf16 v[76:79], a[0:3], a[112:115], v[124:127]
v_exp_f32 v56, v56
v_mfma_f32_16x16x32_bf16 v[76:79], a[4:7], a[116:119], v[76:79]
v_exp_f32 v57, v57
v_mfma_f32_16x16x32_bf16 v[76:79], a[8:11], a[120:123], v[76:79]
v_exp_f32 v58, v58
v_mfma_f32_16x16x32_bf16 v[76:79], a[12:15], a[124:127], v[76:79]
s_waitcnt lgkmcnt(3)
s_add_u32 s36, s45, 8192
s_waitcnt lgkmcnt(2)
buffer_store_dwordx4 v[20:23], v6, s[24:27], s36 offen offset:0
ds_read_b64_tr_b16 a[0:1], v2 offset:0
ds_read_b64_tr_b16 a[2:3], v2 offset:4128
v_mfma_f32_16x16x32_bf16 v[80:83], a[16:19], a[32:35], v[104:107]
v_exp_f32 v59, v59
v_mfma_f32_16x16x32_bf16 v[80:83], a[20:23], a[36:39], v[80:83]
v_cvt_pk_bf16_f32 v56, v56, v57
v_cvt_pk_bf16_f32 v57, v58, v59
v_mfma_f32_16x16x32_bf16 v[80:83], a[24:27], a[40:43], v[80:83]
ds_read_b64_tr_b16 a[4:5], v2 offset:8
ds_read_b64_tr_b16 a[6:7], v2 offset:4136
v_mfma_f32_16x16x32_bf16 v[80:83], a[28:31], a[44:47], v[80:83]
v_mul_f32 v60, s31, v60
v_mul_f32 v61, s31, v61
v_mfma_f32_16x16x32_bf16 v[84:87], a[16:19], a[48:51], v[108:111]
v_mul_f32 v62, s31, v62
v_mul_f32 v63, s31, v63
v_mfma_f32_16x16x32_bf16 v[84:87], a[20:23], a[52:55], v[84:87]
v_mfma_f32_16x16x32_bf16 v[84:87], a[24:27], a[56:59], v[84:87]
v_exp_f32 v60, v60
v_mfma_f32_16x16x32_bf16 v[84:87], a[28:31], a[60:63], v[84:87]
s_add_u32 s36, s45, 8192
s_waitcnt lgkmcnt(5)
buffer_store_dwordx4 v[24:27], v6, s[24:27], s36 offen offset:1024
ds_read_b64_tr_b16 a[8:9], v3 offset:0
ds_read_b64_tr_b16 a[10:11], v3 offset:4128
v_mfma_f32_16x16x32_bf16 v[88:91], a[16:19], a[64:67], v[112:115]
ds_read_b64_tr_b16 a[12:13], v3 offset:8
ds_read_b64_tr_b16 a[14:15], v3 offset:4136
v_mfma_f32_16x16x32_bf16 v[88:91], a[20:23], a[68:71], v[88:91]
v_exp_f32 v61, v61
v_mfma_f32_16x16x32_bf16 v[88:91], a[24:27], a[72:75], v[88:91]
v_exp_f32 v62, v62
v_mfma_f32_16x16x32_bf16 v[88:91], a[28:31], a[76:79], v[88:91]
s_add_u32 m0, s38, 24768
s_add_u32 s40, s32, 57344
buffer_load_dwordx4 v7, s[20:23], s40 offen nt lds
ds_read_b128 v[20:23], v0 offset:11264
v_mfma_f32_16x16x32_bf16 v[92:95], a[16:19], a[80:83], v[116:119]
v_exp_f32 v63, v63
v_mfma_f32_16x16x32_bf16 v[92:95], a[20:23], a[84:87], v[92:95]
v_cvt_pk_bf16_f32 v60, v60, v61
v_cvt_pk_bf16_f32 v61, v62, v63
v_mfma_f32_16x16x32_bf16 v[92:95], a[24:27], a[88:91], v[92:95]
s_add_u32 m0, s38, 24776
s_nop 0
buffer_load_dwordx4 v7, s[20:23], s40 offen offset:1024 nt lds
v_mfma_f32_16x16x32_bf16 v[92:95], a[28:31], a[92:95], v[92:95]
v_mul_f32 v64, s31, v64
v_mul_f32 v65, s31, v65
v_mfma_f32_16x16x32_bf16 v[96:99], a[16:19], a[96:99], v[120:123]
v_mul_f32 v66, s31, v66
v_mul_f32 v67, s31, v67
v_mfma_f32_16x16x32_bf16 v[96:99], a[20:23], a[100:103], v[96:99]
v_exp_f32 v64, v64
v_mfma_f32_16x16x32_bf16 v[96:99], a[24:27], a[104:107], v[96:99]
v_exp_f32 v65, v65
v_mfma_f32_16x16x32_bf16 v[96:99], a[28:31], a[108:111], v[96:99]
v_exp_f32 v66, v66
v_mfma_f32_16x16x32_bf16 v[100:103], a[16:19], a[112:115], v[124:127]
v_exp_f32 v67, v67
v_mfma_f32_16x16x32_bf16 v[100:103], a[20:23], a[116:119], v[100:103]
v_cvt_pk_bf16_f32 v64, v64, v65
v_cvt_pk_bf16_f32 v65, v66, v67
v_mfma_f32_16x16x32_bf16 v[100:103], a[24:27], a[120:123], v[100:103]
v_mul_f32 v68, s31, v68
v_mul_f32 v69, s31, v69
v_mfma_f32_16x16x32_bf16 v[100:103], a[28:31], a[124:127], v[100:103]
s_waitcnt lgkmcnt(1)
s_add_u32 s36, s45, 8192
buffer_store_dwordx4 v[28:31], v6, s[24:27], s36 offen offset:2048
ds_read_b64_tr_b16 a[16:17], v4 offset:0
ds_read_b64_tr_b16 a[18:19], v4 offset:4128
v_mfma_f32_16x16x32_bf16 a[132:135], a[128:131], v[32:35], a[132:135]
v_mul_f32 v70, s31, v70
v_mul_f32 v71, s31, v71
v_mfma_f32_16x16x32_bf16 a[136:139], a[128:131], v[36:39], a[136:139]
v_exp_f32 v68, v68
v_mfma_f32_16x16x32_bf16 a[140:143], a[128:131], v[40:43], a[140:143]
ds_read_b64_tr_b16 a[20:21], v4 offset:8
ds_read_b64_tr_b16 a[22:23], v4 offset:4136
v_mfma_f32_16x16x32_bf16 a[144:147], a[128:131], v[44:47], a[144:147]
v_exp_f32 v69, v69
v_mfma_f32_16x16x32_bf16 a[148:151], a[128:131], v[48:51], a[148:151]
v_exp_f32 v70, v70
v_mfma_f32_16x16x32_bf16 a[152:155], a[128:131], v[52:55], a[152:155]
v_exp_f32 v71, v71
v_mfma_f32_16x16x32_bf16 v[128:131], a[0:3], v[32:35], v[128:131]
v_cvt_pk_bf16_f32 v68, v68, v69
v_cvt_pk_bf16_f32 v69, v70, v71
v_mfma_f32_16x16x32_bf16 v[160:163], a[0:3], v[36:39], v[160:163]
s_add_u32 s36, s45, 8192
s_waitcnt lgkmcnt(4)
buffer_store_dwordx4 v[20:23], v6, s[24:27], s36 offen offset:3072
ds_read_b64_tr_b16 a[24:25], v5 offset:0
ds_read_b64_tr_b16 a[26:27], v5 offset:4128
v_mfma_f32_16x16x32_bf16 v[192:195], a[0:3], v[40:43], v[192:195]
v_mul_f32 v72, s31, v72
v_mul_f32 v73, s31, v73
v_mfma_f32_16x16x32_bf16 v[224:227], a[0:3], v[44:47], v[224:227]
v_mul_f32 v74, s31, v74
v_mul_f32 v75, s31, v75
v_mfma_f32_16x16x32_bf16 a[156:159], a[0:3], v[48:51], a[156:159]
ds_read_b64_tr_b16 a[28:29], v5 offset:8
ds_read_b64_tr_b16 a[30:31], v5 offset:4136
v_mfma_f32_16x16x32_bf16 a[188:191], a[0:3], v[52:55], a[188:191]
v_exp_f32 v72, v72
v_mfma_f32_16x16x32_bf16 v[132:135], a[4:7], v[32:35], v[132:135]
v_exp_f32 v73, v73
v_mfma_f32_16x16x32_bf16 v[164:167], a[4:7], v[36:39], v[164:167]
v_exp_f32 v74, v74
v_mfma_f32_16x16x32_bf16 v[196:199], a[4:7], v[40:43], v[196:199]
v_exp_f32 v75, v75
v_mfma_f32_16x16x32_bf16 v[228:231], a[4:7], v[44:47], v[228:231]
v_cvt_pk_bf16_f32 v72, v72, v73
v_cvt_pk_bf16_f32 v73, v74, v75
v_mfma_f32_16x16x32_bf16 a[160:163], a[4:7], v[48:51], a[160:163]
v_mul_f32 v76, s31, v76
v_mul_f32 v77, s31, v77
v_mfma_f32_16x16x32_bf16 a[192:195], a[4:7], v[52:55], a[192:195]
v_mul_f32 v78, s31, v78
v_mul_f32 v79, s31, v79
v_mfma_f32_16x16x32_bf16 v[136:139], a[8:11], v[32:35], v[136:139]
v_exp_f32 v76, v76
v_mfma_f32_16x16x32_bf16 v[168:171], a[8:11], v[36:39], v[168:171]
v_exp_f32 v77, v77
v_mfma_f32_16x16x32_bf16 v[200:203], a[8:11], v[40:43], v[200:203]
v_exp_f32 v78, v78
v_mfma_f32_16x16x32_bf16 v[232:235], a[8:11], v[44:47], v[232:235]
v_exp_f32 v79, v79
v_mfma_f32_16x16x32_bf16 a[164:167], a[8:11], v[48:51], a[164:167]
v_cvt_pk_bf16_f32 v76, v76, v77
v_cvt_pk_bf16_f32 v77, v78, v79
v_mfma_f32_16x16x32_bf16 a[196:199], a[8:11], v[52:55], a[196:199]
v_mul_f32 v80, s31, v80
v_mul_f32 v81, s31, v81
v_mfma_f32_16x16x32_bf16 v[140:143], a[12:15], v[32:35], v[140:143]
v_mul_f32 v82, s31, v82
v_mul_f32 v83, s31, v83
v_mfma_f32_16x16x32_bf16 v[172:175], a[12:15], v[36:39], v[172:175]
v_exp_f32 v80, v80
v_mfma_f32_16x16x32_bf16 v[204:207], a[12:15], v[40:43], v[204:207]
v_exp_f32 v81, v81
v_mfma_f32_16x16x32_bf16 v[236:239], a[12:15], v[44:47], v[236:239]
v_exp_f32 v82, v82
v_mfma_f32_16x16x32_bf16 a[168:171], a[12:15], v[48:51], a[168:171]
v_exp_f32 v83, v83
v_mfma_f32_16x16x32_bf16 a[200:203], a[12:15], v[52:55], a[200:203]
s_waitcnt lgkmcnt(0)
ds_read_b128 a[0:3], v1 offset:17408
ds_read_b128 a[4:7], v1 offset:17472
v_mfma_f32_16x16x32_bf16 v[144:147], a[16:19], v[32:35], v[144:147]
v_cvt_pk_bf16_f32 v58, v80, v81
v_cvt_pk_bf16_f32 v59, v82, v83
v_mfma_f32_16x16x32_bf16 v[176:179], a[16:19], v[36:39], v[176:179]
v_mul_f32 v84, s31, v84
v_mul_f32 v85, s31, v85
v_mfma_f32_16x16x32_bf16 v[208:211], a[16:19], v[40:43], v[208:211]
ds_read_b128 a[8:11], v1 offset:17536
ds_read_b128 a[12:15], v1 offset:17600
v_mfma_f32_16x16x32_bf16 v[240:243], a[16:19], v[44:47], v[240:243]
v_mul_f32 v86, s31, v86
v_mul_f32 v87, s31, v87
v_mfma_f32_16x16x32_bf16 a[172:175], a[16:19], v[48:51], a[172:175]
v_exp_f32 v84, v84
v_mfma_f32_16x16x32_bf16 a[204:207], a[16:19], v[52:55], a[204:207]
v_exp_f32 v85, v85
v_mfma_f32_16x16x32_bf16 v[148:151], a[20:23], v[32:35], v[148:151]
v_exp_f32 v86, v86
v_mfma_f32_16x16x32_bf16 v[180:183], a[20:23], v[36:39], v[180:183]
v_exp_f32 v87, v87
v_mfma_f32_16x16x32_bf16 v[212:215], a[20:23], v[40:43], v[212:215]
v_cvt_pk_bf16_f32 v62, v84, v85
v_cvt_pk_bf16_f32 v63, v86, v87
v_mfma_f32_16x16x32_bf16 v[244:247], a[20:23], v[44:47], v[244:247]
v_mul_f32 v88, s31, v88
v_mul_f32 v89, s31, v89
v_mfma_f32_16x16x32_bf16 a[176:179], a[20:23], v[48:51], a[176:179]
v_mul_f32 v90, s31, v90
v_mul_f32 v91, s31, v91
v_mfma_f32_16x16x32_bf16 a[208:211], a[20:23], v[52:55], a[208:211]
v_exp_f32 v88, v88
v_mfma_f32_16x16x32_bf16 v[152:155], a[24:27], v[32:35], v[152:155]
v_exp_f32 v89, v89
v_mfma_f32_16x16x32_bf16 v[184:187], a[24:27], v[36:39], v[184:187]
v_exp_f32 v90, v90
v_mfma_f32_16x16x32_bf16 v[216:219], a[24:27], v[40:43], v[216:219]
v_exp_f32 v91, v91
v_mfma_f32_16x16x32_bf16 v[248:251], a[24:27], v[44:47], v[248:251]
v_cvt_pk_bf16_f32 v66, v88, v89
v_cvt_pk_bf16_f32 v67, v90, v91
v_mfma_f32_16x16x32_bf16 a[180:183], a[24:27], v[48:51], a[180:183]
v_mul_f32 v92, s31, v92
v_mul_f32 v93, s31, v93
v_mfma_f32_16x16x32_bf16 a[212:215], a[24:27], v[52:55], a[212:215]
v_mul_f32 v94, s31, v94
v_mul_f32 v95, s31, v95
v_mfma_f32_16x16x32_bf16 v[156:159], a[28:31], v[32:35], v[156:159]
v_exp_f32 v92, v92
v_mfma_f32_16x16x32_bf16 v[188:191], a[28:31], v[36:39], v[188:191]
v_exp_f32 v93, v93
v_mfma_f32_16x16x32_bf16 v[220:223], a[28:31], v[40:43], v[220:223]
v_exp_f32 v94, v94
v_mfma_f32_16x16x32_bf16 v[252:255], a[28:31], v[44:47], v[252:255]
v_exp_f32 v95, v95
v_mfma_f32_16x16x32_bf16 a[184:187], a[28:31], v[48:51], a[184:187]
v_cvt_pk_bf16_f32 v70, v92, v93
v_cvt_pk_bf16_f32 v71, v94, v95
v_mfma_f32_16x16x32_bf16 a[216:219], a[28:31], v[52:55], a[216:219]
s_waitcnt lgkmcnt(0)
ds_read_b128 a[16:19], v1 offset:21760
ds_read_b128 a[20:23], v1 offset:21824
v_mfma_f32_16x16x32_bf16 v[32:35], a[0:3], a[32:35], v[104:107]
v_mul_f32 v96, s31, v96
v_mul_f32 v97, s31, v97
v_mfma_f32_16x16x32_bf16 v[32:35], a[4:7], a[36:39], v[32:35]
v_mul_f32 v98, s31, v98
v_mul_f32 v99, s31, v99
v_mfma_f32_16x16x32_bf16 v[32:35], a[8:11], a[40:43], v[32:35]
ds_read_b128 a[24:27], v1 offset:21888
ds_read_b128 a[28:31], v1 offset:21952
v_mfma_f32_16x16x32_bf16 v[32:35], a[12:15], a[44:47], v[32:35]
v_exp_f32 v96, v96
v_mfma_f32_16x16x32_bf16 v[36:39], a[0:3], a[48:51], v[108:111]
v_exp_f32 v97, v97
v_mfma_f32_16x16x32_bf16 v[36:39], a[4:7], a[52:55], v[36:39]
v_exp_f32 v98, v98
v_mfma_f32_16x16x32_bf16 v[36:39], a[8:11], a[56:59], v[36:39]
v_exp_f32 v99, v99
v_mfma_f32_16x16x32_bf16 v[36:39], a[12:15], a[60:63], v[36:39]
v_cvt_pk_bf16_f32 v74, v96, v97
v_cvt_pk_bf16_f32 v75, v98, v99
v_mfma_f32_16x16x32_bf16 v[40:43], a[0:3], a[64:67], v[112:115]
v_mul_f32 v100, s31, v100
v_mul_f32 v101, s31, v101
v_mfma_f32_16x16x32_bf16 v[40:43], a[4:7], a[68:71], v[40:43]
v_mul_f32 v102, s31, v102
v_mul_f32 v103, s31, v103
v_mfma_f32_16x16x32_bf16 v[40:43], a[8:11], a[72:75], v[40:43]
v_exp_f32 v100, v100
v_mfma_f32_16x16x32_bf16 v[40:43], a[12:15], a[76:79], v[40:43]
v_exp_f32 v101, v101
s_waitcnt vmcnt(14)
s_barrier
v_mfma_f32_16x16x32_bf16 v[44:47], a[0:3], a[80:83], v[116:119]
v_exp_f32 v102, v102
v_mfma_f32_16x16x32_bf16 v[44:47], a[4:7], a[84:87], v[44:47]
s_add_u32 m0, s37, 8704
s_add_u32 s40, s32, 73728
buffer_load_dwordx4 v6, s[16:19], s40 offen nt lds
v_mfma_f32_16x16x32_bf16 v[44:47], a[8:11], a[88:91], v[44:47]
v_exp_f32 v103, v103
v_mfma_f32_16x16x32_bf16 v[44:47], a[12:15], a[92:95], v[44:47]
v_cvt_pk_bf16_f32 v78, v100, v101
v_cvt_pk_bf16_f32 v79, v102, v103
v_mfma_f32_16x16x32_bf16 v[48:51], a[0:3], a[96:99], v[120:123]
s_add_u32 m0, s37, 8768
s_nop 0
buffer_load_dwordx4 v6, s[16:19], s40 offen offset:1024 nt lds
v_mfma_f32_16x16x32_bf16 v[48:51], a[4:7], a[100:103], v[48:51]
v_xor_b32 v12, 64, v6
v_xor_b32 v13, 128, v6
v_mfma_f32_16x16x32_bf16 v[48:51], a[8:11], a[104:107], v[48:51]
v_xor_b32 v28, 192, v6
v_mul_f32 v32, s31, v32
v_mfma_f32_16x16x32_bf16 v[48:51], a[12:15], a[108:111], v[48:51]
v_mul_f32 v33, s31, v33
v_mul_f32 v34, s31, v34
v_mfma_f32_16x16x32_bf16 v[52:55], a[0:3], a[112:115], v[124:127]
v_mul_f32 v35, s31, v35
v_mul_f32 v36, s31, v36
v_mfma_f32_16x16x32_bf16 v[52:55], a[4:7], a[116:119], v[52:55]
v_exp_f32 v32, v32
v_mfma_f32_16x16x32_bf16 v[52:55], a[8:11], a[120:123], v[52:55]
v_exp_f32 v33, v33
v_mfma_f32_16x16x32_bf16 v[52:55], a[12:15], a[124:127], v[52:55]
s_waitcnt lgkmcnt(0)
ds_read_b64_tr_b16 a[0:1], v2 offset:8256
ds_read_b64_tr_b16 a[2:3], v2 offset:12384
v_mfma_f32_16x16x32_bf16 v[80:83], a[16:19], a[32:35], v[104:107]
v_exp_f32 v34, v34
v_mfma_f32_16x16x32_bf16 v[80:83], a[20:23], a[36:39], v[80:83]
v_exp_f32 v35, v35
v_mfma_f32_16x16x32_bf16 v[80:83], a[24:27], a[40:43], v[80:83]
ds_read_b64_tr_b16 a[4:5], v2 offset:8264
ds_read_b64_tr_b16 a[6:7], v2 offset:12392
v_mfma_f32_16x16x32_bf16 v[80:83], a[28:31], a[44:47], v[80:83]
v_cvt_pk_bf16_f32 v32, v32, v33
v_cvt_pk_bf16_f32 v33, v34, v35
v_mfma_f32_16x16x32_bf16 v[84:87], a[16:19], a[48:51], v[108:111]
v_mul_f32 v37, s31, v37
v_mul_f32 v38, s31, v38
v_mfma_f32_16x16x32_bf16 v[84:87], a[20:23], a[52:55], v[84:87]
ds_read_b64_tr_b16 a[8:9], v3 offset:8256
ds_read_b64_tr_b16 a[10:11], v3 offset:12384
v_mfma_f32_16x16x32_bf16 v[84:87], a[24:27], a[56:59], v[84:87]
v_mul_f32 v39, s31, v39
v_mul_f32 v40, s31, v40
v_mfma_f32_16x16x32_bf16 v[84:87], a[28:31], a[60:63], v[84:87]
v_exp_f32 v36, v36
v_mfma_f32_16x16x32_bf16 v[88:91], a[16:19], a[64:67], v[112:115]
ds_read_b64_tr_b16 a[12:13], v3 offset:8264
ds_read_b64_tr_b16 a[14:15], v3 offset:12392
v_mfma_f32_16x16x32_bf16 v[88:91], a[20:23], a[68:71], v[88:91]
v_exp_f32 v37, v37
v_mfma_f32_16x16x32_bf16 v[88:91], a[24:27], a[72:75], v[88:91]
v_exp_f32 v38, v38
v_mfma_f32_16x16x32_bf16 v[88:91], a[28:31], a[76:79], v[88:91]
s_add_u32 m0, s38, 0
s_add_u32 s40, s32, 65536
buffer_load_dwordx4 v7, s[20:23], s40 offen nt lds
v_mfma_f32_16x16x32_bf16 v[92:95], a[16:19], a[80:83], v[116:119]
v_exp_f32 v39, v39
v_mfma_f32_16x16x32_bf16 v[92:95], a[20:23], a[84:87], v[92:95]
v_cvt_pk_bf16_f32 v36, v36, v37
v_cvt_pk_bf16_f32 v37, v38, v39
v_mfma_f32_16x16x32_bf16 v[92:95], a[24:27], a[88:91], v[92:95]
s_add_u32 m0, s38, 8
s_nop 0
buffer_load_dwordx4 v7, s[20:23], s40 offen offset:1024 nt lds
v_mfma_f32_16x16x32_bf16 v[92:95], a[28:31], a[92:95], v[92:95]
v_mul_f32 v41, s31, v41
v_mul_f32 v42, s31, v42
v_mfma_f32_16x16x32_bf16 v[96:99], a[16:19], a[96:99], v[120:123]
v_mul_f32 v43, s31, v43
v_mul_f32 v44, s31, v44
v_mfma_f32_16x16x32_bf16 v[96:99], a[20:23], a[100:103], v[96:99]
v_exp_f32 v40, v40
v_mfma_f32_16x16x32_bf16 v[96:99], a[24:27], a[104:107], v[96:99]
v_exp_f32 v41, v41
v_mfma_f32_16x16x32_bf16 v[96:99], a[28:31], a[108:111], v[96:99]
v_exp_f32 v42, v42
v_mfma_f32_16x16x32_bf16 v[100:103], a[16:19], a[112:115], v[124:127]
v_exp_f32 v43, v43
v_mfma_f32_16x16x32_bf16 v[100:103], a[20:23], a[116:119], v[100:103]
v_cvt_pk_bf16_f32 v40, v40, v41
v_cvt_pk_bf16_f32 v41, v42, v43
v_mfma_f32_16x16x32_bf16 v[100:103], a[24:27], a[120:123], v[100:103]
v_mul_f32 v45, s31, v45
v_mul_f32 v46, s31, v46
v_mfma_f32_16x16x32_bf16 v[100:103], a[28:31], a[124:127], v[100:103]
s_waitcnt lgkmcnt(0)
ds_read_b64_tr_b16 a[16:17], v4 offset:8256
ds_read_b64_tr_b16 a[18:19], v4 offset:12384
v_mfma_f32_16x16x32_bf16 a[132:135], a[128:131], v[56:59], a[132:135]
v_mul_f32 v47, s31, v47
v_mul_f32 v48, s31, v48
v_mfma_f32_16x16x32_bf16 a[136:139], a[128:131], v[60:63], a[136:139]
v_exp_f32 v44, v44
v_mfma_f32_16x16x32_bf16 a[140:143], a[128:131], v[64:67], a[140:143]
ds_read_b64_tr_b16 a[20:21], v4 offset:8264
ds_read_b64_tr_b16 a[22:23], v4 offset:12392
v_mfma_f32_16x16x32_bf16 a[144:147], a[128:131], v[68:71], a[144:147]
v_exp_f32 v45, v45
v_mfma_f32_16x16x32_bf16 a[148:151], a[128:131], v[72:75], a[148:151]
v_exp_f32 v46, v46
v_mfma_f32_16x16x32_bf16 a[152:155], a[128:131], v[76:79], a[152:155]
v_exp_f32 v47, v47
v_mfma_f32_16x16x32_bf16 v[128:131], a[0:3], v[56:59], v[128:131]
v_cvt_pk_bf16_f32 v44, v44, v45
v_cvt_pk_bf16_f32 v45, v46, v47
v_mfma_f32_16x16x32_bf16 v[160:163], a[0:3], v[60:63], v[160:163]
ds_read_b64_tr_b16 a[24:25], v5 offset:8256
ds_read_b64_tr_b16 a[26:27], v5 offset:12384
v_mfma_f32_16x16x32_bf16 v[192:195], a[0:3], v[64:67], v[192:195]
v_mul_f32 v49, s31, v49
v_mul_f32 v50, s31, v50
v_mfma_f32_16x16x32_bf16 v[224:227], a[0:3], v[68:71], v[224:227]
v_mul_f32 v51, s31, v51
v_mul_f32 v52, s31, v52
v_mfma_f32_16x16x32_bf16 a[156:159], a[0:3], v[72:75], a[156:159]
ds_read_b64_tr_b16 a[28:29], v5 offset:8264
ds_read_b64_tr_b16 a[30:31], v5 offset:12392
v_mfma_f32_16x16x32_bf16 a[188:191], a[0:3], v[76:79], a[188:191]
v_exp_f32 v48, v48
v_mfma_f32_16x16x32_bf16 v[132:135], a[4:7], v[56:59], v[132:135]
v_exp_f32 v49, v49
v_mfma_f32_16x16x32_bf16 v[164:167], a[4:7], v[60:63], v[164:167]
v_exp_f32 v50, v50
v_mfma_f32_16x16x32_bf16 v[196:199], a[4:7], v[64:67], v[196:199]
v_exp_f32 v51, v51
v_mfma_f32_16x16x32_bf16 v[228:231], a[4:7], v[68:71], v[228:231]
s_add_u32 m0, s39, 4096
s_add_u32 s41, s34, 4096
buffer_load_dwordx4 v6, s[12:15], s41 offen offset:0 nt lds
buffer_load_dwordx4 v12, s[12:15], s41 offen offset:1024 nt lds
buffer_load_dwordx4 v13, s[12:15], s41 offen offset:2048 nt lds
buffer_load_dwordx4 v28, s[12:15], s41 offen offset:3072 nt lds
v_mfma_f32_16x16x32_bf16 a[160:163], a[4:7], v[72:75], a[160:163]
v_cvt_pk_bf16_f32 v48, v48, v49
v_cvt_pk_bf16_f32 v49, v50, v51
v_mfma_f32_16x16x32_bf16 a[192:195], a[4:7], v[76:79], a[192:195]
v_mul_f32 v53, s31, v53
v_mul_f32 v54, s31, v54
v_mfma_f32_16x16x32_bf16 v[136:139], a[8:11], v[56:59], v[136:139]
v_mul_f32 v55, s31, v55
v_mul_f32 v80, s31, v80
v_mfma_f32_16x16x32_bf16 v[168:171], a[8:11], v[60:63], v[168:171]
v_exp_f32 v52, v52
v_mfma_f32_16x16x32_bf16 v[200:203], a[8:11], v[64:67], v[200:203]
v_exp_f32 v53, v53
v_mfma_f32_16x16x32_bf16 v[232:235], a[8:11], v[68:71], v[232:235]
v_exp_f32 v54, v54
v_mfma_f32_16x16x32_bf16 a[164:167], a[8:11], v[72:75], a[164:167]
v_exp_f32 v55, v55
v_mfma_f32_16x16x32_bf16 a[196:199], a[8:11], v[76:79], a[196:199]
v_cvt_pk_bf16_f32 v52, v52, v53
v_cvt_pk_bf16_f32 v53, v54, v55
v_mfma_f32_16x16x32_bf16 v[140:143], a[12:15], v[56:59], v[140:143]
v_mul_f32 v81, s31, v81
v_mul_f32 v82, s31, v82
v_mfma_f32_16x16x32_bf16 v[172:175], a[12:15], v[60:63], v[172:175]
v_mul_f32 v83, s31, v83
v_mul_f32 v84, s31, v84
v_mfma_f32_16x16x32_bf16 v[204:207], a[12:15], v[64:67], v[204:207]
v_exp_f32 v80, v80
v_mfma_f32_16x16x32_bf16 v[236:239], a[12:15], v[68:71], v[236:239]
v_exp_f32 v81, v81
v_mfma_f32_16x16x32_bf16 a[168:171], a[12:15], v[72:75], a[168:171]
v_exp_f32 v82, v82
v_mfma_f32_16x16x32_bf16 a[200:203], a[12:15], v[76:79], a[200:203]
s_waitcnt lgkmcnt(0)
ds_read_b128 a[0:3], v1 offset:26112
ds_read_b128 a[4:7], v1 offset:26176
v_mfma_f32_16x16x32_bf16 v[144:147], a[16:19], v[56:59], v[144:147]
v_exp_f32 v83, v83
v_mfma_f32_16x16x32_bf16 v[176:179], a[16:19], v[60:63], v[176:179]
v_cvt_pk_bf16_f32 v34, v80, v81
v_cvt_pk_bf16_f32 v35, v82, v83
v_mfma_f32_16x16x32_bf16 v[208:211], a[16:19], v[64:67], v[208:211]
ds_read_b128 a[8:11], v1 offset:26240
ds_read_b128 a[12:15], v1 offset:26304
v_mfma_f32_16x16x32_bf16 v[240:243], a[16:19], v[68:71], v[240:243]
v_mul_f32 v85, s31, v85
v_mul_f32 v86, s31, v86
v_mfma_f32_16x16x32_bf16 a[172:175], a[16:19], v[72:75], a[172:175]
v_mul_f32 v87, s31, v87
v_mul_f32 v88, s31, v88
v_mfma_f32_16x16x32_bf16 a[204:207], a[16:19], v[76:79], a[204:207]
v_exp_f32 v84, v84
v_mfma_f32_16x16x32_bf16 v[148:151], a[20:23], v[56:59], v[148:151]
v_exp_f32 v85, v85
v_mfma_f32_16x16x32_bf16 v[180:183], a[20:23], v[60:63], v[180:183]
v_exp_f32 v86, v86
v_mfma_f32_16x16x32_bf16 v[212:215], a[20:23], v[64:67], v[212:215]
v_exp_f32 v87, v87
v_mfma_f32_16x16x32_bf16 v[244:247], a[20:23], v[68:71], v[244:247]
v_cvt_pk_bf16_f32 v38, v84, v85
v_cvt_pk_bf16_f32 v39, v86, v87
v_mfma_f32_16x16x32_bf16 a[176:179], a[20:23], v[72:75], a[176:179]
v_mul_f32 v89, s31, v89
v_mul_f32 v90, s31, v90
v_mfma_f32_16x16x32_bf16 a[208:211], a[20:23], v[76:79], a[208:211]
v_mul_f32 v91, s31, v91
v_mul_f32 v92, s31, v92
v_mfma_f32_16x16x32_bf16 v[152:155], a[24:27], v[56:59], v[152:155]
v_exp_f32 v88, v88
v_mfma_f32_16x16x32_bf16 v[184:187], a[24:27], v[60:63], v[184:187]
v_exp_f32 v89, v89
v_mfma_f32_16x16x32_bf16 v[216:219], a[24:27], v[64:67], v[216:219]
v_exp_f32 v90, v90
v_mfma_f32_16x16x32_bf16 v[248:251], a[24:27], v[68:71], v[248:251]
v_exp_f32 v91, v91
v_mfma_f32_16x16x32_bf16 a[180:183], a[24:27], v[72:75], a[180:183]
v_cvt_pk_bf16_f32 v42, v88, v89
v_cvt_pk_bf16_f32 v43, v90, v91
v_mfma_f32_16x16x32_bf16 a[212:215], a[24:27], v[76:79], a[212:215]
v_mul_f32 v93, s31, v93
v_mul_f32 v94, s31, v94
v_mfma_f32_16x16x32_bf16 v[156:159], a[28:31], v[56:59], v[156:159]
v_mul_f32 v95, s31, v95
v_mfma_f32_16x16x32_bf16 v[188:191], a[28:31], v[60:63], v[188:191]
v_exp_f32 v92, v92
v_mfma_f32_16x16x32_bf16 v[220:223], a[28:31], v[64:67], v[220:223]
v_exp_f32 v93, v93
v_mfma_f32_16x16x32_bf16 v[252:255], a[28:31], v[68:71], v[252:255]
v_exp_f32 v94, v94
v_mfma_f32_16x16x32_bf16 a[184:187], a[28:31], v[72:75], a[184:187]
v_exp_f32 v95, v95
v_mfma_f32_16x16x32_bf16 a[216:219], a[28:31], v[76:79], a[216:219]
v_cvt_pk_bf16_f32 v46, v92, v93
v_cvt_pk_bf16_f32 v47, v94, v95
s_waitcnt lgkmcnt(0)
ds_read_b128 a[16:19], v1 offset:30464
ds_read_b128 a[20:23], v1 offset:30528
v_mfma_f32_16x16x32_bf16 v[56:59], a[0:3], a[32:35], v[104:107]
v_mul_f32 v96, s31, v96
v_mul_f32 v97, s31, v97
v_mfma_f32_16x16x32_bf16 v[56:59], a[4:7], a[36:39], v[56:59]
v_mul_f32 v98, s31, v98
v_mul_f32 v99, s31, v99
v_mfma_f32_16x16x32_bf16 v[56:59], a[8:11], a[40:43], v[56:59]
ds_read_b128 a[24:27], v1 offset:30592
ds_read_b128 a[28:31], v1 offset:30656
v_mfma_f32_16x16x32_bf16 v[56:59], a[12:15], a[44:47], v[56:59]
v_exp_f32 v96, v96
v_mfma_f32_16x16x32_bf16 v[60:63], a[0:3], a[48:51], v[108:111]
v_exp_f32 v97, v97
v_mfma_f32_16x16x32_bf16 v[60:63], a[4:7], a[52:55], v[60:63]
v_exp_f32 v98, v98
v_mfma_f32_16x16x32_bf16 v[60:63], a[8:11], a[56:59], v[60:63]
ds_read_b128 v[20:23], v0 offset:12288
ds_read_b128 v[24:27], v0 offset:13312
ds_read_b128 v[28:31], v0 offset:14336
v_mfma_f32_16x16x32_bf16 v[60:63], a[12:15], a[60:63], v[60:63]
v_exp_f32 v99, v99
v_mfma_f32_16x16x32_bf16 v[64:67], a[0:3], a[64:67], v[112:115]
v_cvt_pk_bf16_f32 v50, v96, v97
v_cvt_pk_bf16_f32 v51, v98, v99
v_mfma_f32_16x16x32_bf16 v[64:67], a[4:7], a[68:71], v[64:67]
v_mul_f32 v100, s31, v100
v_mul_f32 v101, s31, v101
v_mfma_f32_16x16x32_bf16 v[64:67], a[8:11], a[72:75], v[64:67]
v_mul_f32 v102, s31, v102
v_mul_f32 v103, s31, v103
v_mfma_f32_16x16x32_bf16 v[64:67], a[12:15], a[76:79], v[64:67]
v_exp_f32 v100, v100
s_waitcnt vmcnt(14)
s_barrier
v_mfma_f32_16x16x32_bf16 v[68:71], a[0:3], a[80:83], v[116:119]
v_exp_f32 v101, v101
v_mfma_f32_16x16x32_bf16 v[68:71], a[4:7], a[84:87], v[68:71]
s_add_u32 m0, s37, 17408
s_add_u32 s40, s32, 81920
buffer_load_dwordx4 v6, s[16:19], s40 offen nt lds
v_mfma_f32_16x16x32_bf16 v[68:71], a[8:11], a[88:91], v[68:71]
v_exp_f32 v102, v102
v_mfma_f32_16x16x32_bf16 v[68:71], a[12:15], a[92:95], v[68:71]
v_exp_f32 v103, v103
v_mfma_f32_16x16x32_bf16 v[72:75], a[0:3], a[96:99], v[120:123]
s_add_u32 m0, s37, 17472
s_nop 0
buffer_load_dwordx4 v6, s[16:19], s40 offen offset:1024 nt lds
v_mfma_f32_16x16x32_bf16 v[72:75], a[4:7], a[100:103], v[72:75]
v_cvt_pk_bf16_f32 v54, v100, v101
v_cvt_pk_bf16_f32 v55, v102, v103
v_mfma_f32_16x16x32_bf16 v[72:75], a[8:11], a[104:107], v[72:75]
v_mul_f32 v56, s31, v56
v_mul_f32 v57, s31, v57
v_mfma_f32_16x16x32_bf16 v[72:75], a[12:15], a[108:111], v[72:75]
v_mul_f32 v58, s31, v58
v_mul_f32 v59, s31, v59
v_mfma_f32_16x16x32_bf16 v[76:79], a[0:3], a[112:115], v[124:127]
v_exp_f32 v56, v56
v_mfma_f32_16x16x32_bf16 v[76:79], a[4:7], a[116:119], v[76:79]
v_exp_f32 v57, v57
v_mfma_f32_16x16x32_bf16 v[76:79], a[8:11], a[120:123], v[76:79]
v_exp_f32 v58, v58
v_mfma_f32_16x16x32_bf16 v[76:79], a[12:15], a[124:127], v[76:79]
s_waitcnt lgkmcnt(3)
s_add_u32 s36, s45, 12288
s_waitcnt lgkmcnt(2)
buffer_store_dwordx4 v[20:23], v6, s[24:27], s36 offen offset:0
ds_read_b64_tr_b16 a[0:1], v2 offset:16512
ds_read_b64_tr_b16 a[2:3], v2 offset:20640
v_mfma_f32_16x16x32_bf16 v[80:83], a[16:19], a[32:35], v[104:107]
v_exp_f32 v59, v59
v_mfma_f32_16x16x32_bf16 v[80:83], a[20:23], a[36:39], v[80:83]
v_cvt_pk_bf16_f32 v56, v56, v57
v_cvt_pk_bf16_f32 v57, v58, v59
v_mfma_f32_16x16x32_bf16 v[80:83], a[24:27], a[40:43], v[80:83]
ds_read_b64_tr_b16 a[4:5], v2 offset:16520
ds_read_b64_tr_b16 a[6:7], v2 offset:20648
v_mfma_f32_16x16x32_bf16 v[80:83], a[28:31], a[44:47], v[80:83]
v_mul_f32 v60, s31, v60
v_mul_f32 v61, s31, v61
v_mfma_f32_16x16x32_bf16 v[84:87], a[16:19], a[48:51], v[108:111]
v_mul_f32 v62, s31, v62
v_mul_f32 v63, s31, v63
v_mfma_f32_16x16x32_bf16 v[84:87], a[20:23], a[52:55], v[84:87]
v_mfma_f32_16x16x32_bf16 v[84:87], a[24:27], a[56:59], v[84:87]
v_exp_f32 v60, v60
v_mfma_f32_16x16x32_bf16 v[84:87], a[28:31], a[60:63], v[84:87]
s_add_u32 s36, s45, 12288
s_waitcnt lgkmcnt(5)
buffer_store_dwordx4 v[24:27], v6, s[24:27], s36 offen offset:1024
ds_read_b64_tr_b16 a[8:9], v3 offset:16512
ds_read_b64_tr_b16 a[10:11], v3 offset:20640
v_mfma_f32_16x16x32_bf16 v[88:91], a[16:19], a[64:67], v[112:115]
ds_read_b64_tr_b16 a[12:13], v3 offset:16520
ds_read_b64_tr_b16 a[14:15], v3 offset:20648
v_mfma_f32_16x16x32_bf16 v[88:91], a[20:23], a[68:71], v[88:91]
v_exp_f32 v61, v61
v_mfma_f32_16x16x32_bf16 v[88:91], a[24:27], a[72:75], v[88:91]
v_exp_f32 v62, v62
v_mfma_f32_16x16x32_bf16 v[88:91], a[28:31], a[76:79], v[88:91]
s_add_u32 m0, s38, 8256
s_add_u32 s40, s32, 73728
buffer_load_dwordx4 v7, s[20:23], s40 offen nt lds
ds_read_b128 v[20:23], v0 offset:15360
v_mfma_f32_16x16x32_bf16 v[92:95], a[16:19], a[80:83], v[116:119]
v_exp_f32 v63, v63
v_mfma_f32_16x16x32_bf16 v[92:95], a[20:23], a[84:87], v[92:95]
v_cvt_pk_bf16_f32 v60, v60, v61
v_cvt_pk_bf16_f32 v61, v62, v63
v_mfma_f32_16x16x32_bf16 v[92:95], a[24:27], a[88:91], v[92:95]
s_add_u32 m0, s38, 8264
s_nop 0
buffer_load_dwordx4 v7, s[20:23], s40 offen offset:1024 nt lds
v_mfma_f32_16x16x32_bf16 v[92:95], a[28:31], a[92:95], v[92:95]
v_mul_f32 v64, s31, v64
v_mul_f32 v65, s31, v65
v_mfma_f32_16x16x32_bf16 v[96:99], a[16:19], a[96:99], v[120:123]
v_mul_f32 v66, s31, v66
v_mul_f32 v67, s31, v67
v_mfma_f32_16x16x32_bf16 v[96:99], a[20:23], a[100:103], v[96:99]
v_exp_f32 v64, v64
v_mfma_f32_16x16x32_bf16 v[96:99], a[24:27], a[104:107], v[96:99]
v_exp_f32 v65, v65
v_mfma_f32_16x16x32_bf16 v[96:99], a[28:31], a[108:111], v[96:99]
v_exp_f32 v66, v66
v_mfma_f32_16x16x32_bf16 v[100:103], a[16:19], a[112:115], v[124:127]
v_exp_f32 v67, v67
v_mfma_f32_16x16x32_bf16 v[100:103], a[20:23], a[116:119], v[100:103]
v_cvt_pk_bf16_f32 v64, v64, v65
v_cvt_pk_bf16_f32 v65, v66, v67
v_mfma_f32_16x16x32_bf16 v[100:103], a[24:27], a[120:123], v[100:103]
v_mul_f32 v68, s31, v68
v_mul_f32 v69, s31, v69
v_mfma_f32_16x16x32_bf16 v[100:103], a[28:31], a[124:127], v[100:103]
s_waitcnt lgkmcnt(1)
s_add_u32 s36, s45, 12288
buffer_store_dwordx4 v[28:31], v6, s[24:27], s36 offen offset:2048
ds_read_b64_tr_b16 a[16:17], v4 offset:16512
ds_read_b64_tr_b16 a[18:19], v4 offset:20640
v_mfma_f32_16x16x32_bf16 a[132:135], a[128:131], v[32:35], a[132:135]
v_mul_f32 v70, s31, v70
v_mul_f32 v71, s31, v71
v_mfma_f32_16x16x32_bf16 a[136:139], a[128:131], v[36:39], a[136:139]
v_exp_f32 v68, v68
v_mfma_f32_16x16x32_bf16 a[140:143], a[128:131], v[40:43], a[140:143]
ds_read_b64_tr_b16 a[20:21], v4 offset:16520
ds_read_b64_tr_b16 a[22:23], v4 offset:20648
v_mfma_f32_16x16x32_bf16 a[144:147], a[128:131], v[44:47], a[144:147]
v_exp_f32 v69, v69
v_mfma_f32_16x16x32_bf16 a[148:151], a[128:131], v[48:51], a[148:151]
v_exp_f32 v70, v70
v_mfma_f32_16x16x32_bf16 a[152:155], a[128:131], v[52:55], a[152:155]
v_exp_f32 v71, v71
v_mfma_f32_16x16x32_bf16 v[128:131], a[0:3], v[32:35], v[128:131]
v_cvt_pk_bf16_f32 v68, v68, v69
v_cvt_pk_bf16_f32 v69, v70, v71
v_mfma_f32_16x16x32_bf16 v[160:163], a[0:3], v[36:39], v[160:163]
s_add_u32 s36, s45, 12288
s_waitcnt lgkmcnt(4)
buffer_store_dwordx4 v[20:23], v6, s[24:27], s36 offen offset:3072
ds_read_b64_tr_b16 a[24:25], v5 offset:16512
ds_read_b64_tr_b16 a[26:27], v5 offset:20640
v_mfma_f32_16x16x32_bf16 v[192:195], a[0:3], v[40:43], v[192:195]
v_mul_f32 v72, s31, v72
v_mul_f32 v73, s31, v73
v_mfma_f32_16x16x32_bf16 v[224:227], a[0:3], v[44:47], v[224:227]
v_mul_f32 v74, s31, v74
v_mul_f32 v75, s31, v75
v_mfma_f32_16x16x32_bf16 a[156:159], a[0:3], v[48:51], a[156:159]
ds_read_b64_tr_b16 a[28:29], v5 offset:16520
ds_read_b64_tr_b16 a[30:31], v5 offset:20648
v_mfma_f32_16x16x32_bf16 a[188:191], a[0:3], v[52:55], a[188:191]
v_exp_f32 v72, v72
v_mfma_f32_16x16x32_bf16 v[132:135], a[4:7], v[32:35], v[132:135]
v_exp_f32 v73, v73
v_mfma_f32_16x16x32_bf16 v[164:167], a[4:7], v[36:39], v[164:167]
v_exp_f32 v74, v74
v_mfma_f32_16x16x32_bf16 v[196:199], a[4:7], v[40:43], v[196:199]
v_exp_f32 v75, v75
v_mfma_f32_16x16x32_bf16 v[228:231], a[4:7], v[44:47], v[228:231]
v_cvt_pk_bf16_f32 v72, v72, v73
v_cvt_pk_bf16_f32 v73, v74, v75
v_mfma_f32_16x16x32_bf16 a[160:163], a[4:7], v[48:51], a[160:163]
v_mul_f32 v76, s31, v76
v_mul_f32 v77, s31, v77
v_mfma_f32_16x16x32_bf16 a[192:195], a[4:7], v[52:55], a[192:195]
v_mul_f32 v78, s31, v78
v_mul_f32 v79, s31, v79
v_mfma_f32_16x16x32_bf16 v[136:139], a[8:11], v[32:35], v[136:139]
v_exp_f32 v76, v76
v_mfma_f32_16x16x32_bf16 v[168:171], a[8:11], v[36:39], v[168:171]
v_exp_f32 v77, v77
v_mfma_f32_16x16x32_bf16 v[200:203], a[8:11], v[40:43], v[200:203]
v_exp_f32 v78, v78
v_mfma_f32_16x16x32_bf16 v[232:235], a[8:11], v[44:47], v[232:235]
v_exp_f32 v79, v79
v_mfma_f32_16x16x32_bf16 a[164:167], a[8:11], v[48:51], a[164:167]
v_cvt_pk_bf16_f32 v76, v76, v77
v_cvt_pk_bf16_f32 v77, v78, v79
v_mfma_f32_16x16x32_bf16 a[196:199], a[8:11], v[52:55], a[196:199]
v_mul_f32 v80, s31, v80
v_mul_f32 v81, s31, v81
v_mfma_f32_16x16x32_bf16 v[140:143], a[12:15], v[32:35], v[140:143]
v_mul_f32 v82, s31, v82
v_mul_f32 v83, s31, v83
v_mfma_f32_16x16x32_bf16 v[172:175], a[12:15], v[36:39], v[172:175]
v_exp_f32 v80, v80
v_mfma_f32_16x16x32_bf16 v[204:207], a[12:15], v[40:43], v[204:207]
v_exp_f32 v81, v81
v_mfma_f32_16x16x32_bf16 v[236:239], a[12:15], v[44:47], v[236:239]
v_exp_f32 v82, v82
v_mfma_f32_16x16x32_bf16 a[168:171], a[12:15], v[48:51], a[168:171]
v_exp_f32 v83, v83
v_mfma_f32_16x16x32_bf16 a[200:203], a[12:15], v[52:55], a[200:203]
s_waitcnt lgkmcnt(0)
ds_read_b128 a[0:3], v1 offset:0
ds_read_b128 a[4:7], v1 offset:64
v_mfma_f32_16x16x32_bf16 v[144:147], a[16:19], v[32:35], v[144:147]
v_cvt_pk_bf16_f32 v58, v80, v81
v_cvt_pk_bf16_f32 v59, v82, v83
v_mfma_f32_16x16x32_bf16 v[176:179], a[16:19], v[36:39], v[176:179]
v_mul_f32 v84, s31, v84
v_mul_f32 v85, s31, v85
v_mfma_f32_16x16x32_bf16 v[208:211], a[16:19], v[40:43], v[208:211]
ds_read_b128 a[8:11], v1 offset:128
ds_read_b128 a[12:15], v1 offset:192
v_mfma_f32_16x16x32_bf16 v[240:243], a[16:19], v[44:47], v[240:243]
v_mul_f32 v86, s31, v86
v_mul_f32 v87, s31, v87
v_mfma_f32_16x16x32_bf16 a[172:175], a[16:19], v[48:51], a[172:175]
v_exp_f32 v84, v84
v_mfma_f32_16x16x32_bf16 a[204:207], a[16:19], v[52:55], a[204:207]
v_exp_f32 v85, v85
v_mfma_f32_16x16x32_bf16 v[148:151], a[20:23], v[32:35], v[148:151]
v_exp_f32 v86, v86
v_mfma_f32_16x16x32_bf16 v[180:183], a[20:23], v[36:39], v[180:183]
v_exp_f32 v87, v87
v_mfma_f32_16x16x32_bf16 v[212:215], a[20:23], v[40:43], v[212:215]
v_cvt_pk_bf16_f32 v62, v84, v85
v_cvt_pk_bf16_f32 v63, v86, v87
v_mfma_f32_16x16x32_bf16 v[244:247], a[20:23], v[44:47], v[244:247]
v_mul_f32 v88, s31, v88
v_mul_f32 v89, s31, v89
v_mfma_f32_16x16x32_bf16 a[176:179], a[20:23], v[48:51], a[176:179]
v_mul_f32 v90, s31, v90
v_mul_f32 v91, s31, v91
v_mfma_f32_16x16x32_bf16 a[208:211], a[20:23], v[52:55], a[208:211]
v_exp_f32 v88, v88
v_mfma_f32_16x16x32_bf16 v[152:155], a[24:27], v[32:35], v[152:155]
v_exp_f32 v89, v89
v_mfma_f32_16x16x32_bf16 v[184:187], a[24:27], v[36:39], v[184:187]
v_exp_f32 v90, v90
v_mfma_f32_16x16x32_bf16 v[216:219], a[24:27], v[40:43], v[216:219]
v_exp_f32 v91, v91
v_mfma_f32_16x16x32_bf16 v[248:251], a[24:27], v[44:47], v[248:251]
v_cvt_pk_bf16_f32 v66, v88, v89
v_cvt_pk_bf16_f32 v67, v90, v91
v_mfma_f32_16x16x32_bf16 a[180:183], a[24:27], v[48:51], a[180:183]
v_mul_f32 v92, s31, v92
v_mul_f32 v93, s31, v93
v_mfma_f32_16x16x32_bf16 a[212:215], a[24:27], v[52:55], a[212:215]
v_mul_f32 v94, s31, v94
v_mul_f32 v95, s31, v95
v_mfma_f32_16x16x32_bf16 v[156:159], a[28:31], v[32:35], v[156:159]
v_exp_f32 v92, v92
v_mfma_f32_16x16x32_bf16 v[188:191], a[28:31], v[36:39], v[188:191]
v_exp_f32 v93, v93
v_mfma_f32_16x16x32_bf16 v[220:223], a[28:31], v[40:43], v[220:223]
v_exp_f32 v94, v94
v_mfma_f32_16x16x32_bf16 v[252:255], a[28:31], v[44:47], v[252:255]
v_exp_f32 v95, v95
v_mfma_f32_16x16x32_bf16 a[184:187], a[28:31], v[48:51], a[184:187]
v_cvt_pk_bf16_f32 v70, v92, v93
v_cvt_pk_bf16_f32 v71, v94, v95
v_mfma_f32_16x16x32_bf16 a[216:219], a[28:31], v[52:55], a[216:219]
s_waitcnt lgkmcnt(0)
ds_read_b128 a[16:19], v1 offset:4352
ds_read_b128 a[20:23], v1 offset:4416
v_mfma_f32_16x16x32_bf16 v[32:35], a[0:3], a[32:35], v[104:107]
v_mul_f32 v96, s31, v96
v_mul_f32 v97, s31, v97
v_mfma_f32_16x16x32_bf16 v[32:35], a[4:7], a[36:39], v[32:35]
v_mul_f32 v98, s31, v98
v_mul_f32 v99, s31, v99
v_mfma_f32_16x16x32_bf16 v[32:35], a[8:11], a[40:43], v[32:35]
ds_read_b128 a[24:27], v1 offset:4480
ds_read_b128 a[28:31], v1 offset:4544
v_mfma_f32_16x16x32_bf16 v[32:35], a[12:15], a[44:47], v[32:35]
v_exp_f32 v96, v96
v_mfma_f32_16x16x32_bf16 v[36:39], a[0:3], a[48:51], v[108:111]
v_exp_f32 v97, v97
v_mfma_f32_16x16x32_bf16 v[36:39], a[4:7], a[52:55], v[36:39]
v_exp_f32 v98, v98
v_mfma_f32_16x16x32_bf16 v[36:39], a[8:11], a[56:59], v[36:39]
v_exp_f32 v99, v99
v_mfma_f32_16x16x32_bf16 v[36:39], a[12:15], a[60:63], v[36:39]
v_cvt_pk_bf16_f32 v74, v96, v97
v_cvt_pk_bf16_f32 v75, v98, v99
v_mfma_f32_16x16x32_bf16 v[40:43], a[0:3], a[64:67], v[112:115]
v_mul_f32 v100, s31, v100
v_mul_f32 v101, s31, v101
v_mfma_f32_16x16x32_bf16 v[40:43], a[4:7], a[68:71], v[40:43]
v_mul_f32 v102, s31, v102
v_mul_f32 v103, s31, v103
v_mfma_f32_16x16x32_bf16 v[40:43], a[8:11], a[72:75], v[40:43]
v_exp_f32 v100, v100
v_mfma_f32_16x16x32_bf16 v[40:43], a[12:15], a[76:79], v[40:43]
v_exp_f32 v101, v101
s_waitcnt vmcnt(14)
s_barrier
v_mfma_f32_16x16x32_bf16 v[44:47], a[0:3], a[80:83], v[116:119]
v_exp_f32 v102, v102
v_mfma_f32_16x16x32_bf16 v[44:47], a[4:7], a[84:87], v[44:47]
s_add_u32 m0, s37, 26112
s_add_u32 s40, s32, 90112
buffer_load_dwordx4 v6, s[16:19], s40 offen nt lds
v_mfma_f32_16x16x32_bf16 v[44:47], a[8:11], a[88:91], v[44:47]
v_exp_f32 v103, v103
v_mfma_f32_16x16x32_bf16 v[44:47], a[12:15], a[92:95], v[44:47]
v_cvt_pk_bf16_f32 v78, v100, v101
v_cvt_pk_bf16_f32 v79, v102, v103
v_mfma_f32_16x16x32_bf16 v[48:51], a[0:3], a[96:99], v[120:123]
s_add_u32 m0, s37, 26176
s_nop 0
buffer_load_dwordx4 v6, s[16:19], s40 offen offset:1024 nt lds
v_mfma_f32_16x16x32_bf16 v[48:51], a[4:7], a[100:103], v[48:51]
v_xor_b32 v12, 64, v6
v_xor_b32 v13, 128, v6
v_mfma_f32_16x16x32_bf16 v[48:51], a[8:11], a[104:107], v[48:51]
v_xor_b32 v28, 192, v6
v_mul_f32 v32, s31, v32
v_mfma_f32_16x16x32_bf16 v[48:51], a[12:15], a[108:111], v[48:51]
v_mul_f32 v33, s31, v33
v_mul_f32 v34, s31, v34
v_mfma_f32_16x16x32_bf16 v[52:55], a[0:3], a[112:115], v[124:127]
v_mul_f32 v35, s31, v35
v_mul_f32 v36, s31, v36
v_mfma_f32_16x16x32_bf16 v[52:55], a[4:7], a[116:119], v[52:55]
v_exp_f32 v32, v32
v_mfma_f32_16x16x32_bf16 v[52:55], a[8:11], a[120:123], v[52:55]
v_exp_f32 v33, v33
v_mfma_f32_16x16x32_bf16 v[52:55], a[12:15], a[124:127], v[52:55]
s_waitcnt lgkmcnt(0)
ds_read_b64_tr_b16 a[0:1], v2 offset:24768
ds_read_b64_tr_b16 a[2:3], v2 offset:28896
v_mfma_f32_16x16x32_bf16 v[80:83], a[16:19], a[32:35], v[104:107]
v_exp_f32 v34, v34
v_mfma_f32_16x16x32_bf16 v[80:83], a[20:23], a[36:39], v[80:83]
v_exp_f32 v35, v35
v_mfma_f32_16x16x32_bf16 v[80:83], a[24:27], a[40:43], v[80:83]
ds_read_b64_tr_b16 a[4:5], v2 offset:24776
ds_read_b64_tr_b16 a[6:7], v2 offset:28904
v_mfma_f32_16x16x32_bf16 v[80:83], a[28:31], a[44:47], v[80:83]
v_cvt_pk_bf16_f32 v32, v32, v33
v_cvt_pk_bf16_f32 v33, v34, v35
v_mfma_f32_16x16x32_bf16 v[84:87], a[16:19], a[48:51], v[108:111]
v_mul_f32 v37, s31, v37
v_mul_f32 v38, s31, v38
v_mfma_f32_16x16x32_bf16 v[84:87], a[20:23], a[52:55], v[84:87]
ds_read_b64_tr_b16 a[8:9], v3 offset:24768
ds_read_b64_tr_b16 a[10:11], v3 offset:28896
v_mfma_f32_16x16x32_bf16 v[84:87], a[24:27], a[56:59], v[84:87]
v_mul_f32 v39, s31, v39
v_mul_f32 v40, s31, v40
v_mfma_f32_16x16x32_bf16 v[84:87], a[28:31], a[60:63], v[84:87]
v_exp_f32 v36, v36
v_mfma_f32_16x16x32_bf16 v[88:91], a[16:19], a[64:67], v[112:115]
ds_read_b64_tr_b16 a[12:13], v3 offset:24776
ds_read_b64_tr_b16 a[14:15], v3 offset:28904
v_mfma_f32_16x16x32_bf16 v[88:91], a[20:23], a[68:71], v[88:91]
v_exp_f32 v37, v37
v_mfma_f32_16x16x32_bf16 v[88:91], a[24:27], a[72:75], v[88:91]
v_exp_f32 v38, v38
v_mfma_f32_16x16x32_bf16 v[88:91], a[28:31], a[76:79], v[88:91]
s_add_u32 m0, s38, 16512
s_add_u32 s40, s32, 81920
buffer_load_dwordx4 v7, s[20:23], s40 offen nt lds
v_mfma_f32_16x16x32_bf16 v[92:95], a[16:19], a[80:83], v[116:119]
v_exp_f32 v39, v39
v_mfma_f32_16x16x32_bf16 v[92:95], a[20:23], a[84:87], v[92:95]
v_cvt_pk_bf16_f32 v36, v36, v37
v_cvt_pk_bf16_f32 v37, v38, v39
v_mfma_f32_16x16x32_bf16 v[92:95], a[24:27], a[88:91], v[92:95]
s_add_u32 m0, s38, 16520
s_nop 0
buffer_load_dwordx4 v7, s[20:23], s40 offen offset:1024 nt lds
v_mfma_f32_16x16x32_bf16 v[92:95], a[28:31], a[92:95], v[92:95]
v_mul_f32 v41, s31, v41
v_mul_f32 v42, s31, v42
v_mfma_f32_16x16x32_bf16 v[96:99], a[16:19], a[96:99], v[120:123]
v_mul_f32 v43, s31, v43
v_mul_f32 v44, s31, v44
v_mfma_f32_16x16x32_bf16 v[96:99], a[20:23], a[100:103], v[96:99]
v_exp_f32 v40, v40
v_mfma_f32_16x16x32_bf16 v[96:99], a[24:27], a[104:107], v[96:99]
v_exp_f32 v41, v41
v_mfma_f32_16x16x32_bf16 v[96:99], a[28:31], a[108:111], v[96:99]
v_exp_f32 v42, v42
v_mfma_f32_16x16x32_bf16 v[100:103], a[16:19], a[112:115], v[124:127]
v_exp_f32 v43, v43
v_mfma_f32_16x16x32_bf16 v[100:103], a[20:23], a[116:119], v[100:103]
v_cvt_pk_bf16_f32 v40, v40, v41
v_cvt_pk_bf16_f32 v41, v42, v43
v_mfma_f32_16x16x32_bf16 v[100:103], a[24:27], a[120:123], v[100:103]
v_mul_f32 v45, s31, v45
v_mul_f32 v46, s31, v46
v_mfma_f32_16x16x32_bf16 v[100:103], a[28:31], a[124:127], v[100:103]
s_waitcnt lgkmcnt(0)
ds_read_b64_tr_b16 a[16:17], v4 offset:24768
ds_read_b64_tr_b16 a[18:19], v4 offset:28896
v_mfma_f32_16x16x32_bf16 a[132:135], a[128:131], v[56:59], a[132:135]
v_mul_f32 v47, s31, v47
v_mul_f32 v48, s31, v48
v_mfma_f32_16x16x32_bf16 a[136:139], a[128:131], v[60:63], a[136:139]
v_exp_f32 v44, v44
v_mfma_f32_16x16x32_bf16 a[140:143], a[128:131], v[64:67], a[140:143]
ds_read_b64_tr_b16 a[20:21], v4 offset:24776
ds_read_b64_tr_b16 a[22:23], v4 offset:28904
v_mfma_f32_16x16x32_bf16 a[144:147], a[128:131], v[68:71], a[144:147]
v_exp_f32 v45, v45
v_mfma_f32_16x16x32_bf16 a[148:151], a[128:131], v[72:75], a[148:151]
v_exp_f32 v46, v46
v_mfma_f32_16x16x32_bf16 a[152:155], a[128:131], v[76:79], a[152:155]
v_exp_f32 v47, v47
v_mfma_f32_16x16x32_bf16 v[128:131], a[0:3], v[56:59], v[128:131]
v_cvt_pk_bf16_f32 v44, v44, v45
v_cvt_pk_bf16_f32 v45, v46, v47
v_mfma_f32_16x16x32_bf16 v[160:163], a[0:3], v[60:63], v[160:163]
ds_read_b64_tr_b16 a[24:25], v5 offset:24768
ds_read_b64_tr_b16 a[26:27], v5 offset:28896
v_mfma_f32_16x16x32_bf16 v[192:195], a[0:3], v[64:67], v[192:195]
v_mul_f32 v49, s31, v49
v_mul_f32 v50, s31, v50
v_mfma_f32_16x16x32_bf16 v[224:227], a[0:3], v[68:71], v[224:227]
v_mul_f32 v51, s31, v51
v_mul_f32 v52, s31, v52
v_mfma_f32_16x16x32_bf16 a[156:159], a[0:3], v[72:75], a[156:159]
ds_read_b64_tr_b16 a[28:29], v5 offset:24776
ds_read_b64_tr_b16 a[30:31], v5 offset:28904
v_mfma_f32_16x16x32_bf16 a[188:191], a[0:3], v[76:79], a[188:191]
v_exp_f32 v48, v48
v_mfma_f32_16x16x32_bf16 v[132:135], a[4:7], v[56:59], v[132:135]
v_exp_f32 v49, v49
v_mfma_f32_16x16x32_bf16 v[164:167], a[4:7], v[60:63], v[164:167]
v_exp_f32 v50, v50
v_mfma_f32_16x16x32_bf16 v[196:199], a[4:7], v[64:67], v[196:199]
v_exp_f32 v51, v51
v_mfma_f32_16x16x32_bf16 v[228:231], a[4:7], v[68:71], v[228:231]
s_add_u32 m0, s39, 8192
s_add_u32 s41, s34, 8192
buffer_load_dwordx4 v6, s[12:15], s41 offen offset:0 nt lds
buffer_load_dwordx4 v12, s[12:15], s41 offen offset:1024 nt lds
buffer_load_dwordx4 v13, s[12:15], s41 offen offset:2048 nt lds
buffer_load_dwordx4 v28, s[12:15], s41 offen offset:3072 nt lds
v_mfma_f32_16x16x32_bf16 a[160:163], a[4:7], v[72:75], a[160:163]
v_cvt_pk_bf16_f32 v48, v48, v49
v_cvt_pk_bf16_f32 v49, v50, v51
v_mfma_f32_16x16x32_bf16 a[192:195], a[4:7], v[76:79], a[192:195]
v_mul_f32 v53, s31, v53
v_mul_f32 v54, s31, v54
v_mfma_f32_16x16x32_bf16 v[136:139], a[8:11], v[56:59], v[136:139]
v_mul_f32 v55, s31, v55
v_mul_f32 v80, s31, v80
v_mfma_f32_16x16x32_bf16 v[168:171], a[8:11], v[60:63], v[168:171]
v_exp_f32 v52, v52
v_mfma_f32_16x16x32_bf16 v[200:203], a[8:11], v[64:67], v[200:203]
v_exp_f32 v53, v53
v_mfma_f32_16x16x32_bf16 v[232:235], a[8:11], v[68:71], v[232:235]
v_exp_f32 v54, v54
v_mfma_f32_16x16x32_bf16 a[164:167], a[8:11], v[72:75], a[164:167]
v_exp_f32 v55, v55
v_mfma_f32_16x16x32_bf16 a[196:199], a[8:11], v[76:79], a[196:199]
v_cvt_pk_bf16_f32 v52, v52, v53
v_cvt_pk_bf16_f32 v53, v54, v55
v_mfma_f32_16x16x32_bf16 v[140:143], a[12:15], v[56:59], v[140:143]
v_mul_f32 v81, s31, v81
v_mul_f32 v82, s31, v82
v_mfma_f32_16x16x32_bf16 v[172:175], a[12:15], v[60:63], v[172:175]
v_mul_f32 v83, s31, v83
v_mul_f32 v84, s31, v84
v_mfma_f32_16x16x32_bf16 v[204:207], a[12:15], v[64:67], v[204:207]
v_exp_f32 v80, v80
v_mfma_f32_16x16x32_bf16 v[236:239], a[12:15], v[68:71], v[236:239]
v_exp_f32 v81, v81
v_mfma_f32_16x16x32_bf16 a[168:171], a[12:15], v[72:75], a[168:171]
v_exp_f32 v82, v82
v_mfma_f32_16x16x32_bf16 a[200:203], a[12:15], v[76:79], a[200:203]
s_waitcnt lgkmcnt(0)
ds_read_b128 a[0:3], v1 offset:8704
ds_read_b128 a[4:7], v1 offset:8768
v_mfma_f32_16x16x32_bf16 v[144:147], a[16:19], v[56:59], v[144:147]
v_exp_f32 v83, v83
v_mfma_f32_16x16x32_bf16 v[176:179], a[16:19], v[60:63], v[176:179]
v_cvt_pk_bf16_f32 v34, v80, v81
v_cvt_pk_bf16_f32 v35, v82, v83
v_mfma_f32_16x16x32_bf16 v[208:211], a[16:19], v[64:67], v[208:211]
ds_read_b128 a[8:11], v1 offset:8832
ds_read_b128 a[12:15], v1 offset:8896
v_mfma_f32_16x16x32_bf16 v[240:243], a[16:19], v[68:71], v[240:243]
v_mul_f32 v85, s31, v85
v_mul_f32 v86, s31, v86
v_mfma_f32_16x16x32_bf16 a[172:175], a[16:19], v[72:75], a[172:175]
v_mul_f32 v87, s31, v87
v_mul_f32 v88, s31, v88
v_mfma_f32_16x16x32_bf16 a[204:207], a[16:19], v[76:79], a[204:207]
v_exp_f32 v84, v84
v_mfma_f32_16x16x32_bf16 v[148:151], a[20:23], v[56:59], v[148:151]
v_exp_f32 v85, v85
v_mfma_f32_16x16x32_bf16 v[180:183], a[20:23], v[60:63], v[180:183]
v_exp_f32 v86, v86
v_mfma_f32_16x16x32_bf16 v[212:215], a[20:23], v[64:67], v[212:215]
v_exp_f32 v87, v87
v_mfma_f32_16x16x32_bf16 v[244:247], a[20:23], v[68:71], v[244:247]
v_cvt_pk_bf16_f32 v38, v84, v85
v_cvt_pk_bf16_f32 v39, v86, v87
v_mfma_f32_16x16x32_bf16 a[176:179], a[20:23], v[72:75], a[176:179]
v_mul_f32 v89, s31, v89
v_mul_f32 v90, s31, v90
v_mfma_f32_16x16x32_bf16 a[208:211], a[20:23], v[76:79], a[208:211]
v_mul_f32 v91, s31, v91
v_mul_f32 v92, s31, v92
v_mfma_f32_16x16x32_bf16 v[152:155], a[24:27], v[56:59], v[152:155]
v_exp_f32 v88, v88
v_mfma_f32_16x16x32_bf16 v[184:187], a[24:27], v[60:63], v[184:187]
v_exp_f32 v89, v89
v_mfma_f32_16x16x32_bf16 v[216:219], a[24:27], v[64:67], v[216:219]
v_exp_f32 v90, v90
v_mfma_f32_16x16x32_bf16 v[248:251], a[24:27], v[68:71], v[248:251]
v_exp_f32 v91, v91
v_mfma_f32_16x16x32_bf16 a[180:183], a[24:27], v[72:75], a[180:183]
v_cvt_pk_bf16_f32 v42, v88, v89
v_cvt_pk_bf16_f32 v43, v90, v91
v_mfma_f32_16x16x32_bf16 a[212:215], a[24:27], v[76:79], a[212:215]
v_mul_f32 v93, s31, v93
v_mul_f32 v94, s31, v94
v_mfma_f32_16x16x32_bf16 v[156:159], a[28:31], v[56:59], v[156:159]
v_mul_f32 v95, s31, v95
v_mfma_f32_16x16x32_bf16 v[188:191], a[28:31], v[60:63], v[188:191]
v_exp_f32 v92, v92
v_mfma_f32_16x16x32_bf16 v[220:223], a[28:31], v[64:67], v[220:223]
v_exp_f32 v93, v93
v_mfma_f32_16x16x32_bf16 v[252:255], a[28:31], v[68:71], v[252:255]
v_exp_f32 v94, v94
v_mfma_f32_16x16x32_bf16 a[184:187], a[28:31], v[72:75], a[184:187]
v_exp_f32 v95, v95
v_mfma_f32_16x16x32_bf16 a[216:219], a[28:31], v[76:79], a[216:219]
v_cvt_pk_bf16_f32 v46, v92, v93
v_cvt_pk_bf16_f32 v47, v94, v95
s_waitcnt lgkmcnt(0)
ds_read_b128 a[16:19], v1 offset:13056
ds_read_b128 a[20:23], v1 offset:13120
v_mfma_f32_16x16x32_bf16 v[56:59], a[0:3], a[32:35], v[104:107]
v_mul_f32 v96, s31, v96
v_mul_f32 v97, s31, v97
v_mfma_f32_16x16x32_bf16 v[56:59], a[4:7], a[36:39], v[56:59]
v_mul_f32 v98, s31, v98
v_mul_f32 v99, s31, v99
v_mfma_f32_16x16x32_bf16 v[56:59], a[8:11], a[40:43], v[56:59]
ds_read_b128 a[24:27], v1 offset:13184
ds_read_b128 a[28:31], v1 offset:13248
v_mfma_f32_16x16x32_bf16 v[56:59], a[12:15], a[44:47], v[56:59]
v_exp_f32 v96, v96
v_mfma_f32_16x16x32_bf16 v[60:63], a[0:3], a[48:51], v[108:111]
v_exp_f32 v97, v97
v_mfma_f32_16x16x32_bf16 v[60:63], a[4:7], a[52:55], v[60:63]
v_exp_f32 v98, v98
v_mfma_f32_16x16x32_bf16 v[60:63], a[8:11], a[56:59], v[60:63]
ds_read_b128 v[20:23], v0 offset:16384
ds_read_b128 v[24:27], v0 offset:17408
ds_read_b128 v[28:31], v0 offset:18432
v_mfma_f32_16x16x32_bf16 v[60:63], a[12:15], a[60:63], v[60:63]
v_exp_f32 v99, v99
v_mfma_f32_16x16x32_bf16 v[64:67], a[0:3], a[64:67], v[112:115]
v_cvt_pk_bf16_f32 v50, v96, v97
v_cvt_pk_bf16_f32 v51, v98, v99
v_mfma_f32_16x16x32_bf16 v[64:67], a[4:7], a[68:71], v[64:67]
v_mul_f32 v100, s31, v100
v_mul_f32 v101, s31, v101
v_mfma_f32_16x16x32_bf16 v[64:67], a[8:11], a[72:75], v[64:67]
v_mul_f32 v102, s31, v102
v_mul_f32 v103, s31, v103
v_mfma_f32_16x16x32_bf16 v[64:67], a[12:15], a[76:79], v[64:67]
v_exp_f32 v100, v100
s_waitcnt vmcnt(14)
s_barrier
v_mfma_f32_16x16x32_bf16 v[68:71], a[0:3], a[80:83], v[116:119]
v_exp_f32 v101, v101
v_mfma_f32_16x16x32_bf16 v[68:71], a[4:7], a[84:87], v[68:71]
s_add_u32 m0, s37, 0
s_add_u32 s40, s32, 98304
buffer_load_dwordx4 v6, s[16:19], s40 offen nt lds
v_mfma_f32_16x16x32_bf16 v[68:71], a[8:11], a[88:91], v[68:71]
v_exp_f32 v102, v102
v_mfma_f32_16x16x32_bf16 v[68:71], a[12:15], a[92:95], v[68:71]
v_exp_f32 v103, v103
v_mfma_f32_16x16x32_bf16 v[72:75], a[0:3], a[96:99], v[120:123]
s_add_u32 m0, s37, 64
s_nop 0
buffer_load_dwordx4 v6, s[16:19], s40 offen offset:1024 nt lds
v_mfma_f32_16x16x32_bf16 v[72:75], a[4:7], a[100:103], v[72:75]
v_cvt_pk_bf16_f32 v54, v100, v101
v_cvt_pk_bf16_f32 v55, v102, v103
v_mfma_f32_16x16x32_bf16 v[72:75], a[8:11], a[104:107], v[72:75]
v_mul_f32 v56, s31, v56
v_mul_f32 v57, s31, v57
v_mfma_f32_16x16x32_bf16 v[72:75], a[12:15], a[108:111], v[72:75]
v_mul_f32 v58, s31, v58
v_mul_f32 v59, s31, v59
v_mfma_f32_16x16x32_bf16 v[76:79], a[0:3], a[112:115], v[124:127]
v_exp_f32 v56, v56
v_mfma_f32_16x16x32_bf16 v[76:79], a[4:7], a[116:119], v[76:79]
v_exp_f32 v57, v57
v_mfma_f32_16x16x32_bf16 v[76:79], a[8:11], a[120:123], v[76:79]
v_exp_f32 v58, v58
v_mfma_f32_16x16x32_bf16 v[76:79], a[12:15], a[124:127], v[76:79]
s_waitcnt lgkmcnt(3)
s_add_u32 s36, s45, 16384
s_waitcnt lgkmcnt(2)
buffer_store_dwordx4 v[20:23], v6, s[24:27], s36 offen offset:0
ds_read_b64_tr_b16 a[0:1], v2 offset:0
ds_read_b64_tr_b16 a[2:3], v2 offset:4128
v_mfma_f32_16x16x32_bf16 v[80:83], a[16:19], a[32:35], v[104:107]
v_exp_f32 v59, v59
v_mfma_f32_16x16x32_bf16 v[80:83], a[20:23], a[36:39], v[80:83]
v_cvt_pk_bf16_f32 v56, v56, v57
v_cvt_pk_bf16_f32 v57, v58, v59
v_mfma_f32_16x16x32_bf16 v[80:83], a[24:27], a[40:43], v[80:83]
ds_read_b64_tr_b16 a[4:5], v2 offset:8
ds_read_b64_tr_b16 a[6:7], v2 offset:4136
v_mfma_f32_16x16x32_bf16 v[80:83], a[28:31], a[44:47], v[80:83]
v_mul_f32 v60, s31, v60
v_mul_f32 v61, s31, v61
v_mfma_f32_16x16x32_bf16 v[84:87], a[16:19], a[48:51], v[108:111]
v_mul_f32 v62, s31, v62
v_mul_f32 v63, s31, v63
v_mfma_f32_16x16x32_bf16 v[84:87], a[20:23], a[52:55], v[84:87]
v_mfma_f32_16x16x32_bf16 v[84:87], a[24:27], a[56:59], v[84:87]
v_exp_f32 v60, v60
v_mfma_f32_16x16x32_bf16 v[84:87], a[28:31], a[60:63], v[84:87]
s_add_u32 s36, s45, 16384
s_waitcnt lgkmcnt(5)
buffer_store_dwordx4 v[24:27], v6, s[24:27], s36 offen offset:1024
ds_read_b64_tr_b16 a[8:9], v3 offset:0
ds_read_b64_tr_b16 a[10:11], v3 offset:4128
v_mfma_f32_16x16x32_bf16 v[88:91], a[16:19], a[64:67], v[112:115]
ds_read_b64_tr_b16 a[12:13], v3 offset:8
ds_read_b64_tr_b16 a[14:15], v3 offset:4136
v_mfma_f32_16x16x32_bf16 v[88:91], a[20:23], a[68:71], v[88:91]
v_exp_f32 v61, v61
v_mfma_f32_16x16x32_bf16 v[88:91], a[24:27], a[72:75], v[88:91]
v_exp_f32 v62, v62
v_mfma_f32_16x16x32_bf16 v[88:91], a[28:31], a[76:79], v[88:91]
s_add_u32 m0, s38, 24768
s_add_u32 s40, s32, 90112
buffer_load_dwordx4 v7, s[20:23], s40 offen nt lds
ds_read_b128 v[20:23], v0 offset:19456
v_mfma_f32_16x16x32_bf16 v[92:95], a[16:19], a[80:83], v[116:119]
v_exp_f32 v63, v63
v_mfma_f32_16x16x32_bf16 v[92:95], a[20:23], a[84:87], v[92:95]
v_cvt_pk_bf16_f32 v60, v60, v61
v_cvt_pk_bf16_f32 v61, v62, v63
v_mfma_f32_16x16x32_bf16 v[92:95], a[24:27], a[88:91], v[92:95]
s_add_u32 m0, s38, 24776
s_nop 0
buffer_load_dwordx4 v7, s[20:23], s40 offen offset:1024 nt lds
v_mfma_f32_16x16x32_bf16 v[92:95], a[28:31], a[92:95], v[92:95]
v_mul_f32 v64, s31, v64
v_mul_f32 v65, s31, v65
v_mfma_f32_16x16x32_bf16 v[96:99], a[16:19], a[96:99], v[120:123]
v_mul_f32 v66, s31, v66
v_mul_f32 v67, s31, v67
v_mfma_f32_16x16x32_bf16 v[96:99], a[20:23], a[100:103], v[96:99]
v_exp_f32 v64, v64
v_mfma_f32_16x16x32_bf16 v[96:99], a[24:27], a[104:107], v[96:99]
v_exp_f32 v65, v65
v_mfma_f32_16x16x32_bf16 v[96:99], a[28:31], a[108:111], v[96:99]
v_exp_f32 v66, v66
v_mfma_f32_16x16x32_bf16 v[100:103], a[16:19], a[112:115], v[124:127]
v_exp_f32 v67, v67
v_mfma_f32_16x16x32_bf16 v[100:103], a[20:23], a[116:119], v[100:103]
v_cvt_pk_bf16_f32 v64, v64, v65
v_cvt_pk_bf16_f32 v65, v66, v67
v_mfma_f32_16x16x32_bf16 v[100:103], a[24:27], a[120:123], v[100:103]
v_mul_f32 v68, s31, v68
v_mul_f32 v69, s31, v69
v_mfma_f32_16x16x32_bf16 v[100:103], a[28:31], a[124:127], v[100:103]
s_waitcnt lgkmcnt(1)
s_add_u32 s36, s45, 16384
buffer_store_dwordx4 v[28:31], v6, s[24:27], s36 offen offset:2048
ds_read_b64_tr_b16 a[16:17], v4 offset:0
ds_read_b64_tr_b16 a[18:19], v4 offset:4128
v_mfma_f32_16x16x32_bf16 a[132:135], a[128:131], v[32:35], a[132:135]
v_mul_f32 v70, s31, v70
v_mul_f32 v71, s31, v71
v_mfma_f32_16x16x32_bf16 a[136:139], a[128:131], v[36:39], a[136:139]
v_exp_f32 v68, v68
v_mfma_f32_16x16x32_bf16 a[140:143], a[128:131], v[40:43], a[140:143]
ds_read_b64_tr_b16 a[20:21], v4 offset:8
ds_read_b64_tr_b16 a[22:23], v4 offset:4136
v_mfma_f32_16x16x32_bf16 a[144:147], a[128:131], v[44:47], a[144:147]
v_exp_f32 v69, v69
v_mfma_f32_16x16x32_bf16 a[148:151], a[128:131], v[48:51], a[148:151]
v_exp_f32 v70, v70
v_mfma_f32_16x16x32_bf16 a[152:155], a[128:131], v[52:55], a[152:155]
v_exp_f32 v71, v71
v_mfma_f32_16x16x32_bf16 v[128:131], a[0:3], v[32:35], v[128:131]
v_cvt_pk_bf16_f32 v68, v68, v69
v_cvt_pk_bf16_f32 v69, v70, v71
v_mfma_f32_16x16x32_bf16 v[160:163], a[0:3], v[36:39], v[160:163]
s_add_u32 s36, s45, 16384
s_waitcnt lgkmcnt(4)
buffer_store_dwordx4 v[20:23], v6, s[24:27], s36 offen offset:3072
ds_read_b64_tr_b16 a[24:25], v5 offset:0
ds_read_b64_tr_b16 a[26:27], v5 offset:4128
v_mfma_f32_16x16x32_bf16 v[192:195], a[0:3], v[40:43], v[192:195]
v_mul_f32 v72, s31, v72
v_mul_f32 v73, s31, v73
v_mfma_f32_16x16x32_bf16 v[224:227], a[0:3], v[44:47], v[224:227]
v_mul_f32 v74, s31, v74
v_mul_f32 v75, s31, v75
v_mfma_f32_16x16x32_bf16 a[156:159], a[0:3], v[48:51], a[156:159]
ds_read_b64_tr_b16 a[28:29], v5 offset:8
ds_read_b64_tr_b16 a[30:31], v5 offset:4136
v_mfma_f32_16x16x32_bf16 a[188:191], a[0:3], v[52:55], a[188:191]
v_exp_f32 v72, v72
v_mfma_f32_16x16x32_bf16 v[132:135], a[4:7], v[32:35], v[132:135]
v_exp_f32 v73, v73
v_mfma_f32_16x16x32_bf16 v[164:167], a[4:7], v[36:39], v[164:167]
v_exp_f32 v74, v74
v_mfma_f32_16x16x32_bf16 v[196:199], a[4:7], v[40:43], v[196:199]
v_exp_f32 v75, v75
v_mfma_f32_16x16x32_bf16 v[228:231], a[4:7], v[44:47], v[228:231]
v_cvt_pk_bf16_f32 v72, v72, v73
v_cvt_pk_bf16_f32 v73, v74, v75
v_mfma_f32_16x16x32_bf16 a[160:163], a[4:7], v[48:51], a[160:163]
v_mul_f32 v76, s31, v76
v_mul_f32 v77, s31, v77
v_mfma_f32_16x16x32_bf16 a[192:195], a[4:7], v[52:55], a[192:195]
v_mul_f32 v78, s31, v78
v_mul_f32 v79, s31, v79
v_mfma_f32_16x16x32_bf16 v[136:139], a[8:11], v[32:35], v[136:139]
v_exp_f32 v76, v76
v_mfma_f32_16x16x32_bf16 v[168:171], a[8:11], v[36:39], v[168:171]
v_exp_f32 v77, v77
v_mfma_f32_16x16x32_bf16 v[200:203], a[8:11], v[40:43], v[200:203]
v_exp_f32 v78, v78
v_mfma_f32_16x16x32_bf16 v[232:235], a[8:11], v[44:47], v[232:235]
v_exp_f32 v79, v79
v_mfma_f32_16x16x32_bf16 a[164:167], a[8:11], v[48:51], a[164:167]
v_cvt_pk_bf16_f32 v76, v76, v77
v_cvt_pk_bf16_f32 v77, v78, v79
v_mfma_f32_16x16x32_bf16 a[196:199], a[8:11], v[52:55], a[196:199]
v_mul_f32 v80, s31, v80
v_mul_f32 v81, s31, v81
v_mfma_f32_16x16x32_bf16 v[140:143], a[12:15], v[32:35], v[140:143]
v_mul_f32 v82, s31, v82
v_mul_f32 v83, s31, v83
v_mfma_f32_16x16x32_bf16 v[172:175], a[12:15], v[36:39], v[172:175]
v_exp_f32 v80, v80
v_mfma_f32_16x16x32_bf16 v[204:207], a[12:15], v[40:43], v[204:207]
v_exp_f32 v81, v81
v_mfma_f32_16x16x32_bf16 v[236:239], a[12:15], v[44:47], v[236:239]
v_exp_f32 v82, v82
v_mfma_f32_16x16x32_bf16 a[168:171], a[12:15], v[48:51], a[168:171]
v_exp_f32 v83, v83
v_mfma_f32_16x16x32_bf16 a[200:203], a[12:15], v[52:55], a[200:203]
s_waitcnt lgkmcnt(0)
ds_read_b128 a[0:3], v1 offset:17408
ds_read_b128 a[4:7], v1 offset:17472
v_mfma_f32_16x16x32_bf16 v[144:147], a[16:19], v[32:35], v[144:147]
v_cvt_pk_bf16_f32 v58, v80, v81
v_cvt_pk_bf16_f32 v59, v82, v83
v_mfma_f32_16x16x32_bf16 v[176:179], a[16:19], v[36:39], v[176:179]
v_mul_f32 v84, s31, v84
v_mul_f32 v85, s31, v85
v_mfma_f32_16x16x32_bf16 v[208:211], a[16:19], v[40:43], v[208:211]
ds_read_b128 a[8:11], v1 offset:17536
ds_read_b128 a[12:15], v1 offset:17600
v_mfma_f32_16x16x32_bf16 v[240:243], a[16:19], v[44:47], v[240:243]
v_mul_f32 v86, s31, v86
v_mul_f32 v87, s31, v87
v_mfma_f32_16x16x32_bf16 a[172:175], a[16:19], v[48:51], a[172:175]
v_exp_f32 v84, v84
v_mfma_f32_16x16x32_bf16 a[204:207], a[16:19], v[52:55], a[204:207]
v_exp_f32 v85, v85
v_mfma_f32_16x16x32_bf16 v[148:151], a[20:23], v[32:35], v[148:151]
v_exp_f32 v86, v86
v_mfma_f32_16x16x32_bf16 v[180:183], a[20:23], v[36:39], v[180:183]
v_exp_f32 v87, v87
v_mfma_f32_16x16x32_bf16 v[212:215], a[20:23], v[40:43], v[212:215]
v_cvt_pk_bf16_f32 v62, v84, v85
v_cvt_pk_bf16_f32 v63, v86, v87
v_mfma_f32_16x16x32_bf16 v[244:247], a[20:23], v[44:47], v[244:247]
v_mul_f32 v88, s31, v88
v_mul_f32 v89, s31, v89
v_mfma_f32_16x16x32_bf16 a[176:179], a[20:23], v[48:51], a[176:179]
v_mul_f32 v90, s31, v90
v_mul_f32 v91, s31, v91
v_mfma_f32_16x16x32_bf16 a[208:211], a[20:23], v[52:55], a[208:211]
v_exp_f32 v88, v88
v_mfma_f32_16x16x32_bf16 v[152:155], a[24:27], v[32:35], v[152:155]
v_exp_f32 v89, v89
v_mfma_f32_16x16x32_bf16 v[184:187], a[24:27], v[36:39], v[184:187]
v_exp_f32 v90, v90
v_mfma_f32_16x16x32_bf16 v[216:219], a[24:27], v[40:43], v[216:219]
v_exp_f32 v91, v91
v_mfma_f32_16x16x32_bf16 v[248:251], a[24:27], v[44:47], v[248:251]
v_cvt_pk_bf16_f32 v66, v88, v89
v_cvt_pk_bf16_f32 v67, v90, v91
v_mfma_f32_16x16x32_bf16 a[180:183], a[24:27], v[48:51], a[180:183]
v_mul_f32 v92, s31, v92
v_mul_f32 v93, s31, v93
v_mfma_f32_16x16x32_bf16 a[212:215], a[24:27], v[52:55], a[212:215]
v_mul_f32 v94, s31, v94
v_mul_f32 v95, s31, v95
v_mfma_f32_16x16x32_bf16 v[156:159], a[28:31], v[32:35], v[156:159]
v_exp_f32 v92, v92
v_mfma_f32_16x16x32_bf16 v[188:191], a[28:31], v[36:39], v[188:191]
v_exp_f32 v93, v93
v_mfma_f32_16x16x32_bf16 v[220:223], a[28:31], v[40:43], v[220:223]
v_exp_f32 v94, v94
v_mfma_f32_16x16x32_bf16 v[252:255], a[28:31], v[44:47], v[252:255]
v_exp_f32 v95, v95
v_mfma_f32_16x16x32_bf16 a[184:187], a[28:31], v[48:51], a[184:187]
v_cvt_pk_bf16_f32 v70, v92, v93
v_cvt_pk_bf16_f32 v71, v94, v95
v_mfma_f32_16x16x32_bf16 a[216:219], a[28:31], v[52:55], a[216:219]
s_waitcnt lgkmcnt(0)
ds_read_b128 a[16:19], v1 offset:21760
ds_read_b128 a[20:23], v1 offset:21824
v_mfma_f32_16x16x32_bf16 v[32:35], a[0:3], a[32:35], v[104:107]
v_mul_f32 v96, s31, v96
v_mul_f32 v97, s31, v97
v_mfma_f32_16x16x32_bf16 v[32:35], a[4:7], a[36:39], v[32:35]
v_mul_f32 v98, s31, v98
v_mul_f32 v99, s31, v99
v_mfma_f32_16x16x32_bf16 v[32:35], a[8:11], a[40:43], v[32:35]
ds_read_b128 a[24:27], v1 offset:21888
ds_read_b128 a[28:31], v1 offset:21952
v_mfma_f32_16x16x32_bf16 v[32:35], a[12:15], a[44:47], v[32:35]
v_exp_f32 v96, v96
v_mfma_f32_16x16x32_bf16 v[36:39], a[0:3], a[48:51], v[108:111]
v_exp_f32 v97, v97
v_mfma_f32_16x16x32_bf16 v[36:39], a[4:7], a[52:55], v[36:39]
v_exp_f32 v98, v98
v_mfma_f32_16x16x32_bf16 v[36:39], a[8:11], a[56:59], v[36:39]
v_exp_f32 v99, v99
v_mfma_f32_16x16x32_bf16 v[36:39], a[12:15], a[60:63], v[36:39]
v_cvt_pk_bf16_f32 v74, v96, v97
v_cvt_pk_bf16_f32 v75, v98, v99
v_mfma_f32_16x16x32_bf16 v[40:43], a[0:3], a[64:67], v[112:115]
v_mul_f32 v100, s31, v100
v_mul_f32 v101, s31, v101
v_mfma_f32_16x16x32_bf16 v[40:43], a[4:7], a[68:71], v[40:43]
v_mul_f32 v102, s31, v102
v_mul_f32 v103, s31, v103
v_mfma_f32_16x16x32_bf16 v[40:43], a[8:11], a[72:75], v[40:43]
v_exp_f32 v100, v100
v_mfma_f32_16x16x32_bf16 v[40:43], a[12:15], a[76:79], v[40:43]
v_exp_f32 v101, v101
s_waitcnt vmcnt(14)
s_barrier
v_mfma_f32_16x16x32_bf16 v[44:47], a[0:3], a[80:83], v[116:119]
v_exp_f32 v102, v102
v_mfma_f32_16x16x32_bf16 v[44:47], a[4:7], a[84:87], v[44:47]
s_add_u32 m0, s37, 8704
s_add_u32 s40, s32, 106496
buffer_load_dwordx4 v6, s[16:19], s40 offen nt lds
v_mfma_f32_16x16x32_bf16 v[44:47], a[8:11], a[88:91], v[44:47]
v_exp_f32 v103, v103
v_mfma_f32_16x16x32_bf16 v[44:47], a[12:15], a[92:95], v[44:47]
v_cvt_pk_bf16_f32 v78, v100, v101
v_cvt_pk_bf16_f32 v79, v102, v103
v_mfma_f32_16x16x32_bf16 v[48:51], a[0:3], a[96:99], v[120:123]
s_add_u32 m0, s37, 8768
s_nop 0
buffer_load_dwordx4 v6, s[16:19], s40 offen offset:1024 nt lds
v_mfma_f32_16x16x32_bf16 v[48:51], a[4:7], a[100:103], v[48:51]
v_xor_b32 v12, 64, v6
v_xor_b32 v13, 128, v6
v_mfma_f32_16x16x32_bf16 v[48:51], a[8:11], a[104:107], v[48:51]
v_xor_b32 v28, 192, v6
v_mul_f32 v32, s31, v32
v_mfma_f32_16x16x32_bf16 v[48:51], a[12:15], a[108:111], v[48:51]
v_mul_f32 v33, s31, v33
v_mul_f32 v34, s31, v34
v_mfma_f32_16x16x32_bf16 v[52:55], a[0:3], a[112:115], v[124:127]
v_mul_f32 v35, s31, v35
v_mul_f32 v36, s31, v36
v_mfma_f32_16x16x32_bf16 v[52:55], a[4:7], a[116:119], v[52:55]
v_exp_f32 v32, v32
v_mfma_f32_16x16x32_bf16 v[52:55], a[8:11], a[120:123], v[52:55]
v_exp_f32 v33, v33
v_mfma_f32_16x16x32_bf16 v[52:55], a[12:15], a[124:127], v[52:55]
s_waitcnt lgkmcnt(0)
ds_read_b64_tr_b16 a[0:1], v2 offset:8256
ds_read_b64_tr_b16 a[2:3], v2 offset:12384
v_mfma_f32_16x16x32_bf16 v[80:83], a[16:19], a[32:35], v[104:107]
v_exp_f32 v34, v34
v_mfma_f32_16x16x32_bf16 v[80:83], a[20:23], a[36:39], v[80:83]
v_exp_f32 v35, v35
v_mfma_f32_16x16x32_bf16 v[80:83], a[24:27], a[40:43], v[80:83]
ds_read_b64_tr_b16 a[4:5], v2 offset:8264
ds_read_b64_tr_b16 a[6:7], v2 offset:12392
v_mfma_f32_16x16x32_bf16 v[80:83], a[28:31], a[44:47], v[80:83]
v_cvt_pk_bf16_f32 v32, v32, v33
v_cvt_pk_bf16_f32 v33, v34, v35
v_mfma_f32_16x16x32_bf16 v[84:87], a[16:19], a[48:51], v[108:111]
v_mul_f32 v37, s31, v37
v_mul_f32 v38, s31, v38
v_mfma_f32_16x16x32_bf16 v[84:87], a[20:23], a[52:55], v[84:87]
ds_read_b64_tr_b16 a[8:9], v3 offset:8256
ds_read_b64_tr_b16 a[10:11], v3 offset:12384
v_mfma_f32_16x16x32_bf16 v[84:87], a[24:27], a[56:59], v[84:87]
v_mul_f32 v39, s31, v39
v_mul_f32 v40, s31, v40
v_mfma_f32_16x16x32_bf16 v[84:87], a[28:31], a[60:63], v[84:87]
v_exp_f32 v36, v36
v_mfma_f32_16x16x32_bf16 v[88:91], a[16:19], a[64:67], v[112:115]
ds_read_b64_tr_b16 a[12:13], v3 offset:8264
ds_read_b64_tr_b16 a[14:15], v3 offset:12392
v_mfma_f32_16x16x32_bf16 v[88:91], a[20:23], a[68:71], v[88:91]
v_exp_f32 v37, v37
v_mfma_f32_16x16x32_bf16 v[88:91], a[24:27], a[72:75], v[88:91]
v_exp_f32 v38, v38
v_mfma_f32_16x16x32_bf16 v[88:91], a[28:31], a[76:79], v[88:91]
s_add_u32 m0, s38, 0
s_add_u32 s40, s32, 98304
buffer_load_dwordx4 v7, s[20:23], s40 offen nt lds
v_mfma_f32_16x16x32_bf16 v[92:95], a[16:19], a[80:83], v[116:119]
v_exp_f32 v39, v39
v_mfma_f32_16x16x32_bf16 v[92:95], a[20:23], a[84:87], v[92:95]
v_cvt_pk_bf16_f32 v36, v36, v37
v_cvt_pk_bf16_f32 v37, v38, v39
v_mfma_f32_16x16x32_bf16 v[92:95], a[24:27], a[88:91], v[92:95]
s_add_u32 m0, s38, 8
s_nop 0
buffer_load_dwordx4 v7, s[20:23], s40 offen offset:1024 nt lds
v_mfma_f32_16x16x32_bf16 v[92:95], a[28:31], a[92:95], v[92:95]
v_mul_f32 v41, s31, v41
v_mul_f32 v42, s31, v42
v_mfma_f32_16x16x32_bf16 v[96:99], a[16:19], a[96:99], v[120:123]
v_mul_f32 v43, s31, v43
v_mul_f32 v44, s31, v44
v_mfma_f32_16x16x32_bf16 v[96:99], a[20:23], a[100:103], v[96:99]
v_exp_f32 v40, v40
v_mfma_f32_16x16x32_bf16 v[96:99], a[24:27], a[104:107], v[96:99]
v_exp_f32 v41, v41
v_mfma_f32_16x16x32_bf16 v[96:99], a[28:31], a[108:111], v[96:99]
v_exp_f32 v42, v42
v_mfma_f32_16x16x32_bf16 v[100:103], a[16:19], a[112:115], v[124:127]
v_exp_f32 v43, v43
v_mfma_f32_16x16x32_bf16 v[100:103], a[20:23], a[116:119], v[100:103]
v_cvt_pk_bf16_f32 v40, v40, v41
v_cvt_pk_bf16_f32 v41, v42, v43
v_mfma_f32_16x16x32_bf16 v[100:103], a[24:27], a[120:123], v[100:103]
v_mul_f32 v45, s31, v45
v_mul_f32 v46, s31, v46
v_mfma_f32_16x16x32_bf16 v[100:103], a[28:31], a[124:127], v[100:103]
s_waitcnt lgkmcnt(0)
ds_read_b64_tr_b16 a[16:17], v4 offset:8256
ds_read_b64_tr_b16 a[18:19], v4 offset:12384
v_mfma_f32_16x16x32_bf16 a[132:135], a[128:131], v[56:59], a[132:135]
v_mul_f32 v47, s31, v47
v_mul_f32 v48, s31, v48
v_mfma_f32_16x16x32_bf16 a[136:139], a[128:131], v[60:63], a[136:139]
v_exp_f32 v44, v44
v_mfma_f32_16x16x32_bf16 a[140:143], a[128:131], v[64:67], a[140:143]
ds_read_b64_tr_b16 a[20:21], v4 offset:8264
ds_read_b64_tr_b16 a[22:23], v4 offset:12392
v_mfma_f32_16x16x32_bf16 a[144:147], a[128:131], v[68:71], a[144:147]
v_exp_f32 v45, v45
v_mfma_f32_16x16x32_bf16 a[148:151], a[128:131], v[72:75], a[148:151]
v_exp_f32 v46, v46
v_mfma_f32_16x16x32_bf16 a[152:155], a[128:131], v[76:79], a[152:155]
v_exp_f32 v47, v47
v_mfma_f32_16x16x32_bf16 v[128:131], a[0:3], v[56:59], v[128:131]
v_cvt_pk_bf16_f32 v44, v44, v45
v_cvt_pk_bf16_f32 v45, v46, v47
v_mfma_f32_16x16x32_bf16 v[160:163], a[0:3], v[60:63], v[160:163]
ds_read_b64_tr_b16 a[24:25], v5 offset:8256
ds_read_b64_tr_b16 a[26:27], v5 offset:12384
v_mfma_f32_16x16x32_bf16 v[192:195], a[0:3], v[64:67], v[192:195]
v_mul_f32 v49, s31, v49
v_mul_f32 v50, s31, v50
v_mfma_f32_16x16x32_bf16 v[224:227], a[0:3], v[68:71], v[224:227]
v_mul_f32 v51, s31, v51
v_mul_f32 v52, s31, v52
v_mfma_f32_16x16x32_bf16 a[156:159], a[0:3], v[72:75], a[156:159]
ds_read_b64_tr_b16 a[28:29], v5 offset:8264
ds_read_b64_tr_b16 a[30:31], v5 offset:12392
v_mfma_f32_16x16x32_bf16 a[188:191], a[0:3], v[76:79], a[188:191]
v_exp_f32 v48, v48
v_mfma_f32_16x16x32_bf16 v[132:135], a[4:7], v[56:59], v[132:135]
v_exp_f32 v49, v49
v_mfma_f32_16x16x32_bf16 v[164:167], a[4:7], v[60:63], v[164:167]
v_exp_f32 v50, v50
v_mfma_f32_16x16x32_bf16 v[196:199], a[4:7], v[64:67], v[196:199]
v_exp_f32 v51, v51
v_mfma_f32_16x16x32_bf16 v[228:231], a[4:7], v[68:71], v[228:231]
s_add_u32 m0, s39, 12288
s_add_u32 s41, s34, 12288
buffer_load_dwordx4 v6, s[12:15], s41 offen offset:0 nt lds
buffer_load_dwordx4 v12, s[12:15], s41 offen offset:1024 nt lds
buffer_load_dwordx4 v13, s[12:15], s41 offen offset:2048 nt lds
buffer_load_dwordx4 v28, s[12:15], s41 offen offset:3072 nt lds
v_mfma_f32_16x16x32_bf16 a[160:163], a[4:7], v[72:75], a[160:163]
v_cvt_pk_bf16_f32 v48, v48, v49
v_cvt_pk_bf16_f32 v49, v50, v51
v_mfma_f32_16x16x32_bf16 a[192:195], a[4:7], v[76:79], a[192:195]
v_mul_f32 v53, s31, v53
v_mul_f32 v54, s31, v54
v_mfma_f32_16x16x32_bf16 v[136:139], a[8:11], v[56:59], v[136:139]
v_mul_f32 v55, s31, v55
v_mul_f32 v80, s31, v80
v_mfma_f32_16x16x32_bf16 v[168:171], a[8:11], v[60:63], v[168:171]
v_exp_f32 v52, v52
v_mfma_f32_16x16x32_bf16 v[200:203], a[8:11], v[64:67], v[200:203]
v_exp_f32 v53, v53
v_mfma_f32_16x16x32_bf16 v[232:235], a[8:11], v[68:71], v[232:235]
v_exp_f32 v54, v54
v_mfma_f32_16x16x32_bf16 a[164:167], a[8:11], v[72:75], a[164:167]
v_exp_f32 v55, v55
v_mfma_f32_16x16x32_bf16 a[196:199], a[8:11], v[76:79], a[196:199]
v_cvt_pk_bf16_f32 v52, v52, v53
v_cvt_pk_bf16_f32 v53, v54, v55
v_mfma_f32_16x16x32_bf16 v[140:143], a[12:15], v[56:59], v[140:143]
v_mul_f32 v81, s31, v81
v_mul_f32 v82, s31, v82
v_mfma_f32_16x16x32_bf16 v[172:175], a[12:15], v[60:63], v[172:175]
v_mul_f32 v83, s31, v83
v_mul_f32 v84, s31, v84
v_mfma_f32_16x16x32_bf16 v[204:207], a[12:15], v[64:67], v[204:207]
v_exp_f32 v80, v80
v_mfma_f32_16x16x32_bf16 v[236:239], a[12:15], v[68:71], v[236:239]
v_exp_f32 v81, v81
v_mfma_f32_16x16x32_bf16 a[168:171], a[12:15], v[72:75], a[168:171]
v_exp_f32 v82, v82
v_mfma_f32_16x16x32_bf16 a[200:203], a[12:15], v[76:79], a[200:203]
s_waitcnt lgkmcnt(0)
ds_read_b128 a[0:3], v1 offset:26112
ds_read_b128 a[4:7], v1 offset:26176
v_mfma_f32_16x16x32_bf16 v[144:147], a[16:19], v[56:59], v[144:147]
v_exp_f32 v83, v83
v_mfma_f32_16x16x32_bf16 v[176:179], a[16:19], v[60:63], v[176:179]
v_cvt_pk_bf16_f32 v34, v80, v81
v_cvt_pk_bf16_f32 v35, v82, v83
v_mfma_f32_16x16x32_bf16 v[208:211], a[16:19], v[64:67], v[208:211]
ds_read_b128 a[8:11], v1 offset:26240
ds_read_b128 a[12:15], v1 offset:26304
v_mfma_f32_16x16x32_bf16 v[240:243], a[16:19], v[68:71], v[240:243]
v_mul_f32 v85, s31, v85
v_mul_f32 v86, s31, v86
v_mfma_f32_16x16x32_bf16 a[172:175], a[16:19], v[72:75], a[172:175]
v_mul_f32 v87, s31, v87
v_mul_f32 v88, s31, v88
v_mfma_f32_16x16x32_bf16 a[204:207], a[16:19], v[76:79], a[204:207]
v_exp_f32 v84, v84
v_mfma_f32_16x16x32_bf16 v[148:151], a[20:23], v[56:59], v[148:151]
v_exp_f32 v85, v85
v_mfma_f32_16x16x32_bf16 v[180:183], a[20:23], v[60:63], v[180:183]
v_exp_f32 v86, v86
v_mfma_f32_16x16x32_bf16 v[212:215], a[20:23], v[64:67], v[212:215]
v_exp_f32 v87, v87
v_mfma_f32_16x16x32_bf16 v[244:247], a[20:23], v[68:71], v[244:247]
v_cvt_pk_bf16_f32 v38, v84, v85
v_cvt_pk_bf16_f32 v39, v86, v87
v_mfma_f32_16x16x32_bf16 a[176:179], a[20:23], v[72:75], a[176:179]
v_mul_f32 v89, s31, v89
v_mul_f32 v90, s31, v90
v_mfma_f32_16x16x32_bf16 a[208:211], a[20:23], v[76:79], a[208:211]
v_mul_f32 v91, s31, v91
v_mul_f32 v92, s31, v92
v_mfma_f32_16x16x32_bf16 v[152:155], a[24:27], v[56:59], v[152:155]
v_exp_f32 v88, v88
v_mfma_f32_16x16x32_bf16 v[184:187], a[24:27], v[60:63], v[184:187]
v_exp_f32 v89, v89
v_mfma_f32_16x16x32_bf16 v[216:219], a[24:27], v[64:67], v[216:219]
v_exp_f32 v90, v90
v_mfma_f32_16x16x32_bf16 v[248:251], a[24:27], v[68:71], v[248:251]
v_exp_f32 v91, v91
v_mfma_f32_16x16x32_bf16 a[180:183], a[24:27], v[72:75], a[180:183]
v_cvt_pk_bf16_f32 v42, v88, v89
v_cvt_pk_bf16_f32 v43, v90, v91
v_mfma_f32_16x16x32_bf16 a[212:215], a[24:27], v[76:79], a[212:215]
v_mul_f32 v93, s31, v93
v_mul_f32 v94, s31, v94
v_mfma_f32_16x16x32_bf16 v[156:159], a[28:31], v[56:59], v[156:159]
v_mul_f32 v95, s31, v95
v_mfma_f32_16x16x32_bf16 v[188:191], a[28:31], v[60:63], v[188:191]
v_exp_f32 v92, v92
v_mfma_f32_16x16x32_bf16 v[220:223], a[28:31], v[64:67], v[220:223]
v_exp_f32 v93, v93
v_mfma_f32_16x16x32_bf16 v[252:255], a[28:31], v[68:71], v[252:255]
v_exp_f32 v94, v94
v_mfma_f32_16x16x32_bf16 a[184:187], a[28:31], v[72:75], a[184:187]
v_exp_f32 v95, v95
v_mfma_f32_16x16x32_bf16 a[216:219], a[28:31], v[76:79], a[216:219]
v_cvt_pk_bf16_f32 v46, v92, v93
v_cvt_pk_bf16_f32 v47, v94, v95
s_waitcnt lgkmcnt(0)
ds_read_b128 a[16:19], v1 offset:30464
ds_read_b128 a[20:23], v1 offset:30528
v_mfma_f32_16x16x32_bf16 v[56:59], a[0:3], a[32:35], v[104:107]
v_mul_f32 v96, s31, v96
v_mul_f32 v97, s31, v97
v_mfma_f32_16x16x32_bf16 v[56:59], a[4:7], a[36:39], v[56:59]
v_mul_f32 v98, s31, v98
v_mul_f32 v99, s31, v99
v_mfma_f32_16x16x32_bf16 v[56:59], a[8:11], a[40:43], v[56:59]
ds_read_b128 a[24:27], v1 offset:30592
ds_read_b128 a[28:31], v1 offset:30656
v_mfma_f32_16x16x32_bf16 v[56:59], a[12:15], a[44:47], v[56:59]
v_exp_f32 v96, v96
v_mfma_f32_16x16x32_bf16 v[60:63], a[0:3], a[48:51], v[108:111]
v_exp_f32 v97, v97
v_mfma_f32_16x16x32_bf16 v[60:63], a[4:7], a[52:55], v[60:63]
v_exp_f32 v98, v98
v_mfma_f32_16x16x32_bf16 v[60:63], a[8:11], a[56:59], v[60:63]
v_exp_f32 v99, v99
v_mfma_f32_16x16x32_bf16 v[60:63], a[12:15], a[60:63], v[60:63]
v_cvt_pk_bf16_f32 v50, v96, v97
v_cvt_pk_bf16_f32 v51, v98, v99
v_mfma_f32_16x16x32_bf16 v[64:67], a[0:3], a[64:67], v[112:115]
v_mul_f32 v100, s31, v100
v_mul_f32 v101, s31, v101
v_mfma_f32_16x16x32_bf16 v[64:67], a[4:7], a[68:71], v[64:67]
v_mul_f32 v102, s31, v102
v_mul_f32 v103, s31, v103
v_mfma_f32_16x16x32_bf16 v[64:67], a[8:11], a[72:75], v[64:67]
v_exp_f32 v100, v100
v_mfma_f32_16x16x32_bf16 v[64:67], a[12:15], a[76:79], v[64:67]
v_exp_f32 v101, v101
s_waitcnt vmcnt(14)
s_barrier
v_mfma_f32_16x16x32_bf16 v[68:71], a[0:3], a[80:83], v[116:119]
v_exp_f32 v102, v102
v_mfma_f32_16x16x32_bf16 v[68:71], a[4:7], a[84:87], v[68:71]
s_add_u32 m0, s37, 17408
s_add_u32 s40, s32, 114688
buffer_load_dwordx4 v6, s[16:19], s40 offen nt lds
v_mfma_f32_16x16x32_bf16 v[68:71], a[8:11], a[88:91], v[68:71]
v_exp_f32 v103, v103
v_mfma_f32_16x16x32_bf16 v[68:71], a[12:15], a[92:95], v[68:71]
v_cvt_pk_bf16_f32 v54, v100, v101
v_cvt_pk_bf16_f32 v55, v102, v103
v_mfma_f32_16x16x32_bf16 v[72:75], a[0:3], a[96:99], v[120:123]
s_add_u32 m0, s37, 17472
s_nop 0
buffer_load_dwordx4 v6, s[16:19], s40 offen offset:1024 nt lds
v_mfma_f32_16x16x32_bf16 v[72:75], a[4:7], a[100:103], v[72:75]
v_mul_f32 v56, s31, v56
v_mul_f32 v57, s31, v57
v_mfma_f32_16x16x32_bf16 v[72:75], a[8:11], a[104:107], v[72:75]
v_mul_f32 v58, s31, v58
v_mul_f32 v59, s31, v59
v_mfma_f32_16x16x32_bf16 v[72:75], a[12:15], a[108:111], v[72:75]
v_exp_f32 v56, v56
v_mfma_f32_16x16x32_bf16 v[76:79], a[0:3], a[112:115], v[124:127]
v_exp_f32 v57, v57
v_mfma_f32_16x16x32_bf16 v[76:79], a[4:7], a[116:119], v[76:79]
v_exp_f32 v58, v58
v_mfma_f32_16x16x32_bf16 v[76:79], a[8:11], a[120:123], v[76:79]
v_exp_f32 v59, v59
v_mfma_f32_16x16x32_bf16 v[76:79], a[12:15], a[124:127], v[76:79]
s_waitcnt lgkmcnt(0)
ds_read_b64_tr_b16 a[0:1], v2 offset:16512
ds_read_b64_tr_b16 a[2:3], v2 offset:20640
v_mfma_f32_16x16x32_bf16 v[80:83], a[16:19], a[32:35], v[104:107]
v_cvt_pk_bf16_f32 v56, v56, v57
v_cvt_pk_bf16_f32 v57, v58, v59
v_mfma_f32_16x16x32_bf16 v[80:83], a[20:23], a[36:39], v[80:83]
v_mul_f32 v60, s31, v60
v_mul_f32 v61, s31, v61
v_mfma_f32_16x16x32_bf16 v[80:83], a[24:27], a[40:43], v[80:83]
ds_read_b64_tr_b16 a[4:5], v2 offset:16520
ds_read_b64_tr_b16 a[6:7], v2 offset:20648
v_mfma_f32_16x16x32_bf16 v[80:83], a[28:31], a[44:47], v[80:83]
v_mul_f32 v62, s31, v62
v_mul_f32 v63, s31, v63
v_mfma_f32_16x16x32_bf16 v[84:87], a[16:19], a[48:51], v[108:111]
v_exp_f32 v60, v60
v_mfma_f32_16x16x32_bf16 v[84:87], a[20:23], a[52:55], v[84:87]
ds_read_b64_tr_b16 a[8:9], v3 offset:16512
ds_read_b64_tr_b16 a[10:11], v3 offset:20640
v_mfma_f32_16x16x32_bf16 v[84:87], a[24:27], a[56:59], v[84:87]
v_exp_f32 v61, v61
v_mfma_f32_16x16x32_bf16 v[84:87], a[28:31], a[60:63], v[84:87]
v_exp_f32 v62, v62
v_mfma_f32_16x16x32_bf16 v[88:91], a[16:19], a[64:67], v[112:115]
ds_read_b64_tr_b16 a[12:13], v3 offset:16520
ds_read_b64_tr_b16 a[14:15], v3 offset:20648
v_mfma_f32_16x16x32_bf16 v[88:91], a[20:23], a[68:71], v[88:91]
v_exp_f32 v63, v63
v_mfma_f32_16x16x32_bf16 v[88:91], a[24:27], a[72:75], v[88:91]
v_cvt_pk_bf16_f32 v60, v60, v61
v_cvt_pk_bf16_f32 v61, v62, v63
v_mfma_f32_16x16x32_bf16 v[88:91], a[28:31], a[76:79], v[88:91]
s_add_u32 m0, s38, 8256
s_add_u32 s40, s32, 106496
buffer_load_dwordx4 v7, s[20:23], s40 offen nt lds
v_mfma_f32_16x16x32_bf16 v[92:95], a[16:19], a[80:83], v[116:119]
v_mul_f32 v64, s31, v64
v_mul_f32 v65, s31, v65
v_mfma_f32_16x16x32_bf16 v[92:95], a[20:23], a[84:87], v[92:95]
v_mul_f32 v66, s31, v66
v_mul_f32 v67, s31, v67
v_mfma_f32_16x16x32_bf16 v[92:95], a[24:27], a[88:91], v[92:95]
s_add_u32 m0, s38, 8264
s_nop 0
buffer_load_dwordx4 v7, s[20:23], s40 offen offset:1024 nt lds
v_mfma_f32_16x16x32_bf16 v[92:95], a[28:31], a[92:95], v[92:95]
v_exp_f32 v64, v64
v_mfma_f32_16x16x32_bf16 v[96:99], a[16:19], a[96:99], v[120:123]
v_exp_f32 v65, v65
v_mfma_f32_16x16x32_bf16 v[96:99], a[20:23], a[100:103], v[96:99]
v_exp_f32 v66, v66
v_mfma_f32_16x16x32_bf16 v[96:99], a[24:27], a[104:107], v[96:99]
v_exp_f32 v67, v67
v_mfma_f32_16x16x32_bf16 v[96:99], a[28:31], a[108:111], v[96:99]
v_cvt_pk_bf16_f32 v64, v64, v65
v_cvt_pk_bf16_f32 v65, v66, v67
v_mfma_f32_16x16x32_bf16 v[100:103], a[16:19], a[112:115], v[124:127]
v_mul_f32 v68, s31, v68
v_mul_f32 v69, s31, v69
v_mfma_f32_16x16x32_bf16 v[100:103], a[20:23], a[116:119], v[100:103]
v_mul_f32 v70, s31, v70
v_mul_f32 v71, s31, v71
v_mfma_f32_16x16x32_bf16 v[100:103], a[24:27], a[120:123], v[100:103]
v_exp_f32 v68, v68
v_mfma_f32_16x16x32_bf16 v[100:103], a[28:31], a[124:127], v[100:103]
s_waitcnt lgkmcnt(0)
ds_read_b64_tr_b16 a[16:17], v4 offset:16512
ds_read_b64_tr_b16 a[18:19], v4 offset:20640
v_mfma_f32_16x16x32_bf16 a[132:135], a[128:131], v[32:35], a[132:135]
v_exp_f32 v69, v69
v_mfma_f32_16x16x32_bf16 a[136:139], a[128:131], v[36:39], a[136:139]
v_exp_f32 v70, v70
v_mfma_f32_16x16x32_bf16 a[140:143], a[128:131], v[40:43], a[140:143]
ds_read_b64_tr_b16 a[20:21], v4 offset:16520
ds_read_b64_tr_b16 a[22:23], v4 offset:20648
v_mfma_f32_16x16x32_bf16 a[144:147], a[128:131], v[44:47], a[144:147]
v_exp_f32 v71, v71
v_mfma_f32_16x16x32_bf16 a[148:151], a[128:131], v[48:51], a[148:151]
v_cvt_pk_bf16_f32 v68, v68, v69
v_cvt_pk_bf16_f32 v69, v70, v71
v_mfma_f32_16x16x32_bf16 a[152:155], a[128:131], v[52:55], a[152:155]
v_mul_f32 v72, s31, v72
v_mul_f32 v73, s31, v73
v_mfma_f32_16x16x32_bf16 v[128:131], a[0:3], v[32:35], v[128:131]
v_mul_f32 v74, s31, v74
v_mul_f32 v75, s31, v75
v_mfma_f32_16x16x32_bf16 v[160:163], a[0:3], v[36:39], v[160:163]
ds_read_b64_tr_b16 a[24:25], v5 offset:16512
ds_read_b64_tr_b16 a[26:27], v5 offset:20640
v_mfma_f32_16x16x32_bf16 v[192:195], a[0:3], v[40:43], v[192:195]
v_exp_f32 v72, v72
v_mfma_f32_16x16x32_bf16 v[224:227], a[0:3], v[44:47], v[224:227]
v_exp_f32 v73, v73
v_mfma_f32_16x16x32_bf16 a[156:159], a[0:3], v[48:51], a[156:159]
ds_read_b64_tr_b16 a[28:29], v5 offset:16520
ds_read_b64_tr_b16 a[30:31], v5 offset:20648
v_mfma_f32_16x16x32_bf16 a[188:191], a[0:3], v[52:55], a[188:191]
v_exp_f32 v74, v74
v_mfma_f32_16x16x32_bf16 v[132:135], a[4:7], v[32:35], v[132:135]
v_exp_f32 v75, v75
v_mfma_f32_16x16x32_bf16 v[164:167], a[4:7], v[36:39], v[164:167]
v_cvt_pk_bf16_f32 v72, v72, v73
v_cvt_pk_bf16_f32 v73, v74, v75
v_mfma_f32_16x16x32_bf16 v[196:199], a[4:7], v[40:43], v[196:199]
v_mul_f32 v76, s31, v76
v_mul_f32 v77, s31, v77
v_mfma_f32_16x16x32_bf16 v[228:231], a[4:7], v[44:47], v[228:231]
v_mul_f32 v78, s31, v78
v_mul_f32 v79, s31, v79
v_mfma_f32_16x16x32_bf16 a[160:163], a[4:7], v[48:51], a[160:163]
v_exp_f32 v76, v76
v_mfma_f32_16x16x32_bf16 a[192:195], a[4:7], v[52:55], a[192:195]
v_exp_f32 v77, v77
v_mfma_f32_16x16x32_bf16 v[136:139], a[8:11], v[32:35], v[136:139]
v_exp_f32 v78, v78
v_mfma_f32_16x16x32_bf16 v[168:171], a[8:11], v[36:39], v[168:171]
v_exp_f32 v79, v79
v_mfma_f32_16x16x32_bf16 v[200:203], a[8:11], v[40:43], v[200:203]
v_cvt_pk_bf16_f32 v76, v76, v77
v_cvt_pk_bf16_f32 v77, v78, v79
v_mfma_f32_16x16x32_bf16 v[232:235], a[8:11], v[44:47], v[232:235]
v_mul_f32 v80, s31, v80
v_mul_f32 v81, s31, v81
v_mfma_f32_16x16x32_bf16 a[164:167], a[8:11], v[48:51], a[164:167]
v_mul_f32 v82, s31, v82
v_mul_f32 v83, s31, v83
v_mfma_f32_16x16x32_bf16 a[196:199], a[8:11], v[52:55], a[196:199]
v_exp_f32 v80, v80
v_mfma_f32_16x16x32_bf16 v[140:143], a[12:15], v[32:35], v[140:143]
v_exp_f32 v81, v81
v_mfma_f32_16x16x32_bf16 v[172:175], a[12:15], v[36:39], v[172:175]
v_exp_f32 v82, v82
v_mfma_f32_16x16x32_bf16 v[204:207], a[12:15], v[40:43], v[204:207]
v_exp_f32 v83, v83
v_mfma_f32_16x16x32_bf16 v[236:239], a[12:15], v[44:47], v[236:239]
v_cvt_pk_bf16_f32 v58, v80, v81
v_cvt_pk_bf16_f32 v59, v82, v83
v_mfma_f32_16x16x32_bf16 a[168:171], a[12:15], v[48:51], a[168:171]
v_mul_f32 v84, s31, v84
v_mul_f32 v85, s31, v85
v_mfma_f32_16x16x32_bf16 a[200:203], a[12:15], v[52:55], a[200:203]
s_waitcnt lgkmcnt(0)
ds_read_b128 a[0:3], v1 offset:0
ds_read_b128 a[4:7], v1 offset:64
v_mfma_f32_16x16x32_bf16 v[144:147], a[16:19], v[32:35], v[144:147]
v_mul_f32 v86, s31, v86
v_mul_f32 v87, s31, v87
v_mfma_f32_16x16x32_bf16 v[176:179], a[16:19], v[36:39], v[176:179]
v_exp_f32 v84, v84
v_mfma_f32_16x16x32_bf16 v[208:211], a[16:19], v[40:43], v[208:211]
ds_read_b128 a[8:11], v1 offset:128
ds_read_b128 a[12:15], v1 offset:192
v_mfma_f32_16x16x32_bf16 v[240:243], a[16:19], v[44:47], v[240:243]
v_exp_f32 v85, v85
v_mfma_f32_16x16x32_bf16 a[172:175], a[16:19], v[48:51], a[172:175]
v_exp_f32 v86, v86
v_mfma_f32_16x16x32_bf16 a[204:207], a[16:19], v[52:55], a[204:207]
v_exp_f32 v87, v87
v_mfma_f32_16x16x32_bf16 v[148:151], a[20:23], v[32:35], v[148:151]
v_cvt_pk_bf16_f32 v62, v84, v85
v_cvt_pk_bf16_f32 v63, v86, v87
v_mfma_f32_16x16x32_bf16 v[180:183], a[20:23], v[36:39], v[180:183]
v_mul_f32 v88, s31, v88
v_mul_f32 v89, s31, v89
v_mfma_f32_16x16x32_bf16 v[212:215], a[20:23], v[40:43], v[212:215]
v_mul_f32 v90, s31, v90
v_mul_f32 v91, s31, v91
v_mfma_f32_16x16x32_bf16 v[244:247], a[20:23], v[44:47], v[244:247]
v_exp_f32 v88, v88
v_mfma_f32_16x16x32_bf16 a[176:179], a[20:23], v[48:51], a[176:179]
v_exp_f32 v89, v89
v_mfma_f32_16x16x32_bf16 a[208:211], a[20:23], v[52:55], a[208:211]
v_exp_f32 v90, v90
v_mfma_f32_16x16x32_bf16 v[152:155], a[24:27], v[32:35], v[152:155]
v_exp_f32 v91, v91
v_mfma_f32_16x16x32_bf16 v[184:187], a[24:27], v[36:39], v[184:187]
v_cvt_pk_bf16_f32 v66, v88, v89
v_cvt_pk_bf16_f32 v67, v90, v91
v_mfma_f32_16x16x32_bf16 v[216:219], a[24:27], v[40:43], v[216:219]
v_mul_f32 v92, s31, v92
v_mul_f32 v93, s31, v93
v_mfma_f32_16x16x32_bf16 v[248:251], a[24:27], v[44:47], v[248:251]
v_mul_f32 v94, s31, v94
v_mul_f32 v95, s31, v95
v_mfma_f32_16x16x32_bf16 a[180:183], a[24:27], v[48:51], a[180:183]
v_exp_f32 v92, v92
v_mfma_f32_16x16x32_bf16 a[212:215], a[24:27], v[52:55], a[212:215]
v_exp_f32 v93, v93
v_mfma_f32_16x16x32_bf16 v[156:159], a[28:31], v[32:35], v[156:159]
v_exp_f32 v94, v94
v_mfma_f32_16x16x32_bf16 v[188:191], a[28:31], v[36:39], v[188:191]
v_exp_f32 v95, v95
v_mfma_f32_16x16x32_bf16 v[220:223], a[28:31], v[40:43], v[220:223]
v_cvt_pk_bf16_f32 v70, v92, v93
v_cvt_pk_bf16_f32 v71, v94, v95
v_mfma_f32_16x16x32_bf16 v[252:255], a[28:31], v[44:47], v[252:255]
v_mfma_f32_16x16x32_bf16 a[184:187], a[28:31], v[48:51], a[184:187]
v_mfma_f32_16x16x32_bf16 a[216:219], a[28:31], v[52:55], a[216:219]
s_waitcnt lgkmcnt(0)
ds_read_b128 a[16:19], v1 offset:4352
ds_read_b128 a[20:23], v1 offset:4416
v_mfma_f32_16x16x32_bf16 v[32:35], a[0:3], a[32:35], v[104:107]
v_mul_f32 v96, s31, v96
v_mul_f32 v97, s31, v97
v_mfma_f32_16x16x32_bf16 v[32:35], a[4:7], a[36:39], v[32:35]
v_mul_f32 v98, s31, v98
v_mul_f32 v99, s31, v99
v_mfma_f32_16x16x32_bf16 v[32:35], a[8:11], a[40:43], v[32:35]
ds_read_b128 a[24:27], v1 offset:4480
ds_read_b128 a[28:31], v1 offset:4544
v_mfma_f32_16x16x32_bf16 v[32:35], a[12:15], a[44:47], v[32:35]
v_exp_f32 v96, v96
v_mfma_f32_16x16x32_bf16 v[36:39], a[0:3], a[48:51], v[108:111]
v_exp_f32 v97, v97
v_mfma_f32_16x16x32_bf16 v[36:39], a[4:7], a[52:55], v[36:39]
v_exp_f32 v98, v98
v_mfma_f32_16x16x32_bf16 v[36:39], a[8:11], a[56:59], v[36:39]
v_exp_f32 v99, v99
v_mfma_f32_16x16x32_bf16 v[36:39], a[12:15], a[60:63], v[36:39]
v_cvt_pk_bf16_f32 v74, v96, v97
v_cvt_pk_bf16_f32 v75, v98, v99
v_mfma_f32_16x16x32_bf16 v[40:43], a[0:3], a[64:67], v[112:115]
v_mul_f32 v100, s31, v100
v_mul_f32 v101, s31, v101
v_mfma_f32_16x16x32_bf16 v[40:43], a[4:7], a[68:71], v[40:43]
v_mul_f32 v102, s31, v102
v_mul_f32 v103, s31, v103
v_mfma_f32_16x16x32_bf16 v[40:43], a[8:11], a[72:75], v[40:43]
v_exp_f32 v100, v100
v_mfma_f32_16x16x32_bf16 v[40:43], a[12:15], a[76:79], v[40:43]
v_exp_f32 v101, v101
s_waitcnt vmcnt(10)
s_barrier
v_mfma_f32_16x16x32_bf16 v[44:47], a[0:3], a[80:83], v[116:119]
v_exp_f32 v102, v102
v_mfma_f32_16x16x32_bf16 v[44:47], a[4:7], a[84:87], v[44:47]
s_add_u32 m0, s37, 26112
s_add_u32 s40, s32, 122880
buffer_load_dwordx4 v6, s[16:19], s40 offen nt lds
v_mfma_f32_16x16x32_bf16 v[44:47], a[8:11], a[88:91], v[44:47]
v_exp_f32 v103, v103
v_mfma_f32_16x16x32_bf16 v[44:47], a[12:15], a[92:95], v[44:47]
v_cvt_pk_bf16_f32 v78, v100, v101
v_cvt_pk_bf16_f32 v79, v102, v103
v_mfma_f32_16x16x32_bf16 v[48:51], a[0:3], a[96:99], v[120:123]
s_add_u32 m0, s37, 26176
s_nop 0
buffer_load_dwordx4 v6, s[16:19], s40 offen offset:1024 nt lds
v_mfma_f32_16x16x32_bf16 v[48:51], a[4:7], a[100:103], v[48:51]
v_xor_b32 v12, 64, v6
v_xor_b32 v13, 128, v6
v_mfma_f32_16x16x32_bf16 v[48:51], a[8:11], a[104:107], v[48:51]
v_xor_b32 v28, 192, v6
v_mul_f32 v32, s31, v32
v_mfma_f32_16x16x32_bf16 v[48:51], a[12:15], a[108:111], v[48:51]
v_mul_f32 v33, s31, v33
v_mul_f32 v34, s31, v34
v_mfma_f32_16x16x32_bf16 v[52:55], a[0:3], a[112:115], v[124:127]
v_mul_f32 v35, s31, v35
v_mul_f32 v36, s31, v36
v_mfma_f32_16x16x32_bf16 v[52:55], a[4:7], a[116:119], v[52:55]
v_exp_f32 v32, v32
v_mfma_f32_16x16x32_bf16 v[52:55], a[8:11], a[120:123], v[52:55]
v_exp_f32 v33, v33
v_mfma_f32_16x16x32_bf16 v[52:55], a[12:15], a[124:127], v[52:55]
s_waitcnt lgkmcnt(0)
ds_read_b64_tr_b16 a[0:1], v2 offset:24768
ds_read_b64_tr_b16 a[2:3], v2 offset:28896
v_mfma_f32_16x16x32_bf16 v[80:83], a[16:19], a[32:35], v[104:107]
v_exp_f32 v34, v34
v_mfma_f32_16x16x32_bf16 v[80:83], a[20:23], a[36:39], v[80:83]
v_exp_f32 v35, v35
v_mfma_f32_16x16x32_bf16 v[80:83], a[24:27], a[40:43], v[80:83]
ds_read_b64_tr_b16 a[4:5], v2 offset:24776
ds_read_b64_tr_b16 a[6:7], v2 offset:28904
v_mfma_f32_16x16x32_bf16 v[80:83], a[28:31], a[44:47], v[80:83]
v_cvt_pk_bf16_f32 v32, v32, v33
v_cvt_pk_bf16_f32 v33, v34, v35
v_mfma_f32_16x16x32_bf16 v[84:87], a[16:19], a[48:51], v[108:111]
v_mul_f32 v37, s31, v37
v_mul_f32 v38, s31, v38
v_mfma_f32_16x16x32_bf16 v[84:87], a[20:23], a[52:55], v[84:87]
ds_read_b64_tr_b16 a[8:9], v3 offset:24768
ds_read_b64_tr_b16 a[10:11], v3 offset:28896
v_mfma_f32_16x16x32_bf16 v[84:87], a[24:27], a[56:59], v[84:87]
v_mul_f32 v39, s31, v39
v_mul_f32 v40, s31, v40
v_mfma_f32_16x16x32_bf16 v[84:87], a[28:31], a[60:63], v[84:87]
v_exp_f32 v36, v36
v_mfma_f32_16x16x32_bf16 v[88:91], a[16:19], a[64:67], v[112:115]
ds_read_b64_tr_b16 a[12:13], v3 offset:24776
ds_read_b64_tr_b16 a[14:15], v3 offset:28904
v_mfma_f32_16x16x32_bf16 v[88:91], a[20:23], a[68:71], v[88:91]
v_exp_f32 v37, v37
v_mfma_f32_16x16x32_bf16 v[88:91], a[24:27], a[72:75], v[88:91]
v_exp_f32 v38, v38
v_mfma_f32_16x16x32_bf16 v[88:91], a[28:31], a[76:79], v[88:91]
s_add_u32 m0, s38, 16512
s_add_u32 s40, s32, 114688
buffer_load_dwordx4 v7, s[20:23], s40 offen nt lds
v_mfma_f32_16x16x32_bf16 v[92:95], a[16:19], a[80:83], v[116:119]
v_exp_f32 v39, v39
v_mfma_f32_16x16x32_bf16 v[92:95], a[20:23], a[84:87], v[92:95]
v_cvt_pk_bf16_f32 v36, v36, v37
v_cvt_pk_bf16_f32 v37, v38, v39
v_mfma_f32_16x16x32_bf16 v[92:95], a[24:27], a[88:91], v[92:95]
s_add_u32 m0, s38, 16520
s_nop 0
buffer_load_dwordx4 v7, s[20:23], s40 offen offset:1024 nt lds
v_mfma_f32_16x16x32_bf16 v[92:95], a[28:31], a[92:95], v[92:95]
v_mul_f32 v41, s31, v41
v_mul_f32 v42, s31, v42
v_mfma_f32_16x16x32_bf16 v[96:99], a[16:19], a[96:99], v[120:123]
v_mul_f32 v43, s31, v43
v_mul_f32 v44, s31, v44
v_mfma_f32_16x16x32_bf16 v[96:99], a[20:23], a[100:103], v[96:99]
v_exp_f32 v40, v40
v_mfma_f32_16x16x32_bf16 v[96:99], a[24:27], a[104:107], v[96:99]
v_exp_f32 v41, v41
v_mfma_f32_16x16x32_bf16 v[96:99], a[28:31], a[108:111], v[96:99]
v_exp_f32 v42, v42
v_mfma_f32_16x16x32_bf16 v[100:103], a[16:19], a[112:115], v[124:127]
v_exp_f32 v43, v43
v_mfma_f32_16x16x32_bf16 v[100:103], a[20:23], a[116:119], v[100:103]
v_cvt_pk_bf16_f32 v40, v40, v41
v_cvt_pk_bf16_f32 v41, v42, v43
v_mfma_f32_16x16x32_bf16 v[100:103], a[24:27], a[120:123], v[100:103]
v_mul_f32 v45, s31, v45
v_mul_f32 v46, s31, v46
v_mfma_f32_16x16x32_bf16 v[100:103], a[28:31], a[124:127], v[100:103]
s_waitcnt lgkmcnt(0)
ds_read_b64_tr_b16 a[16:17], v4 offset:24768
ds_read_b64_tr_b16 a[18:19], v4 offset:28896
v_mfma_f32_16x16x32_bf16 a[132:135], a[128:131], v[56:59], a[132:135]
v_mul_f32 v47, s31, v47
v_mul_f32 v48, s31, v48
v_mfma_f32_16x16x32_bf16 a[136:139], a[128:131], v[60:63], a[136:139]
v_exp_f32 v44, v44
v_mfma_f32_16x16x32_bf16 a[140:143], a[128:131], v[64:67], a[140:143]
ds_read_b64_tr_b16 a[20:21], v4 offset:24776
ds_read_b64_tr_b16 a[22:23], v4 offset:28904
v_mfma_f32_16x16x32_bf16 a[144:147], a[128:131], v[68:71], a[144:147]
v_exp_f32 v45, v45
v_mfma_f32_16x16x32_bf16 a[148:151], a[128:131], v[72:75], a[148:151]
v_exp_f32 v46, v46
v_mfma_f32_16x16x32_bf16 a[152:155], a[128:131], v[76:79], a[152:155]
v_exp_f32 v47, v47
v_mfma_f32_16x16x32_bf16 v[128:131], a[0:3], v[56:59], v[128:131]
v_cvt_pk_bf16_f32 v44, v44, v45
v_cvt_pk_bf16_f32 v45, v46, v47
v_mfma_f32_16x16x32_bf16 v[160:163], a[0:3], v[60:63], v[160:163]
ds_read_b64_tr_b16 a[24:25], v5 offset:24768
ds_read_b64_tr_b16 a[26:27], v5 offset:28896
v_mfma_f32_16x16x32_bf16 v[192:195], a[0:3], v[64:67], v[192:195]
v_mul_f32 v49, s31, v49
v_mul_f32 v50, s31, v50
v_mfma_f32_16x16x32_bf16 v[224:227], a[0:3], v[68:71], v[224:227]
v_mul_f32 v51, s31, v51
v_mul_f32 v52, s31, v52
v_mfma_f32_16x16x32_bf16 a[156:159], a[0:3], v[72:75], a[156:159]
ds_read_b64_tr_b16 a[28:29], v5 offset:24776
ds_read_b64_tr_b16 a[30:31], v5 offset:28904
v_mfma_f32_16x16x32_bf16 a[188:191], a[0:3], v[76:79], a[188:191]
v_exp_f32 v48, v48
v_mfma_f32_16x16x32_bf16 v[132:135], a[4:7], v[56:59], v[132:135]
v_exp_f32 v49, v49
v_mfma_f32_16x16x32_bf16 v[164:167], a[4:7], v[60:63], v[164:167]
v_exp_f32 v50, v50
v_mfma_f32_16x16x32_bf16 v[196:199], a[4:7], v[64:67], v[196:199]
v_exp_f32 v51, v51
v_mfma_f32_16x16x32_bf16 v[228:231], a[4:7], v[68:71], v[228:231]
s_add_u32 m0, s39, 16384
s_add_u32 s41, s34, 16384
buffer_load_dwordx4 v6, s[12:15], s41 offen offset:0 nt lds
buffer_load_dwordx4 v12, s[12:15], s41 offen offset:1024 nt lds
buffer_load_dwordx4 v13, s[12:15], s41 offen offset:2048 nt lds
buffer_load_dwordx4 v28, s[12:15], s41 offen offset:3072 nt lds
v_mfma_f32_16x16x32_bf16 a[160:163], a[4:7], v[72:75], a[160:163]
v_cvt_pk_bf16_f32 v48, v48, v49
v_cvt_pk_bf16_f32 v49, v50, v51
v_mfma_f32_16x16x32_bf16 a[192:195], a[4:7], v[76:79], a[192:195]
v_mul_f32 v53, s31, v53
v_mul_f32 v54, s31, v54
v_mfma_f32_16x16x32_bf16 v[136:139], a[8:11], v[56:59], v[136:139]
v_mul_f32 v55, s31, v55
v_mul_f32 v80, s31, v80
v_mfma_f32_16x16x32_bf16 v[168:171], a[8:11], v[60:63], v[168:171]
v_exp_f32 v52, v52
v_mfma_f32_16x16x32_bf16 v[200:203], a[8:11], v[64:67], v[200:203]
v_exp_f32 v53, v53
v_mfma_f32_16x16x32_bf16 v[232:235], a[8:11], v[68:71], v[232:235]
v_exp_f32 v54, v54
v_mfma_f32_16x16x32_bf16 a[164:167], a[8:11], v[72:75], a[164:167]
v_exp_f32 v55, v55
v_mfma_f32_16x16x32_bf16 a[196:199], a[8:11], v[76:79], a[196:199]
v_cvt_pk_bf16_f32 v52, v52, v53
v_cvt_pk_bf16_f32 v53, v54, v55
v_mfma_f32_16x16x32_bf16 v[140:143], a[12:15], v[56:59], v[140:143]
v_mul_f32 v81, s31, v81
v_mul_f32 v82, s31, v82
v_mfma_f32_16x16x32_bf16 v[172:175], a[12:15], v[60:63], v[172:175]
v_mul_f32 v83, s31, v83
v_mul_f32 v84, s31, v84
v_mfma_f32_16x16x32_bf16 v[204:207], a[12:15], v[64:67], v[204:207]
v_exp_f32 v80, v80
v_mfma_f32_16x16x32_bf16 v[236:239], a[12:15], v[68:71], v[236:239]
v_exp_f32 v81, v81
v_mfma_f32_16x16x32_bf16 a[168:171], a[12:15], v[72:75], a[168:171]
v_exp_f32 v82, v82
v_mfma_f32_16x16x32_bf16 a[200:203], a[12:15], v[76:79], a[200:203]
s_waitcnt lgkmcnt(0)
ds_read_b128 a[0:3], v1 offset:8704
ds_read_b128 a[4:7], v1 offset:8768
v_mfma_f32_16x16x32_bf16 v[144:147], a[16:19], v[56:59], v[144:147]
v_exp_f32 v83, v83
v_mfma_f32_16x16x32_bf16 v[176:179], a[16:19], v[60:63], v[176:179]
v_cvt_pk_bf16_f32 v34, v80, v81
v_cvt_pk_bf16_f32 v35, v82, v83
v_mfma_f32_16x16x32_bf16 v[208:211], a[16:19], v[64:67], v[208:211]
ds_read_b128 a[8:11], v1 offset:8832
ds_read_b128 a[12:15], v1 offset:8896
v_mfma_f32_16x16x32_bf16 v[240:243], a[16:19], v[68:71], v[240:243]
v_mul_f32 v85, s31, v85
v_mul_f32 v86, s31, v86
v_mfma_f32_16x16x32_bf16 a[172:175], a[16:19], v[72:75], a[172:175]
v_mul_f32 v87, s31, v87
v_mul_f32 v88, s31, v88
v_mfma_f32_16x16x32_bf16 a[204:207], a[16:19], v[76:79], a[204:207]
v_exp_f32 v84, v84
v_mfma_f32_16x16x32_bf16 v[148:151], a[20:23], v[56:59], v[148:151]
v_exp_f32 v85, v85
v_mfma_f32_16x16x32_bf16 v[180:183], a[20:23], v[60:63], v[180:183]
v_exp_f32 v86, v86
v_mfma_f32_16x16x32_bf16 v[212:215], a[20:23], v[64:67], v[212:215]
v_exp_f32 v87, v87
v_mfma_f32_16x16x32_bf16 v[244:247], a[20:23], v[68:71], v[244:247]
v_cvt_pk_bf16_f32 v38, v84, v85
v_cvt_pk_bf16_f32 v39, v86, v87
v_mfma_f32_16x16x32_bf16 a[176:179], a[20:23], v[72:75], a[176:179]
v_mul_f32 v89, s31, v89
v_mul_f32 v90, s31, v90
v_mfma_f32_16x16x32_bf16 a[208:211], a[20:23], v[76:79], a[208:211]
v_mul_f32 v91, s31, v91
v_mul_f32 v92, s31, v92
v_mfma_f32_16x16x32_bf16 v[152:155], a[24:27], v[56:59], v[152:155]
v_exp_f32 v88, v88
v_mfma_f32_16x16x32_bf16 v[184:187], a[24:27], v[60:63], v[184:187]
v_exp_f32 v89, v89
v_mfma_f32_16x16x32_bf16 v[216:219], a[24:27], v[64:67], v[216:219]
v_exp_f32 v90, v90
v_mfma_f32_16x16x32_bf16 v[248:251], a[24:27], v[68:71], v[248:251]
v_exp_f32 v91, v91
v_mfma_f32_16x16x32_bf16 a[180:183], a[24:27], v[72:75], a[180:183]
v_cvt_pk_bf16_f32 v42, v88, v89
v_cvt_pk_bf16_f32 v43, v90, v91
v_mfma_f32_16x16x32_bf16 a[212:215], a[24:27], v[76:79], a[212:215]
v_mul_f32 v93, s31, v93
v_mul_f32 v94, s31, v94
v_mfma_f32_16x16x32_bf16 v[156:159], a[28:31], v[56:59], v[156:159]
v_mul_f32 v95, s31, v95
v_mfma_f32_16x16x32_bf16 v[188:191], a[28:31], v[60:63], v[188:191]
v_exp_f32 v92, v92
v_mfma_f32_16x16x32_bf16 v[220:223], a[28:31], v[64:67], v[220:223]
v_exp_f32 v93, v93
v_mfma_f32_16x16x32_bf16 v[252:255], a[28:31], v[68:71], v[252:255]
v_exp_f32 v94, v94
v_mfma_f32_16x16x32_bf16 a[184:187], a[28:31], v[72:75], a[184:187]
v_exp_f32 v95, v95
v_mfma_f32_16x16x32_bf16 a[216:219], a[28:31], v[76:79], a[216:219]
v_cvt_pk_bf16_f32 v46, v92, v93
v_cvt_pk_bf16_f32 v47, v94, v95
s_waitcnt lgkmcnt(0)
ds_read_b128 a[16:19], v1 offset:13056
ds_read_b128 a[20:23], v1 offset:13120
v_mfma_f32_16x16x32_bf16 v[56:59], a[0:3], a[32:35], v[104:107]
v_mul_f32 v96, s31, v96
v_mul_f32 v97, s31, v97
v_mfma_f32_16x16x32_bf16 v[56:59], a[4:7], a[36:39], v[56:59]
v_mul_f32 v98, s31, v98
v_mul_f32 v99, s31, v99
v_mfma_f32_16x16x32_bf16 v[56:59], a[8:11], a[40:43], v[56:59]
ds_read_b128 a[24:27], v1 offset:13184
ds_read_b128 a[28:31], v1 offset:13248
v_mfma_f32_16x16x32_bf16 v[56:59], a[12:15], a[44:47], v[56:59]
v_exp_f32 v96, v96
v_mfma_f32_16x16x32_bf16 v[60:63], a[0:3], a[48:51], v[108:111]
v_exp_f32 v97, v97
v_mfma_f32_16x16x32_bf16 v[60:63], a[4:7], a[52:55], v[60:63]
v_exp_f32 v98, v98
v_mfma_f32_16x16x32_bf16 v[60:63], a[8:11], a[56:59], v[60:63]
v_exp_f32 v99, v99
v_mfma_f32_16x16x32_bf16 v[60:63], a[12:15], a[60:63], v[60:63]
v_cvt_pk_bf16_f32 v50, v96, v97
v_cvt_pk_bf16_f32 v51, v98, v99
v_mfma_f32_16x16x32_bf16 v[64:67], a[0:3], a[64:67], v[112:115]
v_mul_f32 v100, s31, v100
v_mul_f32 v101, s31, v101
v_mfma_f32_16x16x32_bf16 v[64:67], a[4:7], a[68:71], v[64:67]
v_mul_f32 v102, s31, v102
v_mul_f32 v103, s31, v103
v_mfma_f32_16x16x32_bf16 v[64:67], a[8:11], a[72:75], v[64:67]
v_exp_f32 v100, v100
v_mfma_f32_16x16x32_bf16 v[64:67], a[12:15], a[76:79], v[64:67]
v_exp_f32 v101, v101
s_waitcnt vmcnt(10)
s_barrier
v_mfma_f32_16x16x32_bf16 v[68:71], a[0:3], a[80:83], v[116:119]
v_exp_f32 v102, v102
v_mfma_f32_16x16x32_bf16 v[68:71], a[4:7], a[84:87], v[68:71]
s_add_u32 m0, s37, 0
s_add_u32 s40, s33, 0
buffer_load_dwordx4 v6, s[16:19], s40 offen nt lds
v_mfma_f32_16x16x32_bf16 v[68:71], a[8:11], a[88:91], v[68:71]
v_exp_f32 v103, v103
v_mfma_f32_16x16x32_bf16 v[68:71], a[12:15], a[92:95], v[68:71]
v_cvt_pk_bf16_f32 v54, v100, v101
v_cvt_pk_bf16_f32 v55, v102, v103
v_mfma_f32_16x16x32_bf16 v[72:75], a[0:3], a[96:99], v[120:123]
s_add_u32 m0, s37, 64
s_nop 0
buffer_load_dwordx4 v6, s[16:19], s40 offen offset:1024 nt lds
v_mfma_f32_16x16x32_bf16 v[72:75], a[4:7], a[100:103], v[72:75]
v_mul_f32 v56, s31, v56
v_mul_f32 v57, s31, v57
v_mfma_f32_16x16x32_bf16 v[72:75], a[8:11], a[104:107], v[72:75]
v_mul_f32 v58, s31, v58
v_mul_f32 v59, s31, v59
v_mfma_f32_16x16x32_bf16 v[72:75], a[12:15], a[108:111], v[72:75]
v_exp_f32 v56, v56
v_mfma_f32_16x16x32_bf16 v[76:79], a[0:3], a[112:115], v[124:127]
v_exp_f32 v57, v57
v_mfma_f32_16x16x32_bf16 v[76:79], a[4:7], a[116:119], v[76:79]
v_exp_f32 v58, v58
v_mfma_f32_16x16x32_bf16 v[76:79], a[8:11], a[120:123], v[76:79]
v_exp_f32 v59, v59
v_mfma_f32_16x16x32_bf16 v[76:79], a[12:15], a[124:127], v[76:79]
s_waitcnt lgkmcnt(0)
ds_read_b64_tr_b16 a[0:1], v2 offset:0
ds_read_b64_tr_b16 a[2:3], v2 offset:4128
v_mfma_f32_16x16x32_bf16 v[80:83], a[16:19], a[32:35], v[104:107]
v_cvt_pk_bf16_f32 v56, v56, v57
v_cvt_pk_bf16_f32 v57, v58, v59
v_mfma_f32_16x16x32_bf16 v[80:83], a[20:23], a[36:39], v[80:83]
v_mul_f32 v60, s31, v60
v_mul_f32 v61, s31, v61
v_mfma_f32_16x16x32_bf16 v[80:83], a[24:27], a[40:43], v[80:83]
ds_read_b64_tr_b16 a[4:5], v2 offset:8
ds_read_b64_tr_b16 a[6:7], v2 offset:4136
v_mfma_f32_16x16x32_bf16 v[80:83], a[28:31], a[44:47], v[80:83]
v_mul_f32 v62, s31, v62
v_mul_f32 v63, s31, v63
v_mfma_f32_16x16x32_bf16 v[84:87], a[16:19], a[48:51], v[108:111]
v_exp_f32 v60, v60
v_mfma_f32_16x16x32_bf16 v[84:87], a[20:23], a[52:55], v[84:87]
ds_read_b64_tr_b16 a[8:9], v3 offset:0
ds_read_b64_tr_b16 a[10:11], v3 offset:4128
v_mfma_f32_16x16x32_bf16 v[84:87], a[24:27], a[56:59], v[84:87]
v_exp_f32 v61, v61
v_mfma_f32_16x16x32_bf16 v[84:87], a[28:31], a[60:63], v[84:87]
v_exp_f32 v62, v62
v_mfma_f32_16x16x32_bf16 v[88:91], a[16:19], a[64:67], v[112:115]
ds_read_b64_tr_b16 a[12:13], v3 offset:8
ds_read_b64_tr_b16 a[14:15], v3 offset:4136
v_mfma_f32_16x16x32_bf16 v[88:91], a[20:23], a[68:71], v[88:91]
v_exp_f32 v63, v63
v_mfma_f32_16x16x32_bf16 v[88:91], a[24:27], a[72:75], v[88:91]
v_cvt_pk_bf16_f32 v60, v60, v61
v_cvt_pk_bf16_f32 v61, v62, v63
v_mfma_f32_16x16x32_bf16 v[88:91], a[28:31], a[76:79], v[88:91]
s_add_u32 m0, s38, 24768
s_add_u32 s40, s32, 122880
buffer_load_dwordx4 v7, s[20:23], s40 offen nt lds
v_mfma_f32_16x16x32_bf16 v[92:95], a[16:19], a[80:83], v[116:119]
v_mul_f32 v64, s31, v64
v_mul_f32 v65, s31, v65
v_mfma_f32_16x16x32_bf16 v[92:95], a[20:23], a[84:87], v[92:95]
v_mul_f32 v66, s31, v66
v_mul_f32 v67, s31, v67
v_mfma_f32_16x16x32_bf16 v[92:95], a[24:27], a[88:91], v[92:95]
s_add_u32 m0, s38, 24776
s_nop 0
buffer_load_dwordx4 v7, s[20:23], s40 offen offset:1024 nt lds
v_mfma_f32_16x16x32_bf16 v[92:95], a[28:31], a[92:95], v[92:95]
v_exp_f32 v64, v64
v_mfma_f32_16x16x32_bf16 v[96:99], a[16:19], a[96:99], v[120:123]
v_exp_f32 v65, v65
v_mfma_f32_16x16x32_bf16 v[96:99], a[20:23], a[100:103], v[96:99]
v_exp_f32 v66, v66
v_mfma_f32_16x16x32_bf16 v[96:99], a[24:27], a[104:107], v[96:99]
v_exp_f32 v67, v67
v_mfma_f32_16x16x32_bf16 v[96:99], a[28:31], a[108:111], v[96:99]
v_cvt_pk_bf16_f32 v64, v64, v65
v_cvt_pk_bf16_f32 v65, v66, v67
v_mfma_f32_16x16x32_bf16 v[100:103], a[16:19], a[112:115], v[124:127]
v_mul_f32 v68, s31, v68
v_mul_f32 v69, s31, v69
v_mfma_f32_16x16x32_bf16 v[100:103], a[20:23], a[116:119], v[100:103]
v_mul_f32 v70, s31, v70
v_mul_f32 v71, s31, v71
v_mfma_f32_16x16x32_bf16 v[100:103], a[24:27], a[120:123], v[100:103]
v_exp_f32 v68, v68
v_mfma_f32_16x16x32_bf16 v[100:103], a[28:31], a[124:127], v[100:103]
s_waitcnt lgkmcnt(0)
ds_read_b64_tr_b16 a[16:17], v4 offset:0
ds_read_b64_tr_b16 a[18:19], v4 offset:4128
v_mfma_f32_16x16x32_bf16 a[132:135], a[128:131], v[32:35], a[132:135]
v_exp_f32 v69, v69
v_mfma_f32_16x16x32_bf16 a[136:139], a[128:131], v[36:39], a[136:139]
v_exp_f32 v70, v70
v_mfma_f32_16x16x32_bf16 a[140:143], a[128:131], v[40:43], a[140:143]
ds_read_b64_tr_b16 a[20:21], v4 offset:8
ds_read_b64_tr_b16 a[22:23], v4 offset:4136
v_mfma_f32_16x16x32_bf16 a[144:147], a[128:131], v[44:47], a[144:147]
v_exp_f32 v71, v71
v_mfma_f32_16x16x32_bf16 a[148:151], a[128:131], v[48:51], a[148:151]
v_cvt_pk_bf16_f32 v68, v68, v69
v_cvt_pk_bf16_f32 v69, v70, v71
v_mfma_f32_16x16x32_bf16 a[152:155], a[128:131], v[52:55], a[152:155]
v_mul_f32 v72, s31, v72
v_mul_f32 v73, s31, v73
v_mfma_f32_16x16x32_bf16 v[128:131], a[0:3], v[32:35], v[128:131]
v_mul_f32 v74, s31, v74
v_mul_f32 v75, s31, v75
v_mfma_f32_16x16x32_bf16 v[160:163], a[0:3], v[36:39], v[160:163]
ds_read_b64_tr_b16 a[24:25], v5 offset:0
ds_read_b64_tr_b16 a[26:27], v5 offset:4128
v_mfma_f32_16x16x32_bf16 v[192:195], a[0:3], v[40:43], v[192:195]
v_exp_f32 v72, v72
v_mfma_f32_16x16x32_bf16 v[224:227], a[0:3], v[44:47], v[224:227]
v_exp_f32 v73, v73
v_mfma_f32_16x16x32_bf16 a[156:159], a[0:3], v[48:51], a[156:159]
ds_read_b64_tr_b16 a[28:29], v5 offset:8
ds_read_b64_tr_b16 a[30:31], v5 offset:4136
v_mfma_f32_16x16x32_bf16 a[188:191], a[0:3], v[52:55], a[188:191]
v_exp_f32 v74, v74
v_mfma_f32_16x16x32_bf16 v[132:135], a[4:7], v[32:35], v[132:135]
v_exp_f32 v75, v75
v_mfma_f32_16x16x32_bf16 v[164:167], a[4:7], v[36:39], v[164:167]
v_cvt_pk_bf16_f32 v72, v72, v73
v_cvt_pk_bf16_f32 v73, v74, v75
v_mfma_f32_16x16x32_bf16 v[196:199], a[4:7], v[40:43], v[196:199]
v_mul_f32 v76, s31, v76
v_mul_f32 v77, s31, v77
v_mfma_f32_16x16x32_bf16 v[228:231], a[4:7], v[44:47], v[228:231]
s_add_u32 s41, s34, 20480
buffer_load_dwordx4 a[220:223], v9, s[12:15], s41 offen offset:0 nt
buffer_load_dwordx4 a[224:227], v9, s[12:15], s41 offen offset:64 nt
buffer_load_dwordx4 a[228:231], v9, s[12:15], s41 offen offset:128 nt
buffer_load_dwordx4 a[232:235], v9, s[12:15], s41 offen offset:192 nt
v_mfma_f32_16x16x32_bf16 a[160:163], a[4:7], v[48:51], a[160:163]
v_mul_f32 v78, s31, v78
v_mul_f32 v79, s31, v79
v_mfma_f32_16x16x32_bf16 a[192:195], a[4:7], v[52:55], a[192:195]
v_exp_f32 v76, v76
v_mfma_f32_16x16x32_bf16 v[136:139], a[8:11], v[32:35], v[136:139]
v_exp_f32 v77, v77
v_mfma_f32_16x16x32_bf16 v[168:171], a[8:11], v[36:39], v[168:171]
v_exp_f32 v78, v78
v_mfma_f32_16x16x32_bf16 v[200:203], a[8:11], v[40:43], v[200:203]
v_exp_f32 v79, v79
v_mfma_f32_16x16x32_bf16 v[232:235], a[8:11], v[44:47], v[232:235]
v_cvt_pk_bf16_f32 v76, v76, v77
v_cvt_pk_bf16_f32 v77, v78, v79
v_mfma_f32_16x16x32_bf16 a[164:167], a[8:11], v[48:51], a[164:167]
v_mul_f32 v80, s31, v80
v_mul_f32 v81, s31, v81
v_mfma_f32_16x16x32_bf16 a[196:199], a[8:11], v[52:55], a[196:199]
v_mul_f32 v82, s31, v82
v_mul_f32 v83, s31, v83
v_mfma_f32_16x16x32_bf16 v[140:143], a[12:15], v[32:35], v[140:143]
v_exp_f32 v80, v80
v_mfma_f32_16x16x32_bf16 v[172:175], a[12:15], v[36:39], v[172:175]
v_exp_f32 v81, v81
v_mfma_f32_16x16x32_bf16 v[204:207], a[12:15], v[40:43], v[204:207]
v_exp_f32 v82, v82
v_mfma_f32_16x16x32_bf16 v[236:239], a[12:15], v[44:47], v[236:239]
v_exp_f32 v83, v83
v_mfma_f32_16x16x32_bf16 a[168:171], a[12:15], v[48:51], a[168:171]
v_cvt_pk_bf16_f32 v58, v80, v81
v_cvt_pk_bf16_f32 v59, v82, v83
v_mfma_f32_16x16x32_bf16 a[200:203], a[12:15], v[52:55], a[200:203]
s_waitcnt lgkmcnt(0)
ds_read_b128 a[0:3], v1 offset:17408
ds_read_b128 a[4:7], v1 offset:17472
v_mfma_f32_16x16x32_bf16 v[144:147], a[16:19], v[32:35], v[144:147]
v_mul_f32 v84, s31, v84
v_mul_f32 v85, s31, v85
v_mfma_f32_16x16x32_bf16 v[176:179], a[16:19], v[36:39], v[176:179]
v_mul_f32 v86, s31, v86
v_mul_f32 v87, s31, v87
v_mfma_f32_16x16x32_bf16 v[208:211], a[16:19], v[40:43], v[208:211]
ds_read_b128 a[8:11], v1 offset:17536
ds_read_b128 a[12:15], v1 offset:17600
v_mfma_f32_16x16x32_bf16 v[240:243], a[16:19], v[44:47], v[240:243]
v_exp_f32 v84, v84
v_mfma_f32_16x16x32_bf16 a[172:175], a[16:19], v[48:51], a[172:175]
v_exp_f32 v85, v85
v_mfma_f32_16x16x32_bf16 a[204:207], a[16:19], v[52:55], a[204:207]
v_exp_f32 v86, v86
v_mfma_f32_16x16x32_bf16 v[148:151], a[20:23], v[32:35], v[148:151]
v_exp_f32 v87, v87
v_mfma_f32_16x16x32_bf16 v[180:183], a[20:23], v[36:39], v[180:183]
v_cvt_pk_bf16_f32 v62, v84, v85
v_cvt_pk_bf16_f32 v63, v86, v87
v_mfma_f32_16x16x32_bf16 v[212:215], a[20:23], v[40:43], v[212:215]
v_mul_f32 v88, s31, v88
v_mul_f32 v89, s31, v89
v_mfma_f32_16x16x32_bf16 v[244:247], a[20:23], v[44:47], v[244:247]
v_mul_f32 v90, s31, v90
v_mul_f32 v91, s31, v91
v_mfma_f32_16x16x32_bf16 a[176:179], a[20:23], v[48:51], a[176:179]
v_exp_f32 v88, v88
v_mfma_f32_16x16x32_bf16 a[208:211], a[20:23], v[52:55], a[208:211]
v_exp_f32 v89, v89
v_mfma_f32_16x16x32_bf16 v[152:155], a[24:27], v[32:35], v[152:155]
v_exp_f32 v90, v90
v_mfma_f32_16x16x32_bf16 v[184:187], a[24:27], v[36:39], v[184:187]
v_exp_f32 v91, v91
v_mfma_f32_16x16x32_bf16 v[216:219], a[24:27], v[40:43], v[216:219]
v_cvt_pk_bf16_f32 v66, v88, v89
v_cvt_pk_bf16_f32 v67, v90, v91
v_mfma_f32_16x16x32_bf16 v[248:251], a[24:27], v[44:47], v[248:251]
v_mul_f32 v92, s31, v92
v_mul_f32 v93, s31, v93
v_mfma_f32_16x16x32_bf16 a[180:183], a[24:27], v[48:51], a[180:183]
v_mul_f32 v94, s31, v94
v_mul_f32 v95, s31, v95
v_mfma_f32_16x16x32_bf16 a[212:215], a[24:27], v[52:55], a[212:215]
v_exp_f32 v92, v92
v_mfma_f32_16x16x32_bf16 v[156:159], a[28:31], v[32:35], v[156:159]
v_exp_f32 v93, v93
v_mfma_f32_16x16x32_bf16 v[188:191], a[28:31], v[36:39], v[188:191]
v_exp_f32 v94, v94
v_mfma_f32_16x16x32_bf16 v[220:223], a[28:31], v[40:43], v[220:223]
v_exp_f32 v95, v95
v_mfma_f32_16x16x32_bf16 v[252:255], a[28:31], v[44:47], v[252:255]
v_cvt_pk_bf16_f32 v70, v92, v93
v_cvt_pk_bf16_f32 v71, v94, v95
v_mfma_f32_16x16x32_bf16 a[184:187], a[28:31], v[48:51], a[184:187]
v_mfma_f32_16x16x32_bf16 a[216:219], a[28:31], v[52:55], a[216:219]
s_waitcnt lgkmcnt(0)
ds_read_b128 a[16:19], v1 offset:21760
ds_read_b128 a[20:23], v1 offset:21824
v_mfma_f32_16x16x32_bf16 v[32:35], a[0:3], a[32:35], v[104:107]
v_mul_f32 v96, s31, v96
v_mul_f32 v97, s31, v97
v_mfma_f32_16x16x32_bf16 v[32:35], a[4:7], a[36:39], v[32:35]
v_mul_f32 v98, s31, v98
v_mul_f32 v99, s31, v99
v_mfma_f32_16x16x32_bf16 v[32:35], a[8:11], a[40:43], v[32:35]
ds_read_b128 a[24:27], v1 offset:21888
ds_read_b128 a[28:31], v1 offset:21952
v_mfma_f32_16x16x32_bf16 v[32:35], a[12:15], a[44:47], v[32:35]
v_exp_f32 v96, v96
v_mfma_f32_16x16x32_bf16 v[36:39], a[0:3], a[48:51], v[108:111]
v_exp_f32 v97, v97
v_mfma_f32_16x16x32_bf16 v[36:39], a[4:7], a[52:55], v[36:39]
v_exp_f32 v98, v98
v_mfma_f32_16x16x32_bf16 v[36:39], a[8:11], a[56:59], v[36:39]
v_exp_f32 v99, v99
v_mfma_f32_16x16x32_bf16 v[36:39], a[12:15], a[60:63], v[36:39]
v_cvt_pk_bf16_f32 v74, v96, v97
v_cvt_pk_bf16_f32 v75, v98, v99
v_mfma_f32_16x16x32_bf16 v[40:43], a[0:3], a[64:67], v[112:115]
v_mul_f32 v100, s31, v100
v_mul_f32 v101, s31, v101
v_mfma_f32_16x16x32_bf16 v[40:43], a[4:7], a[68:71], v[40:43]
v_mul_f32 v102, s31, v102
v_mul_f32 v103, s31, v103
v_mfma_f32_16x16x32_bf16 v[40:43], a[8:11], a[72:75], v[40:43]
v_exp_f32 v100, v100
v_mfma_f32_16x16x32_bf16 v[40:43], a[12:15], a[76:79], v[40:43]
v_exp_f32 v101, v101
s_waitcnt vmcnt(14)
s_barrier
v_mfma_f32_16x16x32_bf16 v[44:47], a[0:3], a[80:83], v[116:119]
v_exp_f32 v102, v102
v_mfma_f32_16x16x32_bf16 v[44:47], a[4:7], a[84:87], v[44:47]
s_add_u32 m0, s37, 8704
s_add_u32 s40, s33, 8192
buffer_load_dwordx4 v6, s[16:19], s40 offen nt lds
v_mfma_f32_16x16x32_bf16 v[44:47], a[8:11], a[88:91], v[44:47]
v_exp_f32 v103, v103
v_mfma_f32_16x16x32_bf16 v[44:47], a[12:15], a[92:95], v[44:47]
v_cvt_pk_bf16_f32 v78, v100, v101
v_cvt_pk_bf16_f32 v79, v102, v103
v_mfma_f32_16x16x32_bf16 v[48:51], a[0:3], a[96:99], v[120:123]
s_add_u32 m0, s37, 8768
s_nop 0
buffer_load_dwordx4 v6, s[16:19], s40 offen offset:1024 nt lds
v_mfma_f32_16x16x32_bf16 v[48:51], a[4:7], a[100:103], v[48:51]
v_mul_f32 v32, s31, v32
v_mul_f32 v33, s31, v33
v_mfma_f32_16x16x32_bf16 v[48:51], a[8:11], a[104:107], v[48:51]
v_mul_f32 v34, s31, v34
v_mul_f32 v35, s31, v35
v_mfma_f32_16x16x32_bf16 v[48:51], a[12:15], a[108:111], v[48:51]
v_exp_f32 v32, v32
v_mfma_f32_16x16x32_bf16 v[52:55], a[0:3], a[112:115], v[124:127]
v_exp_f32 v33, v33
v_mfma_f32_16x16x32_bf16 v[52:55], a[4:7], a[116:119], v[52:55]
v_exp_f32 v34, v34
v_mfma_f32_16x16x32_bf16 v[52:55], a[8:11], a[120:123], v[52:55]
v_exp_f32 v35, v35
v_mfma_f32_16x16x32_bf16 v[52:55], a[12:15], a[124:127], v[52:55]
s_waitcnt lgkmcnt(0)
ds_read_b64_tr_b16 a[0:1], v2 offset:8256
ds_read_b64_tr_b16 a[2:3], v2 offset:12384
v_mfma_f32_16x16x32_bf16 v[80:83], a[16:19], a[32:35], v[104:107]
v_cvt_pk_bf16_f32 v32, v32, v33
v_cvt_pk_bf16_f32 v33, v34, v35
v_mfma_f32_16x16x32_bf16 v[80:83], a[20:23], a[36:39], v[80:83]
v_mul_f32 v36, s31, v36
v_mul_f32 v37, s31, v37
v_mfma_f32_16x16x32_bf16 v[80:83], a[24:27], a[40:43], v[80:83]
ds_read_b64_tr_b16 a[4:5], v2 offset:8264
ds_read_b64_tr_b16 a[6:7], v2 offset:12392
v_mfma_f32_16x16x32_bf16 v[80:83], a[28:31], a[44:47], v[80:83]
v_mul_f32 v38, s31, v38
v_mul_f32 v39, s31, v39
v_mfma_f32_16x16x32_bf16 v[84:87], a[16:19], a[48:51], v[108:111]
v_exp_f32 v36, v36
v_mfma_f32_16x16x32_bf16 v[84:87], a[20:23], a[52:55], v[84:87]
ds_read_b64_tr_b16 a[8:9], v3 offset:8256
ds_read_b64_tr_b16 a[10:11], v3 offset:12384
v_mfma_f32_16x16x32_bf16 v[84:87], a[24:27], a[56:59], v[84:87]
v_exp_f32 v37, v37
v_mfma_f32_16x16x32_bf16 v[84:87], a[28:31], a[60:63], v[84:87]
v_exp_f32 v38, v38
v_mfma_f32_16x16x32_bf16 v[88:91], a[16:19], a[64:67], v[112:115]
ds_read_b64_tr_b16 a[12:13], v3 offset:8264
ds_read_b64_tr_b16 a[14:15], v3 offset:12392
v_mfma_f32_16x16x32_bf16 v[88:91], a[20:23], a[68:71], v[88:91]
v_exp_f32 v39, v39
v_mfma_f32_16x16x32_bf16 v[88:91], a[24:27], a[72:75], v[88:91]
v_cvt_pk_bf16_f32 v36, v36, v37
v_cvt_pk_bf16_f32 v37, v38, v39
v_mfma_f32_16x16x32_bf16 v[88:91], a[28:31], a[76:79], v[88:91]
s_add_u32 m0, s38, 0
s_add_u32 s40, s33, 0
buffer_load_dwordx4 v7, s[20:23], s40 offen nt lds
v_mfma_f32_16x16x32_bf16 v[92:95], a[16:19], a[80:83], v[116:119]
v_mul_f32 v40, s31, v40
v_mul_f32 v41, s31, v41
v_mfma_f32_16x16x32_bf16 v[92:95], a[20:23], a[84:87], v[92:95]
v_mul_f32 v42, s31, v42
v_mul_f32 v43, s31, v43
v_mfma_f32_16x16x32_bf16 v[92:95], a[24:27], a[88:91], v[92:95]
s_add_u32 m0, s38, 8
s_nop 0
buffer_load_dwordx4 v7, s[20:23], s40 offen offset:1024 nt lds
v_mfma_f32_16x16x32_bf16 v[92:95], a[28:31], a[92:95], v[92:95]
v_exp_f32 v40, v40
v_mfma_f32_16x16x32_bf16 v[96:99], a[16:19], a[96:99], v[120:123]
v_exp_f32 v41, v41
v_mfma_f32_16x16x32_bf16 v[96:99], a[20:23], a[100:103], v[96:99]
v_exp_f32 v42, v42
v_mfma_f32_16x16x32_bf16 v[96:99], a[24:27], a[104:107], v[96:99]
v_exp_f32 v43, v43
v_mfma_f32_16x16x32_bf16 v[96:99], a[28:31], a[108:111], v[96:99]
v_cvt_pk_bf16_f32 v40, v40, v41
v_cvt_pk_bf16_f32 v41, v42, v43
v_mfma_f32_16x16x32_bf16 v[100:103], a[16:19], a[112:115], v[124:127]
v_mul_f32 v44, s31, v44
v_mul_f32 v45, s31, v45
v_mfma_f32_16x16x32_bf16 v[100:103], a[20:23], a[116:119], v[100:103]
v_mul_f32 v46, s31, v46
v_mul_f32 v47, s31, v47
v_mfma_f32_16x16x32_bf16 v[100:103], a[24:27], a[120:123], v[100:103]
v_exp_f32 v44, v44
v_mfma_f32_16x16x32_bf16 v[100:103], a[28:31], a[124:127], v[100:103]
s_waitcnt lgkmcnt(0)
ds_read_b64_tr_b16 a[16:17], v4 offset:8256
ds_read_b64_tr_b16 a[18:19], v4 offset:12384
v_mfma_f32_16x16x32_bf16 a[132:135], a[128:131], v[56:59], a[132:135]
v_exp_f32 v45, v45
v_mfma_f32_16x16x32_bf16 a[136:139], a[128:131], v[60:63], a[136:139]
v_exp_f32 v46, v46
v_mfma_f32_16x16x32_bf16 a[140:143], a[128:131], v[64:67], a[140:143]
ds_read_b64_tr_b16 a[20:21], v4 offset:8264
ds_read_b64_tr_b16 a[22:23], v4 offset:12392
v_mfma_f32_16x16x32_bf16 a[144:147], a[128:131], v[68:71], a[144:147]
v_exp_f32 v47, v47
v_mfma_f32_16x16x32_bf16 a[148:151], a[128:131], v[72:75], a[148:151]
v_cvt_pk_bf16_f32 v44, v44, v45
v_cvt_pk_bf16_f32 v45, v46, v47
v_mfma_f32_16x16x32_bf16 a[152:155], a[128:131], v[76:79], a[152:155]
v_mul_f32 v48, s31, v48
v_mul_f32 v49, s31, v49
v_mfma_f32_16x16x32_bf16 v[128:131], a[0:3], v[56:59], v[128:131]
v_mul_f32 v50, s31, v50
v_mul_f32 v51, s31, v51
v_mfma_f32_16x16x32_bf16 v[160:163], a[0:3], v[60:63], v[160:163]
ds_read_b64_tr_b16 a[24:25], v5 offset:8256
ds_read_b64_tr_b16 a[26:27], v5 offset:12384
v_mfma_f32_16x16x32_bf16 v[192:195], a[0:3], v[64:67], v[192:195]
v_exp_f32 v48, v48
v_mfma_f32_16x16x32_bf16 v[224:227], a[0:3], v[68:71], v[224:227]
v_exp_f32 v49, v49
v_mfma_f32_16x16x32_bf16 a[156:159], a[0:3], v[72:75], a[156:159]
ds_read_b64_tr_b16 a[28:29], v5 offset:8264
ds_read_b64_tr_b16 a[30:31], v5 offset:12392
v_mfma_f32_16x16x32_bf16 a[188:191], a[0:3], v[76:79], a[188:191]
v_exp_f32 v50, v50
v_mfma_f32_16x16x32_bf16 v[132:135], a[4:7], v[56:59], v[132:135]
v_exp_f32 v51, v51
v_mfma_f32_16x16x32_bf16 v[164:167], a[4:7], v[60:63], v[164:167]
v_cvt_pk_bf16_f32 v48, v48, v49
v_cvt_pk_bf16_f32 v49, v50, v51
v_mfma_f32_16x16x32_bf16 v[196:199], a[4:7], v[64:67], v[196:199]
v_mul_f32 v52, s31, v52
v_mul_f32 v53, s31, v53
v_mfma_f32_16x16x32_bf16 v[228:231], a[4:7], v[68:71], v[228:231]
v_mul_f32 v54, s31, v54
v_mul_f32 v55, s31, v55
v_mfma_f32_16x16x32_bf16 a[160:163], a[4:7], v[72:75], a[160:163]
v_exp_f32 v52, v52
v_mfma_f32_16x16x32_bf16 a[192:195], a[4:7], v[76:79], a[192:195]
v_exp_f32 v53, v53
v_mfma_f32_16x16x32_bf16 v[136:139], a[8:11], v[56:59], v[136:139]
v_exp_f32 v54, v54
v_mfma_f32_16x16x32_bf16 v[168:171], a[8:11], v[60:63], v[168:171]
v_exp_f32 v55, v55
v_mfma_f32_16x16x32_bf16 v[200:203], a[8:11], v[64:67], v[200:203]
v_cvt_pk_bf16_f32 v52, v52, v53
v_cvt_pk_bf16_f32 v53, v54, v55
v_mfma_f32_16x16x32_bf16 v[232:235], a[8:11], v[68:71], v[232:235]
v_mul_f32 v80, s31, v80
v_mul_f32 v81, s31, v81
v_mfma_f32_16x16x32_bf16 a[164:167], a[8:11], v[72:75], a[164:167]
v_mul_f32 v82, s31, v82
v_mul_f32 v83, s31, v83
v_mfma_f32_16x16x32_bf16 a[196:199], a[8:11], v[76:79], a[196:199]
v_exp_f32 v80, v80
v_mfma_f32_16x16x32_bf16 v[140:143], a[12:15], v[56:59], v[140:143]
v_exp_f32 v81, v81
v_mfma_f32_16x16x32_bf16 v[172:175], a[12:15], v[60:63], v[172:175]
v_exp_f32 v82, v82
v_mfma_f32_16x16x32_bf16 v[204:207], a[12:15], v[64:67], v[204:207]
v_exp_f32 v83, v83
v_mfma_f32_16x16x32_bf16 v[236:239], a[12:15], v[68:71], v[236:239]
v_cvt_pk_bf16_f32 v34, v80, v81
v_cvt_pk_bf16_f32 v35, v82, v83
v_mfma_f32_16x16x32_bf16 a[168:171], a[12:15], v[72:75], a[168:171]
v_mul_f32 v84, s31, v84
v_mul_f32 v85, s31, v85
v_mfma_f32_16x16x32_bf16 a[200:203], a[12:15], v[76:79], a[200:203]
s_waitcnt lgkmcnt(0)
ds_read_b128 a[0:3], v1 offset:26112
ds_read_b128 a[4:7], v1 offset:26176
v_mfma_f32_16x16x32_bf16 v[144:147], a[16:19], v[56:59], v[144:147]
v_mul_f32 v86, s31, v86
v_mul_f32 v87, s31, v87
v_mfma_f32_16x16x32_bf16 v[176:179], a[16:19], v[60:63], v[176:179]
v_exp_f32 v84, v84
v_mfma_f32_16x16x32_bf16 v[208:211], a[16:19], v[64:67], v[208:211]
ds_read_b128 a[8:11], v1 offset:26240
ds_read_b128 a[12:15], v1 offset:26304
v_mfma_f32_16x16x32_bf16 v[240:243], a[16:19], v[68:71], v[240:243]
v_exp_f32 v85, v85
v_mfma_f32_16x16x32_bf16 a[172:175], a[16:19], v[72:75], a[172:175]
v_exp_f32 v86, v86
v_mfma_f32_16x16x32_bf16 a[204:207], a[16:19], v[76:79], a[204:207]
v_exp_f32 v87, v87
v_mfma_f32_16x16x32_bf16 v[148:151], a[20:23], v[56:59], v[148:151]
v_cvt_pk_bf16_f32 v38, v84, v85
v_cvt_pk_bf16_f32 v39, v86, v87
v_mfma_f32_16x16x32_bf16 v[180:183], a[20:23], v[60:63], v[180:183]
v_mul_f32 v88, s31, v88
v_mul_f32 v89, s31, v89
v_mfma_f32_16x16x32_bf16 v[212:215], a[20:23], v[64:67], v[212:215]
v_mul_f32 v90, s31, v90
v_mul_f32 v91, s31, v91
v_mfma_f32_16x16x32_bf16 v[244:247], a[20:23], v[68:71], v[244:247]
v_exp_f32 v88, v88
v_mfma_f32_16x16x32_bf16 a[176:179], a[20:23], v[72:75], a[176:179]
v_exp_f32 v89, v89
v_mfma_f32_16x16x32_bf16 a[208:211], a[20:23], v[76:79], a[208:211]
v_exp_f32 v90, v90
v_mfma_f32_16x16x32_bf16 v[152:155], a[24:27], v[56:59], v[152:155]
v_exp_f32 v91, v91
v_mfma_f32_16x16x32_bf16 v[184:187], a[24:27], v[60:63], v[184:187]
v_cvt_pk_bf16_f32 v42, v88, v89
v_cvt_pk_bf16_f32 v43, v90, v91
v_mfma_f32_16x16x32_bf16 v[216:219], a[24:27], v[64:67], v[216:219]
v_mul_f32 v92, s31, v92
v_mul_f32 v93, s31, v93
v_mfma_f32_16x16x32_bf16 v[248:251], a[24:27], v[68:71], v[248:251]
v_mul_f32 v94, s31, v94
v_mul_f32 v95, s31, v95
v_mfma_f32_16x16x32_bf16 a[180:183], a[24:27], v[72:75], a[180:183]
v_exp_f32 v92, v92
v_mfma_f32_16x16x32_bf16 a[212:215], a[24:27], v[76:79], a[212:215]
v_exp_f32 v93, v93
v_mfma_f32_16x16x32_bf16 v[156:159], a[28:31], v[56:59], v[156:159]
v_exp_f32 v94, v94
v_mfma_f32_16x16x32_bf16 v[188:191], a[28:31], v[60:63], v[188:191]
v_exp_f32 v95, v95
v_mfma_f32_16x16x32_bf16 v[220:223], a[28:31], v[64:67], v[220:223]
v_cvt_pk_bf16_f32 v46, v92, v93
v_cvt_pk_bf16_f32 v47, v94, v95
v_mfma_f32_16x16x32_bf16 v[252:255], a[28:31], v[68:71], v[252:255]
v_mfma_f32_16x16x32_bf16 a[184:187], a[28:31], v[72:75], a[184:187]
v_mfma_f32_16x16x32_bf16 a[216:219], a[28:31], v[76:79], a[216:219]
s_waitcnt lgkmcnt(0)
ds_read_b128 a[16:19], v1 offset:30464
ds_read_b128 a[20:23], v1 offset:30528
v_mfma_f32_16x16x32_bf16 v[56:59], a[0:3], a[32:35], v[104:107]
v_mbcnt_lo_u32_b32 v28, -1, 0
v_mbcnt_hi_u32_b32 v28, -1, v28
v_bfe_u32 v28, v28, 2, 2
v_mfma_f32_16x16x32_bf16 v[56:59], a[4:7], a[36:39], v[56:59]
v_lshl_add_u32 v28, v28, 6, v8
v_xor_b32 v29, 64, v28
v_xor_b32 v30, 128, v28
v_mfma_f32_16x16x32_bf16 v[56:59], a[8:11], a[40:43], v[56:59]
ds_read_b128 a[24:27], v1 offset:30592
ds_read_b128 a[28:31], v1 offset:30656
v_mfma_f32_16x16x32_bf16 v[56:59], a[12:15], a[44:47], v[56:59]
v_xor_b32 v31, 192, v28
v_mul_f32 v96, s31, v96
v_mul_f32 v97, s31, v97
v_mfma_f32_16x16x32_bf16 v[60:63], a[0:3], a[48:51], v[108:111]
v_mul_f32 v98, s31, v98
v_mul_f32 v99, s31, v99
v_mul_f32 v100, s31, v100
v_mfma_f32_16x16x32_bf16 v[60:63], a[4:7], a[52:55], v[60:63]
v_exp_f32 v96, v96
v_mul_f32 v101, s31, v101
v_mfma_f32_16x16x32_bf16 v[60:63], a[8:11], a[56:59], v[60:63]
v_exp_f32 v97, v97
s_nop 0
v_cvt_pk_bf16_f32 v50, v96, v97
v_mfma_f32_16x16x32_bf16 v[60:63], a[12:15], a[60:63], v[60:63]
v_exp_f32 v98, v98
v_mul_f32 v102, s31, v102
v_mfma_f32_16x16x32_bf16 v[64:67], a[0:3], a[64:67], v[112:115]
v_exp_f32 v99, v99
v_mul_f32 v103, s31, v103
v_mfma_f32_16x16x32_bf16 v[64:67], a[4:7], a[68:71], v[64:67]
v_cvt_pk_bf16_f32 v51, v98, v99
v_mul_f32 v56, s31, v56
v_mfma_f32_16x16x32_bf16 v[64:67], a[8:11], a[72:75], v[64:67]
v_exp_f32 v100, v100
v_mul_f32 v57, s31, v57
v_mfma_f32_16x16x32_bf16 v[64:67], a[12:15], a[76:79], v[64:67]
v_exp_f32 v101, v101
s_waitcnt vmcnt(10)
s_barrier
v_mfma_f32_16x16x32_bf16 v[68:71], a[0:3], a[80:83], v[116:119]
v_exp_f32 v102, v102
v_cvt_pk_bf16_f32 v54, v100, v101
v_mfma_f32_16x16x32_bf16 v[68:71], a[4:7], a[84:87], v[68:71]
s_add_u32 m0, s37, 17408
s_add_u32 s40, s33, 16384
buffer_load_dwordx4 v6, s[16:19], s40 offen nt lds
v_mfma_f32_16x16x32_bf16 v[68:71], a[8:11], a[88:91], v[68:71]
v_exp_f32 v103, v103
v_mfma_f32_16x16x32_bf16 v[68:71], a[12:15], a[92:95], v[68:71]
v_cvt_pk_bf16_f32 v55, v102, v103
v_mul_f32 v58, s31, v58
v_mul_f32 v59, s31, v59
v_mfma_f32_16x16x32_bf16 v[72:75], a[0:3], a[96:99], v[120:123]
s_add_u32 m0, s37, 17472
s_nop 0
buffer_load_dwordx4 v6, s[16:19], s40 offen offset:1024 nt lds
v_mfma_f32_16x16x32_bf16 v[72:75], a[4:7], a[100:103], v[72:75]
v_exp_f32 v56, v56
v_mfma_f32_16x16x32_bf16 v[72:75], a[8:11], a[104:107], v[72:75]
v_exp_f32 v57, v57
s_nop 0
v_cvt_pk_bf16_f32 v56, v56, v57
v_mfma_f32_16x16x32_bf16 v[72:75], a[12:15], a[108:111], v[72:75]
v_exp_f32 v58, v58
v_mfma_f32_16x16x32_bf16 v[76:79], a[0:3], a[112:115], v[124:127]
v_exp_f32 v59, v59
v_mul_f32 v60, s31, v60
v_mfma_f32_16x16x32_bf16 v[76:79], a[4:7], a[116:119], v[76:79]
v_cvt_pk_bf16_f32 v57, v58, v59
v_mul_f32 v61, s31, v61
v_mfma_f32_16x16x32_bf16 v[76:79], a[8:11], a[120:123], v[76:79]
v_mul_f32 v62, s31, v62
v_mul_f32 v63, s31, v63
v_mul_f32 v64, s31, v64
v_mfma_f32_16x16x32_bf16 v[76:79], a[12:15], a[124:127], v[76:79]
s_waitcnt lgkmcnt(0)
ds_read_b64_tr_b16 a[0:1], v2 offset:16512
ds_read_b64_tr_b16 a[2:3], v2 offset:20640
v_mfma_f32_16x16x32_bf16 v[80:83], a[16:19], a[32:35], v[104:107]
v_exp_f32 v60, v60
v_mfma_f32_16x16x32_bf16 v[80:83], a[20:23], a[36:39], v[80:83]
v_exp_f32 v61, v61
s_nop 0
v_cvt_pk_bf16_f32 v60, v60, v61
v_mfma_f32_16x16x32_bf16 v[80:83], a[24:27], a[40:43], v[80:83]
ds_read_b64_tr_b16 a[4:5], v2 offset:16520
ds_read_b64_tr_b16 a[6:7], v2 offset:20648
v_mfma_f32_16x16x32_bf16 v[80:83], a[28:31], a[44:47], v[80:83]
ds_read_b128 a[32:35], v28 offset:0
ds_read_b128 a[36:39], v29 offset:0
ds_read_b128 a[40:43], v30 offset:0
ds_read_b128 a[44:47], v31 offset:0
v_mfma_f32_16x16x32_bf16 v[84:87], a[16:19], a[48:51], v[108:111]
v_exp_f32 v62, v62
v_mfma_f32_16x16x32_bf16 v[84:87], a[20:23], a[52:55], v[84:87]
ds_read_b64_tr_b16 a[8:9], v3 offset:16512
ds_read_b64_tr_b16 a[10:11], v3 offset:20640
v_mfma_f32_16x16x32_bf16 v[84:87], a[24:27], a[56:59], v[84:87]
v_exp_f32 v63, v63
v_mfma_f32_16x16x32_bf16 v[84:87], a[28:31], a[60:63], v[84:87]
ds_read_b128 a[48:51], v28 offset:4096
ds_read_b128 a[52:55], v29 offset:4096
ds_read_b128 a[56:59], v30 offset:4096
ds_read_b128 a[60:63], v31 offset:4096
v_mfma_f32_16x16x32_bf16 v[88:91], a[16:19], a[64:67], v[112:115]
ds_read_b64_tr_b16 a[12:13], v3 offset:16520
ds_read_b64_tr_b16 a[14:15], v3 offset:20648
v_mfma_f32_16x16x32_bf16 v[88:91], a[20:23], a[68:71], v[88:91]
v_cvt_pk_bf16_f32 v61, v62, v63
v_mul_f32 v65, s31, v65
v_mfma_f32_16x16x32_bf16 v[88:91], a[24:27], a[72:75], v[88:91]
v_mul_f32 v66, s31, v66
v_mul_f32 v67, s31, v67
v_mfma_f32_16x16x32_bf16 v[88:91], a[28:31], a[76:79], v[88:91]
s_add_u32 m0, s38, 8256
s_add_u32 s40, s33, 8192
buffer_load_dwordx4 v7, s[20:23], s40 offen nt lds
v_mfma_f32_16x16x32_bf16 v[92:95], a[16:19], a[80:83], v[116:119]
ds_read_b128 a[64:67], v28 offset:8192
ds_read_b128 a[68:71], v29 offset:8192
ds_read_b128 a[72:75], v30 offset:8192
ds_read_b128 a[76:79], v31 offset:8192
v_mfma_f32_16x16x32_bf16 v[92:95], a[20:23], a[84:87], v[92:95]
v_exp_f32 v64, v64
v_mfma_f32_16x16x32_bf16 v[92:95], a[24:27], a[88:91], v[92:95]
s_add_u32 m0, s38, 8264
s_nop 0
buffer_load_dwordx4 v7, s[20:23], s40 offen offset:1024 nt lds
v_mfma_f32_16x16x32_bf16 v[92:95], a[28:31], a[92:95], v[92:95]
ds_read_b128 a[80:83], v28 offset:12288
ds_read_b128 a[84:87], v29 offset:12288
ds_read_b128 a[88:91], v30 offset:12288
ds_read_b128 a[92:95], v31 offset:12288
v_mfma_f32_16x16x32_bf16 v[96:99], a[16:19], a[96:99], v[120:123]
v_exp_f32 v65, v65
v_mfma_f32_16x16x32_bf16 v[96:99], a[20:23], a[100:103], v[96:99]
v_exp_f32 v66, v66
v_mfma_f32_16x16x32_bf16 v[96:99], a[24:27], a[104:107], v[96:99]
v_exp_f32 v67, v67
v_mfma_f32_16x16x32_bf16 v[96:99], a[28:31], a[108:111], v[96:99]
ds_read_b128 a[96:99], v28 offset:16384
ds_read_b128 a[100:103], v29 offset:16384
ds_read_b128 a[104:107], v30 offset:16384
ds_read_b128 a[108:111], v31 offset:16384
v_mfma_f32_16x16x32_bf16 v[100:103], a[16:19], a[112:115], v[124:127]
s_waitcnt vmcnt(11)
v_accvgpr_mov_b32 a112, a220
v_accvgpr_mov_b32 a113, a221
v_mfma_f32_16x16x32_bf16 v[100:103], a[20:23], a[116:119], v[100:103]
v_accvgpr_mov_b32 a114, a222
v_accvgpr_mov_b32 a115, a223
v_mfma_f32_16x16x32_bf16 v[100:103], a[24:27], a[120:123], v[100:103]
s_waitcnt vmcnt(10)
v_accvgpr_mov_b32 a116, a224
v_accvgpr_mov_b32 a117, a225
v_mfma_f32_16x16x32_bf16 v[100:103], a[28:31], a[124:127], v[100:103]
s_waitcnt lgkmcnt(12)
ds_read_b64_tr_b16 a[16:17], v4 offset:16512
ds_read_b64_tr_b16 a[18:19], v4 offset:20640
v_mfma_f32_16x16x32_bf16 a[132:135], a[128:131], v[32:35], a[132:135]
v_accvgpr_mov_b32 a118, a226
v_accvgpr_mov_b32 a119, a227
v_mfma_f32_16x16x32_bf16 a[136:139], a[128:131], v[36:39], a[136:139]
s_waitcnt vmcnt(9)
v_accvgpr_mov_b32 a120, a228
v_accvgpr_mov_b32 a121, a229
v_mfma_f32_16x16x32_bf16 a[140:143], a[128:131], v[40:43], a[140:143]
ds_read_b64_tr_b16 a[20:21], v4 offset:16520
ds_read_b64_tr_b16 a[22:23], v4 offset:20648
v_mfma_f32_16x16x32_bf16 a[144:147], a[128:131], v[44:47], a[144:147]
v_accvgpr_mov_b32 a122, a230
v_accvgpr_mov_b32 a123, a231
v_mfma_f32_16x16x32_bf16 a[148:151], a[128:131], v[48:51], a[148:151]
s_waitcnt vmcnt(8)
v_accvgpr_mov_b32 a124, a232
v_accvgpr_mov_b32 a125, a233
v_mfma_f32_16x16x32_bf16 a[152:155], a[128:131], v[52:55], a[152:155]
v_accvgpr_mov_b32 a126, a234
v_accvgpr_mov_b32 a127, a235
v_mfma_f32_16x16x32_bf16 v[128:131], a[0:3], v[32:35], v[128:131]
v_cvt_pk_bf16_f32 v64, v64, v65
v_cvt_pk_bf16_f32 v65, v66, v67
v_mfma_f32_16x16x32_bf16 v[160:163], a[0:3], v[36:39], v[160:163]
ds_read_b64_tr_b16 a[24:25], v5 offset:16512
ds_read_b64_tr_b16 a[26:27], v5 offset:20640
v_mfma_f32_16x16x32_bf16 v[192:195], a[0:3], v[40:43], v[192:195]
v_mul_f32 v68, s31, v68
v_mul_f32 v69, s31, v69
v_mfma_f32_16x16x32_bf16 v[224:227], a[0:3], v[44:47], v[224:227]
v_mul_f32 v70, s31, v70
v_mul_f32 v71, s31, v71
v_mfma_f32_16x16x32_bf16 a[156:159], a[0:3], v[48:51], a[156:159]
ds_read_b64_tr_b16 a[28:29], v5 offset:16520
ds_read_b64_tr_b16 a[30:31], v5 offset:20648
v_mfma_f32_16x16x32_bf16 a[188:191], a[0:3], v[52:55], a[188:191]
v_exp_f32 v68, v68
v_mfma_f32_16x16x32_bf16 v[132:135], a[4:7], v[32:35], v[132:135]
v_exp_f32 v69, v69
v_mfma_f32_16x16x32_bf16 v[164:167], a[4:7], v[36:39], v[164:167]
v_exp_f32 v70, v70
v_mfma_f32_16x16x32_bf16 v[196:199], a[4:7], v[40:43], v[196:199]
v_exp_f32 v71, v71
v_mfma_f32_16x16x32_bf16 v[228:231], a[4:7], v[44:47], v[228:231]
v_cvt_pk_bf16_f32 v68, v68, v69
v_cvt_pk_bf16_f32 v69, v70, v71
v_mfma_f32_16x16x32_bf16 a[160:163], a[4:7], v[48:51], a[160:163]
v_mul_f32 v72, s31, v72
v_mul_f32 v73, s31, v73
v_mfma_f32_16x16x32_bf16 a[192:195], a[4:7], v[52:55], a[192:195]
v_mul_f32 v74, s31, v74
v_mul_f32 v75, s31, v75
v_mfma_f32_16x16x32_bf16 v[136:139], a[8:11], v[32:35], v[136:139]
v_exp_f32 v72, v72
v_mfma_f32_16x16x32_bf16 v[168:171], a[8:11], v[36:39], v[168:171]
v_exp_f32 v73, v73
v_mfma_f32_16x16x32_bf16 v[200:203], a[8:11], v[40:43], v[200:203]
v_exp_f32 v74, v74
v_mfma_f32_16x16x32_bf16 v[232:235], a[8:11], v[44:47], v[232:235]
v_exp_f32 v75, v75
v_mfma_f32_16x16x32_bf16 a[164:167], a[8:11], v[48:51], a[164:167]
v_cvt_pk_bf16_f32 v72, v72, v73
v_cvt_pk_bf16_f32 v73, v74, v75
v_mfma_f32_16x16x32_bf16 a[196:199], a[8:11], v[52:55], a[196:199]
v_mul_f32 v76, s31, v76
v_mul_f32 v77, s31, v77
v_mfma_f32_16x16x32_bf16 v[140:143], a[12:15], v[32:35], v[140:143]
v_mul_f32 v78, s31, v78
v_mul_f32 v79, s31, v79
v_mfma_f32_16x16x32_bf16 v[172:175], a[12:15], v[36:39], v[172:175]
v_exp_f32 v76, v76
v_mfma_f32_16x16x32_bf16 v[204:207], a[12:15], v[40:43], v[204:207]
v_exp_f32 v77, v77
v_mfma_f32_16x16x32_bf16 v[236:239], a[12:15], v[44:47], v[236:239]
v_exp_f32 v78, v78
v_mfma_f32_16x16x32_bf16 a[168:171], a[12:15], v[48:51], a[168:171]
v_exp_f32 v79, v79
v_cvt_pk_bf16_f32 v76, v76, v77
v_mfma_f32_16x16x32_bf16 a[200:203], a[12:15], v[52:55], a[200:203]
s_waitcnt lgkmcnt(0)
ds_read_b128 a[0:3], v1 offset:0
ds_read_b128 a[4:7], v1 offset:64
v_mfma_f32_16x16x32_bf16 v[144:147], a[16:19], v[32:35], v[144:147]
v_cvt_pk_bf16_f32 v77, v78, v79
v_mul_f32 v80, s31, v80
v_mfma_f32_16x16x32_bf16 v[176:179], a[16:19], v[36:39], v[176:179]
v_mul_f32 v81, s31, v81
v_mul_f32 v82, s31, v82
v_mul_f32 v83, s31, v83
v_mfma_f32_16x16x32_bf16 v[208:211], a[16:19], v[40:43], v[208:211]
ds_read_b128 a[8:11], v1 offset:128
ds_read_b128 a[12:15], v1 offset:192
v_mfma_f32_16x16x32_bf16 v[240:243], a[16:19], v[44:47], v[240:243]
v_exp_f32 v80, v80
v_mfma_f32_16x16x32_bf16 a[172:175], a[16:19], v[48:51], a[172:175]
v_exp_f32 v81, v81
s_nop 0
v_cvt_pk_bf16_f32 v58, v80, v81
v_mfma_f32_16x16x32_bf16 a[204:207], a[16:19], v[52:55], a[204:207]
v_exp_f32 v82, v82
v_mfma_f32_16x16x32_bf16 v[148:151], a[20:23], v[32:35], v[148:151]
v_exp_f32 v83, v83
v_mul_f32 v84, s31, v84
v_mfma_f32_16x16x32_bf16 v[180:183], a[20:23], v[36:39], v[180:183]
v_cvt_pk_bf16_f32 v59, v82, v83
v_mul_f32 v85, s31, v85
v_mfma_f32_16x16x32_bf16 v[212:215], a[20:23], v[40:43], v[212:215]
v_mul_f32 v86, s31, v86
v_mul_f32 v87, s31, v87
v_mul_f32 v88, s31, v88
v_mfma_f32_16x16x32_bf16 v[244:247], a[20:23], v[44:47], v[244:247]
v_exp_f32 v84, v84
v_mfma_f32_16x16x32_bf16 a[176:179], a[20:23], v[48:51], a[176:179]
v_exp_f32 v85, v85
s_nop 0
v_cvt_pk_bf16_f32 v62, v84, v85
v_mfma_f32_16x16x32_bf16 a[208:211], a[20:23], v[52:55], a[208:211]
v_exp_f32 v86, v86
v_mfma_f32_16x16x32_bf16 v[152:155], a[24:27], v[32:35], v[152:155]
v_exp_f32 v87, v87
v_mul_f32 v89, s31, v89
v_mfma_f32_16x16x32_bf16 v[184:187], a[24:27], v[36:39], v[184:187]
v_cvt_pk_bf16_f32 v63, v86, v87
v_mul_f32 v90, s31, v90
v_mfma_f32_16x16x32_bf16 v[216:219], a[24:27], v[40:43], v[216:219]
v_mul_f32 v91, s31, v91
v_exp_f32 v88, v88
v_mfma_f32_16x16x32_bf16 v[248:251], a[24:27], v[44:47], v[248:251]
v_exp_f32 v89, v89
v_mfma_f32_16x16x32_bf16 a[180:183], a[24:27], v[48:51], a[180:183]
v_exp_f32 v90, v90
v_cvt_pk_bf16_f32 v66, v88, v89
v_mfma_f32_16x16x32_bf16 a[212:215], a[24:27], v[52:55], a[212:215]
v_exp_f32 v91, v91
v_mfma_f32_16x16x32_bf16 v[156:159], a[28:31], v[32:35], v[156:159]
v_cvt_pk_bf16_f32 v67, v90, v91
v_mul_f32 v92, s31, v92
v_mul_f32 v93, s31, v93
v_mfma_f32_16x16x32_bf16 v[188:191], a[28:31], v[36:39], v[188:191]
v_mul_f32 v94, s31, v94
v_mul_f32 v95, s31, v95
v_mfma_f32_16x16x32_bf16 v[220:223], a[28:31], v[40:43], v[220:223]
v_exp_f32 v92, v92
v_mfma_f32_16x16x32_bf16 v[252:255], a[28:31], v[44:47], v[252:255]
v_exp_f32 v93, v93
s_nop 0
v_cvt_pk_bf16_f32 v70, v92, v93
v_mfma_f32_16x16x32_bf16 a[184:187], a[28:31], v[48:51], a[184:187]
v_exp_f32 v94, v94
v_mfma_f32_16x16x32_bf16 a[216:219], a[28:31], v[52:55], a[216:219]
v_exp_f32 v95, v95
s_nop 0
v_cvt_pk_bf16_f32 v71, v94, v95
s_cmp_eq_u32 s42, 3
s_cbranch_scc1 L_it15L
s_waitcnt lgkmcnt(0)
ds_read_b128 a[16:19], v1 offset:4352
ds_read_b128 a[20:23], v1 offset:4416
v_mfma_f32_16x16x32_bf16 v[32:35], a[0:3], a[32:35], 0
v_mul_f32 v96, s31, v96
v_mul_f32 v97, s31, v97
v_mul_f32 v98, s31, v98
v_mul_f32 v99, s31, v99
v_mul_f32 v100, s31, v100
v_mfma_f32_16x16x32_bf16 v[32:35], a[4:7], a[36:39], v[32:35]
v_exp_f32 v96, v96
v_exp_f32 v97, v97
s_nop 0
v_cvt_pk_bf16_f32 v74, v96, v97
v_mfma_f32_16x16x32_bf16 v[32:35], a[8:11], a[40:43], v[32:35]
ds_read_b128 a[24:27], v1 offset:4480
ds_read_b128 a[28:31], v1 offset:4544
v_mfma_f32_16x16x32_bf16 v[32:35], a[12:15], a[44:47], v[32:35]
v_exp_f32 v98, v98
v_exp_f32 v99, v99
v_mul_f32 v101, s31, v101
v_mfma_f32_16x16x32_bf16 v[36:39], a[0:3], a[48:51], 0
v_cvt_pk_bf16_f32 v75, v98, v99
v_mul_f32 v102, s31, v102
v_mul_f32 v103, s31, v103
v_exp_f32 v100, v100
v_mfma_f32_16x16x32_bf16 v[36:39], a[4:7], a[52:55], v[36:39]
v_exp_f32 v101, v101
v_exp_f32 v102, v102
v_cvt_pk_bf16_f32 v78, v100, v101
v_mfma_f32_16x16x32_bf16 v[36:39], a[8:11], a[56:59], v[36:39]
v_exp_f32 v103, v103
s_add_u32 s36, s35, 20480
v_cvt_pk_bf16_f32 v79, v102, v103
v_mfma_f32_16x16x32_bf16 v[36:39], a[12:15], a[60:63], v[36:39]
v_mfma_f32_16x16x32_bf16 v[40:43], a[0:3], a[64:67], 0
v_max3_f32 v12, v32, v33, v34
v_max_f32 v12, v12, v35
v_mov_b32 v13, v12
v_mfma_f32_16x16x32_bf16 v[40:43], a[4:7], a[68:71], v[40:43]
s_nop 0
v_permlane32_swap_b32 v12, v13
v_max_f32 v12, v12, v13
v_mov_b32 v13, v12
v_mfma_f32_16x16x32_bf16 v[40:43], a[8:11], a[72:75], v[40:43]
s_nop 0
v_permlane16_swap_b32 v12, v13
v_max_f32 v12, v12, v13
v_sub_f32 v104, s57, v12
v_sub_f32 v105, s57, v12
v_sub_f32 v106, s57, v12
v_mfma_f32_16x16x32_bf16 v[40:43], a[12:15], a[76:79], v[40:43]
v_sub_f32 v107, s57, v12
v_add_f32 v32, v32, v104
v_add_f32 v33, v33, v104
v_add_f32 v34, v34, v104
v_add_f32 v35, v35, v104
s_waitcnt vmcnt(6)
s_barrier
v_mfma_f32_16x16x32_bf16 v[44:47], a[0:3], a[80:83], 0
v_max3_f32 v12, v36, v37, v38
v_max_f32 v12, v12, v39
v_mov_b32 v13, v12
v_mul_f32 v32, s31, v32
s_nop 0
v_permlane32_swap_b32 v12, v13
v_mfma_f32_16x16x32_bf16 v[44:47], a[4:7], a[84:87], v[44:47]
s_add_u32 m0, s37, 26112
s_add_u32 s40, s33, 24576
buffer_load_dwordx4 v6, s[16:19], s40 offen nt lds
v_mfma_f32_16x16x32_bf16 v[44:47], a[8:11], a[88:91], v[44:47]
v_max_f32 v12, v12, v13
v_mov_b32 v13, v12
v_mul_f32 v33, s31, v33
s_nop 0
v_permlane16_swap_b32 v12, v13
v_max_f32 v12, v12, v13
v_mfma_f32_16x16x32_bf16 v[44:47], a[12:15], a[92:95], v[44:47]
v_sub_f32 v108, s57, v12
v_sub_f32 v109, s57, v12
v_sub_f32 v110, s57, v12
v_sub_f32 v111, s57, v12
v_max3_f32 v12, v40, v41, v42
v_mfma_f32_16x16x32_bf16 v[48:51], a[0:3], a[96:99], 0
s_add_u32 m0, s37, 26176
s_nop 0
buffer_load_dwordx4 v6, s[16:19], s40 offen offset:1024 nt lds
v_mfma_f32_16x16x32_bf16 v[48:51], a[4:7], a[100:103], v[48:51]
v_max_f32 v12, v12, v43
v_mov_b32 v13, v12
v_mul_f32 v34, s31, v34
s_nop 0
v_permlane32_swap_b32 v12, v13
v_max_f32 v12, v12, v13
v_mfma_f32_16x16x32_bf16 v[48:51], a[8:11], a[104:107], v[48:51]
v_mov_b32 v13, v12
v_mul_f32 v35, s31, v35
s_nop 0
v_permlane16_swap_b32 v12, v13
v_max_f32 v12, v12, v13
v_sub_f32 v112, s57, v12
v_mfma_f32_16x16x32_bf16 v[48:51], a[12:15], a[108:111], v[48:51]
v_sub_f32 v113, s57, v12
v_sub_f32 v114, s57, v12
v_sub_f32 v115, s57, v12
v_exp_f32 v32, v32
v_mfma_f32_16x16x32_bf16 v[52:55], a[0:3], a[112:115], 0
v_max3_f32 v12, v44, v45, v46
v_max_f32 v12, v12, v47
v_mov_b32 v13, v12
v_exp_f32 v33, v33
v_mfma_f32_16x16x32_bf16 v[52:55], a[4:7], a[116:119], v[52:55]
v_permlane32_swap_b32 v12, v13
v_max_f32 v12, v12, v13
v_mov_b32 v13, v12
v_exp_f32 v34, v34
v_mfma_f32_16x16x32_bf16 v[52:55], a[8:11], a[120:123], v[52:55]
v_permlane16_swap_b32 v12, v13
v_max_f32 v12, v12, v13
v_sub_f32 v116, s57, v12
v_sub_f32 v117, s57, v12
v_sub_f32 v118, s57, v12
v_mfma_f32_16x16x32_bf16 v[52:55], a[12:15], a[124:127], v[52:55]
s_waitcnt lgkmcnt(0)
ds_read_b64_tr_b16 a[0:1], v2 offset:24768
ds_read_b64_tr_b16 a[2:3], v2 offset:28896
v_mfma_f32_16x16x32_bf16 v[80:83], a[16:19], a[32:35], v[104:107]
v_sub_f32 v119, s57, v12
v_max3_f32 v12, v48, v49, v50
v_max_f32 v12, v12, v51
v_mov_b32 v13, v12
v_cvt_pk_bf16_f32 v32, v32, v33
v_mfma_f32_16x16x32_bf16 v[80:83], a[20:23], a[36:39], v[80:83]
v_permlane32_swap_b32 v12, v13
v_max_f32 v12, v12, v13
v_mov_b32 v13, v12
v_exp_f32 v35, v35
v_mfma_f32_16x16x32_bf16 v[80:83], a[24:27], a[40:43], v[80:83]
ds_read_b64_tr_b16 a[4:5], v2 offset:24776
ds_read_b64_tr_b16 a[6:7], v2 offset:28904
v_mfma_f32_16x16x32_bf16 v[80:83], a[28:31], a[44:47], v[80:83]
v_permlane16_swap_b32 v12, v13
v_max_f32 v12, v12, v13
v_sub_f32 v120, s57, v12
v_sub_f32 v121, s57, v12
v_sub_f32 v122, s57, v12
v_mfma_f32_16x16x32_bf16 v[84:87], a[16:19], a[48:51], v[108:111]
v_sub_f32 v123, s57, v12
v_max3_f32 v12, v52, v53, v54
v_max_f32 v12, v12, v55
v_mov_b32 v13, v12
v_cvt_pk_bf16_f32 v33, v34, v35
v_mfma_f32_16x16x32_bf16 v[84:87], a[20:23], a[52:55], v[84:87]
ds_read_b64_tr_b16 a[8:9], v3 offset:24768
ds_read_b64_tr_b16 a[10:11], v3 offset:28896
v_mfma_f32_16x16x32_bf16 v[84:87], a[24:27], a[56:59], v[84:87]
v_permlane32_swap_b32 v12, v13
v_max_f32 v12, v12, v13
v_mov_b32 v13, v12
v_add_f32 v36, v36, v108
s_nop 0
v_permlane16_swap_b32 v12, v13
v_mfma_f32_16x16x32_bf16 v[84:87], a[28:31], a[60:63], v[84:87]
v_max_f32 v12, v12, v13
v_sub_f32 v124, s57, v12
v_sub_f32 v125, s57, v12
v_sub_f32 v126, s57, v12
v_sub_f32 v127, s57, v12
v_mfma_f32_16x16x32_bf16 v[88:91], a[16:19], a[64:67], v[112:115]
ds_read_b64_tr_b16 a[12:13], v3 offset:24776
ds_read_b64_tr_b16 a[14:15], v3 offset:28904
v_mfma_f32_16x16x32_bf16 v[88:91], a[20:23], a[68:71], v[88:91]
v_add_f32 v37, v37, v108
v_add_f32 v38, v38, v108
v_add_f32 v39, v39, v108
v_mul_f32 v36, s31, v36
v_mul_f32 v37, s31, v37
v_mfma_f32_16x16x32_bf16 v[88:91], a[24:27], a[72:75], v[88:91]
v_mul_f32 v38, s31, v38
v_mul_f32 v39, s31, v39
v_exp_f32 v36, v36
v_add_f32 v40, v40, v112
v_mfma_f32_16x16x32_bf16 v[88:91], a[28:31], a[76:79], v[88:91]
s_add_u32 m0, s38, 16512
s_add_u32 s40, s33, 16384
buffer_load_dwordx4 v7, s[20:23], s40 offen nt lds
v_mfma_f32_16x16x32_bf16 v[92:95], a[16:19], a[80:83], v[116:119]
v_exp_f32 v37, v37
v_exp_f32 v38, v38
v_cvt_pk_bf16_f32 v36, v36, v37
v_mfma_f32_16x16x32_bf16 v[92:95], a[20:23], a[84:87], v[92:95]
v_exp_f32 v39, v39
v_add_f32 v41, v41, v112
v_cvt_pk_bf16_f32 v37, v38, v39
v_add_f32 v42, v42, v112
v_mfma_f32_16x16x32_bf16 v[92:95], a[24:27], a[88:91], v[92:95]
s_add_u32 m0, s38, 16520
s_nop 0
buffer_load_dwordx4 v7, s[20:23], s40 offen offset:1024 nt lds
v_mfma_f32_16x16x32_bf16 v[92:95], a[28:31], a[92:95], v[92:95]
v_add_f32 v43, v43, v112
v_mul_f32 v40, s31, v40
v_mul_f32 v41, s31, v41
v_mul_f32 v42, s31, v42
v_mul_f32 v43, s31, v43
v_mfma_f32_16x16x32_bf16 v[96:99], a[16:19], a[96:99], v[120:123]
v_exp_f32 v40, v40
v_exp_f32 v41, v41
s_nop 0
v_cvt_pk_bf16_f32 v40, v40, v41
v_mfma_f32_16x16x32_bf16 v[96:99], a[20:23], a[100:103], v[96:99]
v_exp_f32 v42, v42
v_exp_f32 v43, v43
v_add_f32 v44, v44, v116
v_mfma_f32_16x16x32_bf16 v[96:99], a[24:27], a[104:107], v[96:99]
v_cvt_pk_bf16_f32 v41, v42, v43
v_add_f32 v45, v45, v116
v_add_f32 v46, v46, v116
v_add_f32 v47, v47, v116
v_mul_f32 v44, s31, v44
v_mfma_f32_16x16x32_bf16 v[96:99], a[28:31], a[108:111], v[96:99]
v_mul_f32 v45, s31, v45
v_mul_f32 v46, s31, v46
v_mul_f32 v47, s31, v47
v_exp_f32 v44, v44
v_mfma_f32_16x16x32_bf16 v[100:103], a[16:19], a[112:115], v[124:127]
v_exp_f32 v45, v45
v_exp_f32 v46, v46
v_cvt_pk_bf16_f32 v44, v44, v45
v_mfma_f32_16x16x32_bf16 v[100:103], a[20:23], a[116:119], v[100:103]
v_exp_f32 v47, v47
v_add_f32 v48, v48, v120
v_cvt_pk_bf16_f32 v45, v46, v47
v_add_f32 v49, v49, v120
v_mfma_f32_16x16x32_bf16 v[100:103], a[24:27], a[120:123], v[100:103]
v_add_f32 v50, v50, v120
v_add_f32 v51, v51, v120
v_mul_f32 v48, s31, v48
v_mul_f32 v49, s31, v49
v_mul_f32 v50, s31, v50
v_mfma_f32_16x16x32_bf16 v[100:103], a[28:31], a[124:127], v[100:103]
s_waitcnt lgkmcnt(0)
ds_read_b64_tr_b16 a[16:17], v4 offset:24768
ds_read_b64_tr_b16 a[18:19], v4 offset:28896
v_mfma_f32_16x16x32_bf16 a[132:135], a[128:131], v[56:59], a[132:135]
v_mul_f32 v51, s31, v51
v_exp_f32 v48, v48
v_exp_f32 v49, v49
v_mfma_f32_16x16x32_bf16 a[136:139], a[128:131], v[60:63], a[136:139]
v_exp_f32 v50, v50
v_exp_f32 v51, v51
v_cvt_pk_bf16_f32 v48, v48, v49
v_mfma_f32_16x16x32_bf16 a[140:143], a[128:131], v[64:67], a[140:143]
ds_read_b64_tr_b16 a[20:21], v4 offset:24776
ds_read_b64_tr_b16 a[22:23], v4 offset:28904
v_mfma_f32_16x16x32_bf16 a[144:147], a[128:131], v[68:71], a[144:147]
v_cvt_pk_bf16_f32 v49, v50, v51
v_add_f32 v52, v52, v124
v_add_f32 v53, v53, v124
v_add_f32 v54, v54, v124
v_add_f32 v55, v55, v124
v_mfma_f32_16x16x32_bf16 a[148:151], a[128:131], v[72:75], a[148:151]
v_mul_f32 v52, s31, v52
v_mul_f32 v53, s31, v53
v_mul_f32 v54, s31, v54
v_mul_f32 v55, s31, v55
v_mul_f32 v80, s31, v80
v_mfma_f32_16x16x32_bf16 a[152:155], a[128:131], v[76:79], a[152:155]
v_exp_f32 v52, v52
v_exp_f32 v53, v53
s_nop 0
v_cvt_pk_bf16_f32 v52, v52, v53
v_mfma_f32_16x16x32_bf16 v[128:131], a[0:3], v[56:59], v[128:131]
v_exp_f32 v54, v54
v_exp_f32 v55, v55
v_mul_f32 v81, s31, v81
v_mfma_f32_16x16x32_bf16 v[160:163], a[0:3], v[60:63], v[160:163]
ds_read_b64_tr_b16 a[24:25], v5 offset:24768
ds_read_b64_tr_b16 a[26:27], v5 offset:28896
v_mfma_f32_16x16x32_bf16 v[192:195], a[0:3], v[64:67], v[192:195]
v_cvt_pk_bf16_f32 v53, v54, v55
v_mul_f32 v82, s31, v82
v_mul_f32 v83, s31, v83
v_exp_f32 v80, v80
v_mfma_f32_16x16x32_bf16 v[224:227], a[0:3], v[68:71], v[224:227]
v_exp_f32 v81, v81
v_exp_f32 v82, v82
v_cvt_pk_bf16_f32 v34, v80, v81
v_mfma_f32_16x16x32_bf16 a[156:159], a[0:3], v[72:75], a[156:159]
ds_read_b64_tr_b16 a[28:29], v5 offset:24776
ds_read_b64_tr_b16 a[30:31], v5 offset:28904
v_mfma_f32_16x16x32_bf16 a[188:191], a[0:3], v[76:79], a[188:191]
v_exp_f32 v83, v83
v_mul_f32 v84, s31, v84
v_cvt_pk_bf16_f32 v35, v82, v83
v_mul_f32 v85, s31, v85
v_mfma_f32_16x16x32_bf16 v[132:135], a[4:7], v[56:59], v[132:135]
v_mul_f32 v86, s31, v86
v_mul_f32 v87, s31, v87
v_exp_f32 v84, v84
v_mul_f32 v88, s31, v88
v_mfma_f32_16x16x32_bf16 v[164:167], a[4:7], v[60:63], v[164:167]
v_exp_f32 v85, v85
v_exp_f32 v86, v86
v_cvt_pk_bf16_f32 v38, v84, v85
v_mfma_f32_16x16x32_bf16 v[196:199], a[4:7], v[64:67], v[196:199]
v_exp_f32 v87, v87
v_mul_f32 v89, s31, v89
v_cvt_pk_bf16_f32 v39, v86, v87
v_mul_f32 v90, s31, v90
v_mfma_f32_16x16x32_bf16 v[228:231], a[4:7], v[68:71], v[228:231]
v_mul_f32 v91, s31, v91
v_exp_f32 v88, v88
v_exp_f32 v89, v89
v_mfma_f32_16x16x32_bf16 a[160:163], a[4:7], v[72:75], a[160:163]
v_exp_f32 v90, v90
v_exp_f32 v91, v91
v_cvt_pk_bf16_f32 v42, v88, v89
v_mfma_f32_16x16x32_bf16 a[192:195], a[4:7], v[76:79], a[192:195]
v_cvt_pk_bf16_f32 v43, v90, v91
v_mul_f32 v92, s31, v92
v_mul_f32 v93, s31, v93
v_mul_f32 v94, s31, v94
v_mul_f32 v95, s31, v95
v_mfma_f32_16x16x32_bf16 v[136:139], a[8:11], v[56:59], v[136:139]
v_exp_f32 v92, v92
v_exp_f32 v93, v93
s_nop 0
v_cvt_pk_bf16_f32 v46, v92, v93
v_mfma_f32_16x16x32_bf16 v[168:171], a[8:11], v[60:63], v[168:171]
v_exp_f32 v94, v94
v_exp_f32 v95, v95
v_accvgpr_read_b32 v10, a132
v_mfma_f32_16x16x32_bf16 v[200:203], a[8:11], v[64:67], v[200:203]
v_cvt_pk_bf16_f32 v47, v94, v95
v_cmp_nge_f32 vcc, s44, v10
s_cmp_lg_u64 vcc, 0
s_cselect_b32 s46, s47, 0
s_or_b32 s43, s43, s46
v_rcp_f32 v10, v10
v_mfma_f32_16x16x32_bf16 v[232:235], a[8:11], v[68:71], v[232:235]
v_mul_f32 v128, v128, v10
v_mul_f32 v129, v129, v10
v_mul_f32 v130, v130, v10
v_mul_f32 v131, v131, v10
v_cvt_pk_bf16_f32 v20, v128, v129
v_mfma_f32_16x16x32_bf16 a[164:167], a[8:11], v[72:75], a[164:167]
v_cvt_pk_bf16_f32 v21, v130, v131
v_mul_f32 v132, v132, v10
v_mul_f32 v133, v133, v10
v_mul_f32 v134, v134, v10
v_mul_f32 v135, v135, v10
v_mfma_f32_16x16x32_bf16 a[196:199], a[8:11], v[76:79], a[196:199]
v_cvt_pk_bf16_f32 v22, v132, v133
v_cvt_pk_bf16_f32 v23, v134, v135
v_accvgpr_read_b32 v11, a136
v_cmp_nge_f32 vcc, s44, v11
s_cmp_lg_u64 vcc, 0
s_cselect_b32 s46, s47, 0
s_or_b32 s43, s43, s46
v_mfma_f32_16x16x32_bf16 v[140:143], a[12:15], v[56:59], v[140:143]
ds_write_b128 v8, v[20:23] offset:0
v_mfma_f32_16x16x32_bf16 v[172:175], a[12:15], v[60:63], v[172:175]
v_rcp_f32 v11, v11
v_accvgpr_read_b32 v10, a140
v_mul_f32 v160, v160, v11
v_mul_f32 v161, v161, v11
v_mfma_f32_16x16x32_bf16 v[204:207], a[12:15], v[64:67], v[204:207]
v_mul_f32 v162, v162, v11
v_mul_f32 v163, v163, v11
v_cvt_pk_bf16_f32 v24, v160, v161
v_cvt_pk_bf16_f32 v25, v162, v163
v_mul_f32 v164, v164, v11
v_mfma_f32_16x16x32_bf16 v[236:239], a[12:15], v[68:71], v[236:239]
v_mul_f32 v165, v165, v11
v_mul_f32 v166, v166, v11
v_mul_f32 v167, v167, v11
v_cvt_pk_bf16_f32 v26, v164, v165
v_cvt_pk_bf16_f32 v27, v166, v167
v_mfma_f32_16x16x32_bf16 a[168:171], a[12:15], v[72:75], a[168:171]
ds_write_b128 v8, v[24:27] offset:4096
v_mfma_f32_16x16x32_bf16 a[200:203], a[12:15], v[76:79], a[200:203]
s_waitcnt lgkmcnt(2)
ds_read_b128 a[0:3], v1 offset:8704
ds_read_b128 a[4:7], v1 offset:8768
v_mfma_f32_16x16x32_bf16 v[144:147], a[16:19], v[56:59], v[144:147]
v_cmp_nge_f32 vcc, s44, v10
s_cmp_lg_u64 vcc, 0
s_cselect_b32 s46, s47, 0
s_or_b32 s43, s43, s46
v_rcp_f32 v10, v10
v_accvgpr_read_b32 v11, a144
v_mfma_f32_16x16x32_bf16 v[176:179], a[16:19], v[60:63], v[176:179]
v_mul_f32 v192, v192, v10
v_mul_f32 v193, v193, v10
v_mul_f32 v194, v194, v10
v_mul_f32 v195, v195, v10
v_cvt_pk_bf16_f32 v20, v192, v193
v_mfma_f32_16x16x32_bf16 v[208:211], a[16:19], v[64:67], v[208:211]
ds_read_b128 a[8:11], v1 offset:8832
ds_read_b128 a[12:15], v1 offset:8896
v_mfma_f32_16x16x32_bf16 v[240:243], a[16:19], v[68:71], v[240:243]
v_cvt_pk_bf16_f32 v21, v194, v195
v_mul_f32 v196, v196, v10
v_mul_f32 v197, v197, v10
v_mul_f32 v198, v198, v10
v_mul_f32 v199, v199, v10
v_mfma_f32_16x16x32_bf16 a[172:175], a[16:19], v[72:75], a[172:175]
v_cvt_pk_bf16_f32 v22, v196, v197
v_cvt_pk_bf16_f32 v23, v198, v199
v_cmp_nge_f32 vcc, s44, v11
s_cmp_lg_u64 vcc, 0
s_cselect_b32 s46, s47, 0
s_or_b32 s43, s43, s46
v_accvgpr_read_b32 v10, a148
v_mfma_f32_16x16x32_bf16 a[204:207], a[16:19], v[76:79], a[204:207]
ds_write_b128 v8, v[20:23] offset:8192
v_mfma_f32_16x16x32_bf16 v[148:151], a[20:23], v[56:59], v[148:151]
v_rcp_f32 v11, v11
v_cmp_nge_f32 vcc, s44, v10
v_mul_f32 v224, v224, v11
v_mul_f32 v225, v225, v11
v_mfma_f32_16x16x32_bf16 v[180:183], a[20:23], v[60:63], v[180:183]
v_mul_f32 v226, v226, v11
v_mul_f32 v227, v227, v11
v_cvt_pk_bf16_f32 v24, v224, v225
v_cvt_pk_bf16_f32 v25, v226, v227
v_mul_f32 v228, v228, v11
v_mfma_f32_16x16x32_bf16 v[212:215], a[20:23], v[64:67], v[212:215]
v_mul_f32 v229, v229, v11
v_mul_f32 v230, v230, v11
v_mul_f32 v231, v231, v11
v_cvt_pk_bf16_f32 v26, v228, v229
v_cvt_pk_bf16_f32 v27, v230, v231
v_mfma_f32_16x16x32_bf16 v[244:247], a[20:23], v[68:71], v[244:247]
ds_write_b128 v8, v[24:27] offset:12288
v_mfma_f32_16x16x32_bf16 a[176:179], a[20:23], v[72:75], a[176:179]
s_cmp_lg_u64 vcc, 0
s_cselect_b32 s46, s47, 0
s_or_b32 s43, s43, s46
v_rcp_f32 v10, v10
v_accvgpr_read_b32 v28, a156
v_mfma_f32_16x16x32_bf16 a[208:211], a[20:23], v[76:79], a[208:211]
v_accvgpr_read_b32 v29, a157
v_accvgpr_read_b32 v30, a158
v_accvgpr_read_b32 v31, a159
v_mul_f32 v28, v28, v10
v_mfma_f32_16x16x32_bf16 v[152:155], a[24:27], v[56:59], v[152:155]
v_mul_f32 v29, v29, v10
v_mul_f32 v30, v30, v10
v_mul_f32 v31, v31, v10
v_cvt_pk_bf16_f32 v20, v28, v29
v_cvt_pk_bf16_f32 v21, v30, v31
v_mfma_f32_16x16x32_bf16 v[184:187], a[24:27], v[60:63], v[184:187]
v_accvgpr_read_b32 v28, a160
v_accvgpr_read_b32 v29, a161
v_accvgpr_read_b32 v30, a162
v_accvgpr_read_b32 v31, a163
v_mfma_f32_16x16x32_bf16 v[216:219], a[24:27], v[64:67], v[216:219]
v_mul_f32 v28, v28, v10
v_mul_f32 v29, v29, v10
v_mul_f32 v30, v30, v10
v_mul_f32 v31, v31, v10
v_cvt_pk_bf16_f32 v22, v28, v29
v_mfma_f32_16x16x32_bf16 v[248:251], a[24:27], v[68:71], v[248:251]
v_cvt_pk_bf16_f32 v23, v30, v31
v_accvgpr_read_b32 v11, a152
v_cmp_nge_f32 vcc, s44, v11
s_cmp_lg_u64 vcc, 0
s_cselect_b32 s46, s47, 0
s_or_b32 s43, s43, s46
v_mfma_f32_16x16x32_bf16 a[180:183], a[24:27], v[72:75], a[180:183]
ds_write_b128 v8, v[20:23] offset:16384
v_mfma_f32_16x16x32_bf16 a[212:215], a[24:27], v[76:79], a[212:215]
v_rcp_f32 v11, v11
v_accvgpr_read_b32 v28, a188
v_accvgpr_read_b32 v29, a189
v_mfma_f32_16x16x32_bf16 v[156:159], a[28:31], v[56:59], v[156:159]
v_accvgpr_read_b32 v30, a190
v_accvgpr_read_b32 v31, a191
v_mul_f32 v28, v28, v11
v_mul_f32 v29, v29, v11
v_mfma_f32_16x16x32_bf16 v[188:191], a[28:31], v[60:63], v[188:191]
v_mul_f32 v30, v30, v11
v_mul_f32 v31, v31, v11
v_cvt_pk_bf16_f32 v24, v28, v29
v_cvt_pk_bf16_f32 v25, v30, v31
v_mfma_f32_16x16x32_bf16 v[220:223], a[28:31], v[64:67], v[220:223]
v_accvgpr_read_b32 v28, a192
v_accvgpr_read_b32 v29, a193
v_accvgpr_read_b32 v30, a194
v_accvgpr_read_b32 v31, a195
v_mfma_f32_16x16x32_bf16 v[252:255], a[28:31], v[68:71], v[252:255]
v_mul_f32 v28, v28, v11
v_mul_f32 v29, v29, v11
v_mul_f32 v30, v30, v11
v_mul_f32 v31, v31, v11
v_mfma_f32_16x16x32_bf16 a[184:187], a[28:31], v[72:75], a[184:187]
v_cvt_pk_bf16_f32 v26, v28, v29
v_cvt_pk_bf16_f32 v27, v30, v31
v_mfma_f32_16x16x32_bf16 a[216:219], a[28:31], v[76:79], a[216:219]
buffer_store_dwordx4 v[24:27], v9, s[24:27], s36 offen offset:0
s_mov_b32 s45, s35
s_mov_b32 s35, s34
s_mov_b32 s32, s33
s_add_u32 s42, s42, 1
s_lshl_b32 s47, s47, 1
s_add_u32 s33, s33, 2097152
s_add_u32 s34, s34, 3145728
s_cmp_eq_u32 s42, 3
s_cselect_b32 s33, 0x20000000, s33
s_cselect_b32 s34, 0x20000000, s34
s_branch L_it0
L_it15L:
s_barrier
s_waitcnt lgkmcnt(0)
ds_read_b64_tr_b16 a[0:1], v2 offset:24768
ds_read_b64_tr_b16 a[2:3], v2 offset:28896
ds_read_b64_tr_b16 a[4:5], v2 offset:24776
ds_read_b64_tr_b16 a[6:7], v2 offset:28904
v_mfma_f32_16x16x32_bf16 a[132:135], a[128:131], v[56:59], a[132:135]
ds_read_b64_tr_b16 a[8:9], v3 offset:24768
ds_read_b64_tr_b16 a[10:11], v3 offset:28896
ds_read_b64_tr_b16 a[12:13], v3 offset:24776
ds_read_b64_tr_b16 a[14:15], v3 offset:28904
ds_read_b64_tr_b16 a[16:17], v4 offset:24768
ds_read_b64_tr_b16 a[18:19], v4 offset:28896
ds_read_b64_tr_b16 a[20:21], v4 offset:24776
ds_read_b64_tr_b16 a[22:23], v4 offset:28904
v_mul_f32 v96, s31, v96
v_mul_f32 v97, s31, v97
v_mul_f32 v98, s31, v98
v_mfma_f32_16x16x32_bf16 a[136:139], a[128:131], v[60:63], a[136:139]
v_mul_f32 v99, s31, v99
v_exp_f32 v96, v96
v_exp_f32 v97, v97
v_exp_f32 v98, v98
v_exp_f32 v99, v99
v_cvt_pk_bf16_f32 v74, v96, v97
v_cvt_pk_bf16_f32 v75, v98, v99
v_mul_f32 v100, s31, v100
v_mul_f32 v101, s31, v101
v_mul_f32 v102, s31, v102
v_mul_f32 v103, s31, v103
v_mfma_f32_16x16x32_bf16 a[140:143], a[128:131], v[64:67], a[140:143]
v_exp_f32 v100, v100
v_exp_f32 v101, v101
v_exp_f32 v102, v102
v_exp_f32 v103, v103
v_cvt_pk_bf16_f32 v78, v100, v101
v_cvt_pk_bf16_f32 v79, v102, v103
s_add_u32 s36, s35, 20480
v_mfma_f32_16x16x32_bf16 a[144:147], a[128:131], v[68:71], a[144:147]
ds_read_b64_tr_b16 a[24:25], v5 offset:24768
ds_read_b64_tr_b16 a[26:27], v5 offset:28896
ds_read_b64_tr_b16 a[28:29], v5 offset:24776
ds_read_b64_tr_b16 a[30:31], v5 offset:28904
v_mfma_f32_16x16x32_bf16 a[148:151], a[128:131], v[72:75], a[148:151]
v_mfma_f32_16x16x32_bf16 a[152:155], a[128:131], v[76:79], a[152:155]
s_waitcnt lgkmcnt(12)
v_mfma_f32_16x16x32_bf16 a[188:191], a[0:3], v[76:79], a[188:191]
v_mfma_f32_16x16x32_bf16 a[192:195], a[4:7], v[76:79], a[192:195]
s_waitcnt lgkmcnt(8)
v_mfma_f32_16x16x32_bf16 a[196:199], a[8:11], v[76:79], a[196:199]
v_mfma_f32_16x16x32_bf16 a[200:203], a[12:15], v[76:79], a[200:203]
s_nop 0
v_accvgpr_read_b32 v10, a148
s_waitcnt lgkmcnt(4)
v_mfma_f32_16x16x32_bf16 a[204:207], a[16:19], v[76:79], a[204:207]
v_accvgpr_read_b32 v11, a152
v_cmp_nge_f32 vcc, s44, v11
s_cmp_lg_u64 vcc, 0
s_cselect_b32 s46, s47, 0
v_rcp_f32 v11, v11
v_cmp_nge_f32 vcc, s44, v10
v_rcp_f32 v10, v10
s_or_b32 s43, s43, s46
s_cmp_lg_u64 vcc, 0
s_cselect_b32 s46, s47, 0
s_or_b32 s43, s43, s46
v_mfma_f32_16x16x32_bf16 a[208:211], a[20:23], v[76:79], a[208:211]
v_accvgpr_read_b32 v28, a188
v_accvgpr_read_b32 v29, a189
v_accvgpr_read_b32 v30, a190
v_accvgpr_read_b32 v31, a191
v_mul_f32 v28, v28, v11
v_mul_f32 v29, v29, v11
v_mul_f32 v30, v30, v11
v_mul_f32 v31, v31, v11
v_cvt_pk_bf16_f32 v20, v28, v29
v_cvt_pk_bf16_f32 v21, v30, v31
s_waitcnt lgkmcnt(0)
v_mfma_f32_16x16x32_bf16 a[212:215], a[24:27], v[76:79], a[212:215]
v_accvgpr_read_b32 v28, a192
v_accvgpr_read_b32 v29, a193
v_accvgpr_read_b32 v30, a194
v_accvgpr_read_b32 v31, a195
v_mul_f32 v28, v28, v11
v_mul_f32 v29, v29, v11
v_mul_f32 v30, v30, v11
v_mul_f32 v31, v31, v11
v_cvt_pk_bf16_f32 v22, v28, v29
v_cvt_pk_bf16_f32 v23, v30, v31
buffer_store_dwordx4 v[20:23], v9, s[24:27], s36 offen offset:0
s_add_u32 s36, s35, 20480
v_mfma_f32_16x16x32_bf16 a[216:219], a[28:31], v[76:79], a[216:219]
v_accvgpr_read_b32 v28, a196
v_accvgpr_read_b32 v29, a197
v_accvgpr_read_b32 v30, a198
v_accvgpr_read_b32 v31, a199
v_mul_f32 v28, v28, v11
v_mul_f32 v29, v29, v11
v_mul_f32 v30, v30, v11
v_mul_f32 v31, v31, v11
v_cvt_pk_bf16_f32 v24, v28, v29
v_cvt_pk_bf16_f32 v25, v30, v31
v_mfma_f32_16x16x32_bf16 a[156:159], a[0:3], v[72:75], a[156:159]
v_accvgpr_read_b32 v28, a200
v_accvgpr_read_b32 v29, a201
v_accvgpr_read_b32 v30, a202
v_accvgpr_read_b32 v31, a203
v_mul_f32 v28, v28, v11
v_mul_f32 v29, v29, v11
v_mul_f32 v30, v30, v11
v_mul_f32 v31, v31, v11
v_cvt_pk_bf16_f32 v26, v28, v29
v_cvt_pk_bf16_f32 v27, v30, v31
buffer_store_dwordx4 v[24:27], v9, s[24:27], s36 offen offset:64
s_add_u32 s36, s35, 20480
v_mfma_f32_16x16x32_bf16 a[160:163], a[4:7], v[72:75], a[160:163]
v_accvgpr_read_b32 v28, a204
v_accvgpr_read_b32 v29, a205
v_accvgpr_read_b32 v30, a206
v_accvgpr_read_b32 v31, a207
v_mul_f32 v28, v28, v11
v_mul_f32 v29, v29, v11
v_mul_f32 v30, v30, v11
v_mul_f32 v31, v31, v11
v_cvt_pk_bf16_f32 v20, v28, v29
v_cvt_pk_bf16_f32 v21, v30, v31
v_mfma_f32_16x16x32_bf16 a[164:167], a[8:11], v[72:75], a[164:167]
v_accvgpr_read_b32 v28, a208
v_accvgpr_read_b32 v29, a209
v_accvgpr_read_b32 v30, a210
v_accvgpr_read_b32 v31, a211
v_mul_f32 v28, v28, v11
v_mul_f32 v29, v29, v11
v_mul_f32 v30, v30, v11
v_mul_f32 v31, v31, v11
v_cvt_pk_bf16_f32 v22, v28, v29
v_cvt_pk_bf16_f32 v23, v30, v31
buffer_store_dwordx4 v[20:23], v9, s[24:27], s36 offen offset:128
s_add_u32 s36, s35, 20480
v_mfma_f32_16x16x32_bf16 a[168:171], a[12:15], v[72:75], a[168:171]
v_accvgpr_read_b32 v28, a212
v_accvgpr_read_b32 v29, a213
v_accvgpr_read_b32 v30, a214
v_accvgpr_read_b32 v31, a215
v_mul_f32 v28, v28, v11
v_mul_f32 v29, v29, v11
v_mul_f32 v30, v30, v11
v_mul_f32 v31, v31, v11
v_cvt_pk_bf16_f32 v24, v28, v29
v_cvt_pk_bf16_f32 v25, v30, v31
v_mfma_f32_16x16x32_bf16 a[172:175], a[16:19], v[72:75], a[172:175]
v_accvgpr_read_b32 v28, a216
v_accvgpr_read_b32 v29, a217
v_accvgpr_read_b32 v30, a218
v_accvgpr_read_b32 v31, a219
v_mul_f32 v28, v28, v11
v_mul_f32 v29, v29, v11
v_mul_f32 v30, v30, v11
v_mul_f32 v31, v31, v11
v_cvt_pk_bf16_f32 v26, v28, v29
v_cvt_pk_bf16_f32 v27, v30, v31
buffer_store_dwordx4 v[24:27], v9, s[24:27], s36 offen offset:192
s_add_u32 s36, s35, 16384
v_mfma_f32_16x16x32_bf16 a[176:179], a[20:23], v[72:75], a[176:179]
v_accvgpr_read_b32 v28, a156
v_accvgpr_read_b32 v29, a157
v_accvgpr_read_b32 v30, a158
v_accvgpr_read_b32 v31, a159
v_mul_f32 v28, v28, v10
v_mul_f32 v29, v29, v10
v_mul_f32 v30, v30, v10
v_mul_f32 v31, v31, v10
v_cvt_pk_bf16_f32 v20, v28, v29
v_cvt_pk_bf16_f32 v21, v30, v31
v_accvgpr_read_b32 v11, a136
v_mfma_f32_16x16x32_bf16 a[180:183], a[24:27], v[72:75], a[180:183]
v_accvgpr_read_b32 v28, a160
v_accvgpr_read_b32 v29, a161
v_accvgpr_read_b32 v30, a162
v_accvgpr_read_b32 v31, a163
v_mul_f32 v28, v28, v10
v_mul_f32 v29, v29, v10
v_mul_f32 v30, v30, v10
v_mul_f32 v31, v31, v10
v_cvt_pk_bf16_f32 v22, v28, v29
v_cvt_pk_bf16_f32 v23, v30, v31
ds_write_b128 v8, v[20:23] offset:16384
v_mfma_f32_16x16x32_bf16 a[184:187], a[28:31], v[72:75], a[184:187]
v_accvgpr_read_b32 v28, a164
v_accvgpr_read_b32 v29, a165
v_accvgpr_read_b32 v30, a166
v_accvgpr_read_b32 v31, a167
v_mul_f32 v28, v28, v10
v_mul_f32 v29, v29, v10
v_mul_f32 v30, v30, v10
v_mul_f32 v31, v31, v10
v_cvt_pk_bf16_f32 v24, v28, v29
v_cvt_pk_bf16_f32 v25, v30, v31
v_mfma_f32_16x16x32_bf16 v[128:131], a[0:3], v[56:59], v[128:131]
v_accvgpr_read_b32 v28, a168
v_accvgpr_read_b32 v29, a169
v_accvgpr_read_b32 v30, a170
v_accvgpr_read_b32 v31, a171
v_mul_f32 v28, v28, v10
v_mul_f32 v29, v29, v10
v_mul_f32 v30, v30, v10
v_mul_f32 v31, v31, v10
v_cvt_pk_bf16_f32 v26, v28, v29
v_cvt_pk_bf16_f32 v27, v30, v31
ds_write_b128 v8, v[24:27] offset:16448
v_mfma_f32_16x16x32_bf16 v[132:135], a[4:7], v[56:59], v[132:135]
v_accvgpr_read_b32 v28, a172
v_accvgpr_read_b32 v29, a173
v_accvgpr_read_b32 v30, a174
v_accvgpr_read_b32 v31, a175
v_mul_f32 v28, v28, v10
v_mul_f32 v29, v29, v10
v_mul_f32 v30, v30, v10
v_mul_f32 v31, v31, v10
v_cvt_pk_bf16_f32 v20, v28, v29
v_cvt_pk_bf16_f32 v21, v30, v31
v_mfma_f32_16x16x32_bf16 v[136:139], a[8:11], v[56:59], v[136:139]
v_accvgpr_read_b32 v28, a176
v_accvgpr_read_b32 v29, a177
v_accvgpr_read_b32 v30, a178
v_accvgpr_read_b32 v31, a179
v_mul_f32 v28, v28, v10
v_mul_f32 v29, v29, v10
v_mul_f32 v30, v30, v10
v_mul_f32 v31, v31, v10
v_cvt_pk_bf16_f32 v22, v28, v29
v_cvt_pk_bf16_f32 v23, v30, v31
ds_write_b128 v8, v[20:23] offset:16512
v_mfma_f32_16x16x32_bf16 v[140:143], a[12:15], v[56:59], v[140:143]
v_accvgpr_read_b32 v28, a180
v_accvgpr_read_b32 v29, a181
v_accvgpr_read_b32 v30, a182
v_accvgpr_read_b32 v31, a183
v_mul_f32 v28, v28, v10
v_mul_f32 v29, v29, v10
v_mul_f32 v30, v30, v10
v_mul_f32 v31, v31, v10
v_cvt_pk_bf16_f32 v24, v28, v29
v_cvt_pk_bf16_f32 v25, v30, v31
v_mfma_f32_16x16x32_bf16 v[144:147], a[16:19], v[56:59], v[144:147]
v_accvgpr_read_b32 v28, a184
v_accvgpr_read_b32 v29, a185
v_accvgpr_read_b32 v30, a186
v_accvgpr_read_b32 v31, a187
v_mul_f32 v28, v28, v10
v_mul_f32 v29, v29, v10
v_mul_f32 v30, v30, v10
v_mul_f32 v31, v31, v10
v_cvt_pk_bf16_f32 v26, v28, v29
v_cvt_pk_bf16_f32 v27, v30, v31
ds_write_b128 v8, v[24:27] offset:16576
ds_read_b128 v[28:31], v0 offset:16384
ds_read_b128 v[20:23], v0 offset:17408
ds_read_b128 v[24:27], v0 offset:18432
v_mfma_f32_16x16x32_bf16 v[148:151], a[20:23], v[56:59], v[148:151]
v_accvgpr_read_b32 v10, a132
v_cmp_nge_f32 vcc, s44, v10
v_rcp_f32 v10, v10
v_mfma_f32_16x16x32_bf16 v[152:155], a[24:27], v[56:59], v[152:155]
v_mul_f32 v128, v128, v10
v_mul_f32 v129, v129, v10
v_mul_f32 v130, v130, v10
v_mul_f32 v131, v131, v10
v_mul_f32 v132, v132, v10
v_mul_f32 v133, v133, v10
v_mul_f32 v134, v134, v10
v_mul_f32 v135, v135, v10
s_cmp_lg_u64 vcc, 0
s_cselect_b32 s46, s47, 0
v_cmp_nge_f32 vcc, s44, v11
v_rcp_f32 v11, v11
s_or_b32 s43, s43, s46
s_cmp_lg_u64 vcc, 0
s_cselect_b32 s46, s47, 0
s_or_b32 s43, s43, s46
v_mfma_f32_16x16x32_bf16 v[156:159], a[28:31], v[56:59], v[156:159]
v_mul_f32 v136, v136, v10
v_mul_f32 v137, v137, v10
v_mul_f32 v138, v138, v10
v_mul_f32 v139, v139, v10
v_mfma_f32_16x16x32_bf16 v[160:163], a[0:3], v[60:63], v[160:163]
v_mul_f32 v140, v140, v10
v_mul_f32 v141, v141, v10
v_mul_f32 v142, v142, v10
v_mul_f32 v143, v143, v10
v_mfma_f32_16x16x32_bf16 v[164:167], a[4:7], v[60:63], v[164:167]
v_mul_f32 v144, v144, v10
v_mul_f32 v145, v145, v10
v_mul_f32 v146, v146, v10
v_mul_f32 v147, v147, v10
v_mfma_f32_16x16x32_bf16 v[168:171], a[8:11], v[60:63], v[168:171]
v_mul_f32 v148, v148, v10
v_mul_f32 v149, v149, v10
v_mul_f32 v150, v150, v10
v_mul_f32 v151, v151, v10
v_mfma_f32_16x16x32_bf16 v[172:175], a[12:15], v[60:63], v[172:175]
v_mul_f32 v152, v152, v10
v_mul_f32 v153, v153, v10
v_mul_f32 v154, v154, v10
v_mul_f32 v155, v155, v10
v_mfma_f32_16x16x32_bf16 v[176:179], a[16:19], v[60:63], v[176:179]
s_waitcnt lgkmcnt(2)
buffer_store_dwordx4 v[28:31], v6, s[24:27], s36 offen offset:0
s_waitcnt lgkmcnt(1)
buffer_store_dwordx4 v[20:23], v6, s[24:27], s36 offen offset:1024
s_waitcnt lgkmcnt(0)
buffer_store_dwordx4 v[24:27], v6, s[24:27], s36 offen offset:2048
ds_read_b128 v[28:31], v0 offset:19456
v_cvt_pk_bf16_f32 v20, v128, v129
v_cvt_pk_bf16_f32 v21, v130, v131
v_cvt_pk_bf16_f32 v22, v132, v133
v_cvt_pk_bf16_f32 v23, v134, v135
ds_write_b128 v8, v[20:23] offset:0
v_cvt_pk_bf16_f32 v24, v136, v137
v_cvt_pk_bf16_f32 v25, v138, v139
v_cvt_pk_bf16_f32 v26, v140, v141
v_cvt_pk_bf16_f32 v27, v142, v143
ds_write_b128 v8, v[24:27] offset:64
v_cvt_pk_bf16_f32 v20, v144, v145
v_cvt_pk_bf16_f32 v21, v146, v147
v_cvt_pk_bf16_f32 v22, v148, v149
v_cvt_pk_bf16_f32 v23, v150, v151
ds_write_b128 v8, v[20:23] offset:128
v_cvt_pk_bf16_f32 v24, v152, v153
v_cvt_pk_bf16_f32 v25, v154, v155
v_mul_f32 v156, v156, v10
v_mul_f32 v157, v157, v10
v_mul_f32 v158, v158, v10
v_mul_f32 v159, v159, v10
v_cvt_pk_bf16_f32 v26, v156, v157
v_cvt_pk_bf16_f32 v27, v158, v159
ds_write_b128 v8, v[24:27] offset:192
ds_read_b128 v[24:27], v0 offset:0
v_mfma_f32_16x16x32_bf16 v[180:183], a[20:23], v[60:63], v[180:183]
ds_read_b128 v[20:23], v0 offset:2048
v_mul_f32 v160, v160, v11
v_mul_f32 v161, v161, v11
v_mul_f32 v162, v162, v11
v_mul_f32 v163, v163, v11
v_accvgpr_read_b32 v10, a140
v_cmp_nge_f32 vcc, s44, v10
s_cmp_lg_u64 vcc, 0
s_cselect_b32 s46, s47, 0
s_or_b32 s43, s43, s46
v_rcp_f32 v10, v10
v_mfma_f32_16x16x32_bf16 v[184:187], a[24:27], v[60:63], v[184:187]
v_mul_f32 v164, v164, v11
v_mul_f32 v165, v165, v11
v_mul_f32 v166, v166, v11
v_mul_f32 v167, v167, v11
v_mfma_f32_16x16x32_bf16 v[188:191], a[28:31], v[60:63], v[188:191]
v_mul_f32 v168, v168, v11
v_mul_f32 v169, v169, v11
v_mul_f32 v170, v170, v11
v_mul_f32 v171, v171, v11
v_mfma_f32_16x16x32_bf16 v[192:195], a[0:3], v[64:67], v[192:195]
v_mul_f32 v172, v172, v11
v_mul_f32 v173, v173, v11
v_mul_f32 v174, v174, v11
v_mul_f32 v175, v175, v11
v_mfma_f32_16x16x32_bf16 v[196:199], a[4:7], v[64:67], v[196:199]
v_mul_f32 v176, v176, v11
v_mul_f32 v177, v177, v11
v_mul_f32 v178, v178, v11
v_mul_f32 v179, v179, v11
v_mfma_f32_16x16x32_bf16 v[200:203], a[8:11], v[64:67], v[200:203]
v_mul_f32 v180, v180, v11
v_mul_f32 v181, v181, v11
v_mul_f32 v182, v182, v11
v_mul_f32 v183, v183, v11
v_mfma_f32_16x16x32_bf16 v[204:207], a[12:15], v[64:67], v[204:207]
v_mul_f32 v184, v184, v11
v_mul_f32 v185, v185, v11
v_mul_f32 v186, v186, v11
v_mul_f32 v187, v187, v11
v_mfma_f32_16x16x32_bf16 v[208:211], a[16:19], v[64:67], v[208:211]
s_waitcnt lgkmcnt(6)
buffer_store_dwordx4 v[28:31], v6, s[24:27], s36 offen offset:3072
s_add_u32 s36, s35, 0
s_waitcnt lgkmcnt(1)
buffer_store_dwordx4 v[24:27], v6, s[24:27], s36 offen offset:0
ds_read_b128 v[28:31], v0 offset:1024
ds_read_b128 v[24:27], v0 offset:3072
v_mul_f32 v188, v188, v11
v_mul_f32 v189, v189, v11
v_mul_f32 v190, v190, v11
v_mul_f32 v191, v191, v11
v_accvgpr_read_b32 v11, a144
v_cmp_nge_f32 vcc, s44, v11
s_cmp_lg_u64 vcc, 0
s_cselect_b32 s46, s47, 0
s_or_b32 s43, s43, s46
v_rcp_f32 v11, v11
v_mfma_f32_16x16x32_bf16 v[212:215], a[20:23], v[64:67], v[212:215]
s_waitcnt lgkmcnt(2)
buffer_store_dwordx4 v[20:23], v6, s[24:27], s36 offen offset:2048
v_mul_f32 v192, v192, v10
s_nop 0
v_cvt_pk_bf16_f32 v20, v160, v161
v_cvt_pk_bf16_f32 v21, v162, v163
v_cvt_pk_bf16_f32 v22, v164, v165
v_cvt_pk_bf16_f32 v23, v166, v167
ds_write_b128 v8, v[20:23] offset:4096
v_cvt_pk_bf16_f32 v20, v176, v177
v_cvt_pk_bf16_f32 v21, v178, v179
v_cvt_pk_bf16_f32 v22, v180, v181
v_cvt_pk_bf16_f32 v23, v182, v183
ds_write_b128 v8, v[20:23] offset:4224
v_mul_f32 v193, v193, v10
v_mfma_f32_16x16x32_bf16 v[216:219], a[24:27], v[64:67], v[216:219]
v_mul_f32 v194, v194, v10
v_mul_f32 v195, v195, v10
v_mul_f32 v196, v196, v10
v_mul_f32 v197, v197, v10
v_mul_f32 v198, v198, v10
v_mul_f32 v199, v199, v10
v_mfma_f32_16x16x32_bf16 v[220:223], a[28:31], v[64:67], v[220:223]
v_mul_f32 v200, v200, v10
v_mul_f32 v201, v201, v10
v_mul_f32 v202, v202, v10
v_mul_f32 v203, v203, v10
v_mfma_f32_16x16x32_bf16 v[224:227], a[0:3], v[68:71], v[224:227]
v_mul_f32 v204, v204, v10
v_mul_f32 v205, v205, v10
v_mul_f32 v206, v206, v10
v_mul_f32 v207, v207, v10
v_mfma_f32_16x16x32_bf16 v[228:231], a[4:7], v[68:71], v[228:231]
v_mul_f32 v208, v208, v10
v_mul_f32 v209, v209, v10
v_mul_f32 v210, v210, v10
v_mul_f32 v211, v211, v10
v_mfma_f32_16x16x32_bf16 v[232:235], a[8:11], v[68:71], v[232:235]
v_mul_f32 v212, v212, v10
v_mul_f32 v213, v213, v10
v_mul_f32 v214, v214, v10
v_mul_f32 v215, v215, v10
v_mfma_f32_16x16x32_bf16 v[236:239], a[12:15], v[68:71], v[236:239]
v_mul_f32 v216, v216, v10
v_mul_f32 v217, v217, v10
v_mul_f32 v218, v218, v10
v_mul_f32 v219, v219, v10
v_mfma_f32_16x16x32_bf16 v[240:243], a[16:19], v[68:71], v[240:243]
s_waitcnt lgkmcnt(3)
buffer_store_dwordx4 v[28:31], v6, s[24:27], s36 offen offset:1024
s_waitcnt lgkmcnt(2)
buffer_store_dwordx4 v[24:27], v6, s[24:27], s36 offen offset:3072
s_nop 1
v_cvt_pk_bf16_f32 v24, v168, v169
v_cvt_pk_bf16_f32 v25, v170, v171
v_cvt_pk_bf16_f32 v26, v172, v173
v_cvt_pk_bf16_f32 v27, v174, v175
ds_write_b128 v8, v[24:27] offset:4160
v_cvt_pk_bf16_f32 v24, v184, v185
v_cvt_pk_bf16_f32 v25, v186, v187
v_cvt_pk_bf16_f32 v26, v188, v189
v_cvt_pk_bf16_f32 v27, v190, v191
ds_write_b128 v8, v[24:27] offset:4288
ds_read_b128 v[20:23], v0 offset:4096
ds_read_b128 v[24:27], v0 offset:5120
ds_read_b128 v[28:31], v0 offset:6144
s_add_u32 s36, s35, 4096
v_mul_f32 v220, v220, v10
v_mul_f32 v221, v221, v10
v_mul_f32 v222, v222, v10
v_mul_f32 v223, v223, v10
v_mfma_f32_16x16x32_bf16 v[244:247], a[20:23], v[68:71], v[244:247]
v_mul_f32 v224, v224, v11
v_mul_f32 v225, v225, v11
v_mul_f32 v226, v226, v11
v_mul_f32 v227, v227, v11
v_mfma_f32_16x16x32_bf16 v[248:251], a[24:27], v[68:71], v[248:251]
v_mul_f32 v228, v228, v11
v_mul_f32 v229, v229, v11
v_mul_f32 v230, v230, v11
v_mul_f32 v231, v231, v11
v_mfma_f32_16x16x32_bf16 v[252:255], a[28:31], v[68:71], v[252:255]
s_waitcnt lgkmcnt(2)
buffer_store_dwordx4 v[20:23], v6, s[24:27], s36 offen offset:0
s_waitcnt lgkmcnt(1)
buffer_store_dwordx4 v[24:27], v6, s[24:27], s36 offen offset:1024
s_waitcnt lgkmcnt(0)
buffer_store_dwordx4 v[28:31], v6, s[24:27], s36 offen offset:2048
ds_read_b128 v[20:23], v0 offset:7168
s_waitcnt lgkmcnt(0)
buffer_store_dwordx4 v[20:23], v6, s[24:27], s36 offen offset:3072
s_nop 1
v_cvt_pk_bf16_f32 v20, v192, v193
v_cvt_pk_bf16_f32 v21, v194, v195
v_cvt_pk_bf16_f32 v22, v196, v197
v_cvt_pk_bf16_f32 v23, v198, v199
ds_write_b128 v8, v[20:23] offset:8192
v_cvt_pk_bf16_f32 v24, v200, v201
v_cvt_pk_bf16_f32 v25, v202, v203
v_cvt_pk_bf16_f32 v26, v204, v205
v_cvt_pk_bf16_f32 v27, v206, v207
ds_write_b128 v8, v[24:27] offset:8256
v_cvt_pk_bf16_f32 v20, v208, v209
v_cvt_pk_bf16_f32 v21, v210, v211
v_cvt_pk_bf16_f32 v22, v212, v213
v_cvt_pk_bf16_f32 v23, v214, v215
ds_write_b128 v8, v[20:23] offset:8320
v_cvt_pk_bf16_f32 v24, v216, v217
v_cvt_pk_bf16_f32 v25, v218, v219
v_cvt_pk_bf16_f32 v26, v220, v221
v_cvt_pk_bf16_f32 v27, v222, v223
ds_write_b128 v8, v[24:27] offset:8384
s_add_u32 s36, s35, 8192
ds_read_b128 v[28:31], v0 offset:8192
s_waitcnt lgkmcnt(0)
buffer_store_dwordx4 v[28:31], v6, s[24:27], s36 offen offset:0
ds_read_b128 v[20:23], v0 offset:9216
s_waitcnt lgkmcnt(0)
buffer_store_dwordx4 v[20:23], v6, s[24:27], s36 offen offset:1024
ds_read_b128 v[24:27], v0 offset:10240
s_waitcnt lgkmcnt(0)
buffer_store_dwordx4 v[24:27], v6, s[24:27], s36 offen offset:2048
ds_read_b128 v[28:31], v0 offset:11264
s_waitcnt lgkmcnt(0)
buffer_store_dwordx4 v[28:31], v6, s[24:27], s36 offen offset:3072
v_cvt_pk_bf16_f32 v20, v224, v225
v_cvt_pk_bf16_f32 v21, v226, v227
v_cvt_pk_bf16_f32 v22, v228, v229
v_cvt_pk_bf16_f32 v23, v230, v231
ds_write_b128 v8, v[20:23] offset:12288
v_mul_f32 v232, v232, v11
v_mul_f32 v233, v233, v11
v_mul_f32 v234, v234, v11
v_mul_f32 v235, v235, v11
v_cvt_pk_bf16_f32 v24, v232, v233
v_cvt_pk_bf16_f32 v25, v234, v235
v_mul_f32 v236, v236, v11
v_mul_f32 v237, v237, v11
v_mul_f32 v238, v238, v11
v_mul_f32 v239, v239, v11
v_cvt_pk_bf16_f32 v26, v236, v237
v_cvt_pk_bf16_f32 v27, v238, v239
ds_write_b128 v8, v[24:27] offset:12352
v_mul_f32 v240, v240, v11
v_mul_f32 v241, v241, v11
v_mul_f32 v242, v242, v11
v_mul_f32 v243, v243, v11
v_cvt_pk_bf16_f32 v20, v240, v241
v_cvt_pk_bf16_f32 v21, v242, v243
v_mul_f32 v244, v244, v11
v_mul_f32 v245, v245, v11
v_mul_f32 v246, v246, v11
v_mul_f32 v247, v247, v11
v_cvt_pk_bf16_f32 v22, v244, v245
v_cvt_pk_bf16_f32 v23, v246, v247
ds_write_b128 v8, v[20:23] offset:12416
v_mul_f32 v248, v248, v11
v_mul_f32 v249, v249, v11
v_mul_f32 v250, v250, v11
v_mul_f32 v251, v251, v11
v_cvt_pk_bf16_f32 v24, v248, v249
v_cvt_pk_bf16_f32 v25, v250, v251
v_mul_f32 v252, v252, v11
v_mul_f32 v253, v253, v11
v_mul_f32 v254, v254, v11
v_mul_f32 v255, v255, v11
v_cvt_pk_bf16_f32 v26, v252, v253
v_cvt_pk_bf16_f32 v27, v254, v255
ds_write_b128 v8, v[24:27] offset:12480
s_add_u32 s36, s35, 12288
ds_read_b128 v[24:27], v0 offset:12288
s_waitcnt lgkmcnt(0)
buffer_store_dwordx4 v[24:27], v6, s[24:27], s36 offen offset:0
ds_read_b128 v[28:31], v0 offset:13312
s_waitcnt lgkmcnt(0)
buffer_store_dwordx4 v[28:31], v6, s[24:27], s36 offen offset:1024
ds_read_b128 v[20:23], v0 offset:14336
s_waitcnt lgkmcnt(0)
buffer_store_dwordx4 v[20:23], v6, s[24:27], s36 offen offset:2048
ds_read_b128 v[24:27], v0 offset:15360
s_waitcnt lgkmcnt(0)
buffer_store_dwordx4 v[24:27], v6, s[24:27], s36 offen offset:3072
s_cmp_lg_u32 s43, 0
s_cbranch_scc1 L_redo
L_end:
s_endpgm
L_main_end:
s_nop 15
L_redo:
s_waitcnt vmcnt(0) lgkmcnt(0)
s_mov_b32 s55, s39
v_add_u32 v1, s55, v1
s_add_u32 s40, s55, 4294941184
v_add_u32 v2, s40, v2
v_add_u32 v3, s40, v3
v_add_u32 v4, s40, v4
v_add_u32 v5, s40, v5
s_waitcnt vmcnt(0) lgkmcnt(0)
s_nop 15
L_redo_blk:
s_and_b32 s40, s43, 1
s_cbranch_scc0 L_redo_next
s_add_u32 s41, s53, 0
buffer_load_dwordx4 a[32:35], v9, s[12:15], s41 offen offset:0
buffer_load_dwordx4 a[36:39], v9, s[12:15], s41 offen offset:64
buffer_load_dwordx4 a[40:43], v9, s[12:15], s41 offen offset:128
buffer_load_dwordx4 a[44:47], v9, s[12:15], s41 offen offset:192
v_mov_b32 v56, 0xff800000
v_mov_b32 v128, 0
v_mov_b32 v129, 0
v_mov_b32 v130, 0
v_mov_b32 v131, 0
v_mov_b32 v132, 0
v_mov_b32 v133, 0
v_mov_b32 v134, 0
v_mov_b32 v135, 0
v_mov_b32 v136, 0
v_mov_b32 v137, 0
v_mov_b32 v138, 0
v_mov_b32 v139, 0
v_mov_b32 v140, 0
v_mov_b32 v141, 0
v_mov_b32 v142, 0
v_mov_b32 v143, 0
v_mov_b32 v144, 0
v_mov_b32 v145, 0
v_mov_b32 v146, 0
v_mov_b32 v147, 0
v_mov_b32 v148, 0
v_mov_b32 v149, 0
v_mov_b32 v150, 0
v_mov_b32 v151, 0
v_mov_b32 v152, 0
v_mov_b32 v153, 0
v_mov_b32 v154, 0
v_mov_b32 v155, 0
v_mov_b32 v156, 0
v_mov_b32 v157, 0
v_mov_b32 v158, 0
v_mov_b32 v159, 0
v_accvgpr_write_b32 a132, 0
v_accvgpr_write_b32 a133, 0
v_accvgpr_write_b32 a134, 0
v_accvgpr_write_b32 a135, 0
s_add_u32 s41, s53, 4096
buffer_load_dwordx4 a[48:51], v9, s[12:15], s41 offen offset:0
buffer_load_dwordx4 a[52:55], v9, s[12:15], s41 offen offset:64
buffer_load_dwordx4 a[56:59], v9, s[12:15], s41 offen offset:128
buffer_load_dwordx4 a[60:63], v9, s[12:15], s41 offen offset:192
v_mov_b32 v57, 0xff800000
v_mov_b32 v160, 0
v_mov_b32 v161, 0
v_mov_b32 v162, 0
v_mov_b32 v163, 0
v_mov_b32 v164, 0
v_mov_b32 v165, 0
v_mov_b32 v166, 0
v_mov_b32 v167, 0
v_mov_b32 v168, 0
v_mov_b32 v169, 0
v_mov_b32 v170, 0
v_mov_b32 v171, 0
v_mov_b32 v172, 0
v_mov_b32 v173, 0
v_mov_b32 v174, 0
v_mov_b32 v175, 0
v_mov_b32 v176, 0
v_mov_b32 v177, 0
v_mov_b32 v178, 0
v_mov_b32 v179, 0
v_mov_b32 v180, 0
v_mov_b32 v181, 0
v_mov_b32 v182, 0
v_mov_b32 v183, 0
v_mov_b32 v184, 0
v_mov_b32 v185, 0
v_mov_b32 v186, 0
v_mov_b32 v187, 0
v_mov_b32 v188, 0
v_mov_b32 v189, 0
v_mov_b32 v190, 0
v_mov_b32 v191, 0
v_accvgpr_write_b32 a136, 0
v_accvgpr_write_b32 a137, 0
v_accvgpr_write_b32 a138, 0
v_accvgpr_write_b32 a139, 0
s_add_u32 s41, s53, 8192
buffer_load_dwordx4 a[64:67], v9, s[12:15], s41 offen offset:0
buffer_load_dwordx4 a[68:71], v9, s[12:15], s41 offen offset:64
buffer_load_dwordx4 a[72:75], v9, s[12:15], s41 offen offset:128
buffer_load_dwordx4 a[76:79], v9, s[12:15], s41 offen offset:192
v_mov_b32 v58, 0xff800000
v_mov_b32 v192, 0
v_mov_b32 v193, 0
v_mov_b32 v194, 0
v_mov_b32 v195, 0
v_mov_b32 v196, 0
v_mov_b32 v197, 0
v_mov_b32 v198, 0
v_mov_b32 v199, 0
v_mov_b32 v200, 0
v_mov_b32 v201, 0
v_mov_b32 v202, 0
v_mov_b32 v203, 0
v_mov_b32 v204, 0
v_mov_b32 v205, 0
v_mov_b32 v206, 0
v_mov_b32 v207, 0
v_mov_b32 v208, 0
v_mov_b32 v209, 0
v_mov_b32 v210, 0
v_mov_b32 v211, 0
v_mov_b32 v212, 0
v_mov_b32 v213, 0
v_mov_b32 v214, 0
v_mov_b32 v215, 0
v_mov_b32 v216, 0
v_mov_b32 v217, 0
v_mov_b32 v218, 0
v_mov_b32 v219, 0
v_mov_b32 v220, 0
v_mov_b32 v221, 0
v_mov_b32 v222, 0
v_mov_b32 v223, 0
v_accvgpr_write_b32 a140, 0
v_accvgpr_write_b32 a141, 0
v_accvgpr_write_b32 a142, 0
v_accvgpr_write_b32 a143, 0
s_add_u32 s41, s53, 12288
buffer_load_dwordx4 a[80:83], v9, s[12:15], s41 offen offset:0
buffer_load_dwordx4 a[84:87], v9, s[12:15], s41 offen offset:64
buffer_load_dwordx4 a[88:91], v9, s[12:15], s41 offen offset:128
buffer_load_dwordx4 a[92:95], v9, s[12:15], s41 offen offset:192
v_mov_b32 v59, 0xff800000
v_mov_b32 v224, 0
v_mov_b32 v225, 0
v_mov_b32 v226, 0
v_mov_b32 v227, 0
v_mov_b32 v228, 0
v_mov_b32 v229, 0
v_mov_b32 v230, 0
v_mov_b32 v231, 0
v_mov_b32 v232, 0
v_mov_b32 v233, 0
v_mov_b32 v234, 0
v_mov_b32 v235, 0
v_mov_b32 v236, 0
v_mov_b32 v237, 0
v_mov_b32 v238, 0
v_mov_b32 v239, 0
v_mov_b32 v240, 0
v_mov_b32 v241, 0
v_mov_b32 v242, 0
v_mov_b32 v243, 0
v_mov_b32 v244, 0
v_mov_b32 v245, 0
v_mov_b32 v246, 0
v_mov_b32 v247, 0
v_mov_b32 v248, 0
v_mov_b32 v249, 0
v_mov_b32 v250, 0
v_mov_b32 v251, 0
v_mov_b32 v252, 0
v_mov_b32 v253, 0
v_mov_b32 v254, 0
v_mov_b32 v255, 0
v_accvgpr_write_b32 a144, 0
v_accvgpr_write_b32 a145, 0
v_accvgpr_write_b32 a146, 0
v_accvgpr_write_b32 a147, 0
s_add_u32 s41, s53, 16384
buffer_load_dwordx4 a[96:99], v9, s[12:15], s41 offen offset:0
buffer_load_dwordx4 a[100:103], v9, s[12:15], s41 offen offset:64
buffer_load_dwordx4 a[104:107], v9, s[12:15], s41 offen offset:128
buffer_load_dwordx4 a[108:111], v9, s[12:15], s41 offen offset:192
v_mov_b32 v60, 0xff800000
v_accvgpr_write_b32 a156, 0
v_accvgpr_write_b32 a157, 0
v_accvgpr_write_b32 a158, 0
v_accvgpr_write_b32 a159, 0
v_accvgpr_write_b32 a160, 0
v_accvgpr_write_b32 a161, 0
v_accvgpr_write_b32 a162, 0
v_accvgpr_write_b32 a163, 0
v_accvgpr_write_b32 a164, 0
v_accvgpr_write_b32 a165, 0
v_accvgpr_write_b32 a166, 0
v_accvgpr_write_b32 a167, 0
v_accvgpr_write_b32 a168, 0
v_accvgpr_write_b32 a169, 0
v_accvgpr_write_b32 a170, 0
v_accvgpr_write_b32 a171, 0
v_accvgpr_write_b32 a172, 0
v_accvgpr_write_b32 a173, 0
v_accvgpr_write_b32 a174, 0
v_accvgpr_write_b32 a175, 0
v_accvgpr_write_b32 a176, 0
v_accvgpr_write_b32 a177, 0
v_accvgpr_write_b32 a178, 0
v_accvgpr_write_b32 a179, 0
v_accvgpr_write_b32 a180, 0
v_accvgpr_write_b32 a181, 0
v_accvgpr_write_b32 a182, 0
v_accvgpr_write_b32 a183, 0
v_accvgpr_write_b32 a184, 0
v_accvgpr_write_b32 a185, 0
v_accvgpr_write_b32 a186, 0
v_accvgpr_write_b32 a187, 0
v_accvgpr_write_b32 a148, 0
v_accvgpr_write_b32 a149, 0
v_accvgpr_write_b32 a150, 0
v_accvgpr_write_b32 a151, 0
s_add_u32 s41, s53, 20480
buffer_load_dwordx4 a[112:115], v9, s[12:15], s41 offen offset:0
buffer_load_dwordx4 a[116:119], v9, s[12:15], s41 offen offset:64
buffer_load_dwordx4 a[120:123], v9, s[12:15], s41 offen offset:128
buffer_load_dwordx4 a[124:127], v9, s[12:15], s41 offen offset:192
v_mov_b32 v61, 0xff800000
v_accvgpr_write_b32 a188, 0
v_accvgpr_write_b32 a189, 0
v_accvgpr_write_b32 a190, 0
v_accvgpr_write_b32 a191, 0
v_accvgpr_write_b32 a192, 0
v_accvgpr_write_b32 a193, 0
v_accvgpr_write_b32 a194, 0
v_accvgpr_write_b32 a195, 0
v_accvgpr_write_b32 a196, 0
v_accvgpr_write_b32 a197, 0
v_accvgpr_write_b32 a198, 0
v_accvgpr_write_b32 a199, 0
v_accvgpr_write_b32 a200, 0
v_accvgpr_write_b32 a201, 0
v_accvgpr_write_b32 a202, 0
v_accvgpr_write_b32 a203, 0
v_accvgpr_write_b32 a204, 0
v_accvgpr_write_b32 a205, 0
v_accvgpr_write_b32 a206, 0
v_accvgpr_write_b32 a207, 0
v_accvgpr_write_b32 a208, 0
v_accvgpr_write_b32 a209, 0
v_accvgpr_write_b32 a210, 0
v_accvgpr_write_b32 a211, 0
v_accvgpr_write_b32 a212, 0
v_accvgpr_write_b32 a213, 0
v_accvgpr_write_b32 a214, 0
v_accvgpr_write_b32 a215, 0
v_accvgpr_write_b32 a216, 0
v_accvgpr_write_b32 a217, 0
v_accvgpr_write_b32 a218, 0
v_accvgpr_write_b32 a219, 0
v_accvgpr_write_b32 a152, 0
v_accvgpr_write_b32 a153, 0
v_accvgpr_write_b32 a154, 0
v_accvgpr_write_b32 a155, 0
s_mov_b32 s56, s52
s_mov_b32 s54, 16
s_waitcnt vmcnt(0) lgkmcnt(0)
s_nop 15
L_redo_p1:
s_add_u32 m0, s55, 0
s_add_u32 s40, s56, 0
buffer_load_dwordx4 v6, s[16:19], s40 offen lds
s_add_u32 m0, s55, 1088
s_add_u32 s40, s56, 1024
buffer_load_dwordx4 v6, s[16:19], s40 offen lds
s_add_u32 m0, s55, 2176
s_add_u32 s40, s56, 2048
buffer_load_dwordx4 v6, s[16:19], s40 offen lds
s_add_u32 m0, s55, 3264
s_add_u32 s40, s56, 3072
buffer_load_dwordx4 v6, s[16:19], s40 offen lds
s_add_u32 m0, s55, 4352
s_add_u32 s40, s56, 4096
buffer_load_dwordx4 v6, s[16:19], s40 offen lds
s_add_u32 m0, s55, 5440
s_add_u32 s40, s56, 5120
buffer_load_dwordx4 v6, s[16:19], s40 offen lds
s_add_u32 m0, s55, 6528
s_add_u32 s40, s56, 6144
buffer_load_dwordx4 v6, s[16:19], s40 offen lds
s_add_u32 m0, s55, 7616
s_add_u32 s40, s56, 7168
buffer_load_dwordx4 v6, s[16:19], s40 offen lds
s_waitcnt vmcnt(0)
ds_read_b128 a[0:3], v1 offset:0
ds_read_b128 a[4:7], v1 offset:64
ds_read_b128 a[8:11], v1 offset:128
ds_read_b128 a[12:15], v1 offset:192
ds_read_b128 a[16:19], v1 offset:4352
ds_read_b128 a[20:23], v1 offset:4416
ds_read_b128 a[24:27], v1 offset:4480
ds_read_b128 a[28:31], v1 offset:4544
s_waitcnt lgkmcnt(7)
v_mfma_f32_16x16x32_bf16 v[32:35], a[0:3], a[32:35], 0
s_waitcnt lgkmcnt(6)
v_mfma_f32_16x16x32_bf16 v[32:35], a[4:7], a[36:39], v[32:35]
s_waitcnt lgkmcnt(5)
v_mfma_f32_16x16x32_bf16 v[32:35], a[8:11], a[40:43], v[32:35]
s_waitcnt lgkmcnt(4)
v_mfma_f32_16x16x32_bf16 v[32:35], a[12:15], a[44:47], v[32:35]
v_mfma_f32_16x16x32_bf16 v[36:39], a[0:3], a[48:51], 0
v_mfma_f32_16x16x32_bf16 v[36:39], a[4:7], a[52:55], v[36:39]
v_mfma_f32_16x16x32_bf16 v[36:39], a[8:11], a[56:59], v[36:39]
v_mfma_f32_16x16x32_bf16 v[36:39], a[12:15], a[60:63], v[36:39]
v_mfma_f32_16x16x32_bf16 v[40:43], a[0:3], a[64:67], 0
v_mfma_f32_16x16x32_bf16 v[40:43], a[4:7], a[68:71], v[40:43]
v_mfma_f32_16x16x32_bf16 v[40:43], a[8:11], a[72:75], v[40:43]
v_mfma_f32_16x16x32_bf16 v[40:43], a[12:15], a[76:79], v[40:43]
v_mfma_f32_16x16x32_bf16 v[44:47], a[0:3], a[80:83], 0
v_mfma_f32_16x16x32_bf16 v[44:47], a[4:7], a[84:87], v[44:47]
v_mfma_f32_16x16x32_bf16 v[44:47], a[8:11], a[88:91], v[44:47]
v_mfma_f32_16x16x32_bf16 v[44:47], a[12:15], a[92:95], v[44:47]
v_mfma_f32_16x16x32_bf16 v[48:51], a[0:3], a[96:99], 0
v_mfma_f32_16x16x32_bf16 v[48:51], a[4:7], a[100:103], v[48:51]
v_mfma_f32_16x16x32_bf16 v[48:51], a[8:11], a[104:107], v[48:51]
v_mfma_f32_16x16x32_bf16 v[48:51], a[12:15], a[108:111], v[48:51]
v_mfma_f32_16x16x32_bf16 v[52:55], a[0:3], a[112:115], 0
v_mfma_f32_16x16x32_bf16 v[52:55], a[4:7], a[116:119], v[52:55]
v_mfma_f32_16x16x32_bf16 v[52:55], a[8:11], a[120:123], v[52:55]
v_mfma_f32_16x16x32_bf16 v[52:55], a[12:15], a[124:127], v[52:55]
s_waitcnt lgkmcnt(3)
v_mfma_f32_16x16x32_bf16 v[80:83], a[16:19], a[32:35], 0
s_waitcnt lgkmcnt(2)
v_mfma_f32_16x16x32_bf16 v[80:83], a[20:23], a[36:39], v[80:83]
s_waitcnt lgkmcnt(1)
v_mfma_f32_16x16x32_bf16 v[80:83], a[24:27], a[40:43], v[80:83]
s_waitcnt lgkmcnt(0)
v_mfma_f32_16x16x32_bf16 v[80:83], a[28:31], a[44:47], v[80:83]
v_mfma_f32_16x16x32_bf16 v[84:87], a[16:19], a[48:51], 0
v_mfma_f32_16x16x32_bf16 v[84:87], a[20:23], a[52:55], v[84:87]
v_mfma_f32_16x16x32_bf16 v[84:87], a[24:27], a[56:59], v[84:87]
v_mfma_f32_16x16x32_bf16 v[84:87], a[28:31], a[60:63], v[84:87]
v_mfma_f32_16x16x32_bf16 v[88:91], a[16:19], a[64:67], 0
v_mfma_f32_16x16x32_bf16 v[88:91], a[20:23], a[68:71], v[88:91]
v_mfma_f32_16x16x32_bf16 v[88:91], a[24:27], a[72:75], v[88:91]
v_mfma_f32_16x16x32_bf16 v[88:91], a[28:31], a[76:79], v[88:91]
v_mfma_f32_16x16x32_bf16 v[92:95], a[16:19], a[80:83], 0
v_mfma_f32_16x16x32_bf16 v[92:95], a[20:23], a[84:87], v[92:95]
v_mfma_f32_16x16x32_bf16 v[92:95], a[24:27], a[88:91], v[92:95]
v_mfma_f32_16x16x32_bf16 v[92:95], a[28:31], a[92:95], v[92:95]
v_mfma_f32_16x16x32_bf16 v[96:99], a[16:19], a[96:99], 0
v_mfma_f32_16x16x32_bf16 v[96:99], a[20:23], a[100:103], v[96:99]
v_mfma_f32_16x16x32_bf16 v[96:99], a[24:27], a[104:107], v[96:99]
v_mfma_f32_16x16x32_bf16 v[96:99], a[28:31], a[108:111], v[96:99]
v_mfma_f32_16x16x32_bf16 v[100:103], a[16:19], a[112:115], 0
v_mfma_f32_16x16x32_bf16 v[100:103], a[20:23], a[116:119], v[100:103]
v_mfma_f32_16x16x32_bf16 v[100:103], a[24:27], a[120:123], v[100:103]
v_mfma_f32_16x16x32_bf16 v[100:103], a[28:31], a[124:127], v[100:103]
v_max3_f32 v56, v56, v32, v33
v_max3_f32 v56, v56, v34, v35
v_max3_f32 v56, v56, v80, v81
v_max3_f32 v56, v56, v82, v83
v_max3_f32 v57, v57, v36, v37
v_max3_f32 v57, v57, v38, v39
v_max3_f32 v57, v57, v84, v85
v_max3_f32 v57, v57, v86, v87
v_max3_f32 v58, v58, v40, v41
v_max3_f32 v58, v58, v42, v43
v_max3_f32 v58, v58, v88, v89
v_max3_f32 v58, v58, v90, v91
v_max3_f32 v59, v59, v44, v45
v_max3_f32 v59, v59, v46, v47
v_max3_f32 v59, v59, v92, v93
v_max3_f32 v59, v59, v94, v95
v_max3_f32 v60, v60, v48, v49
v_max3_f32 v60, v60, v50, v51
v_max3_f32 v60, v60, v96, v97
v_max3_f32 v60, v60, v98, v99
v_max3_f32 v61, v61, v52, v53
v_max3_f32 v61, v61, v54, v55
v_max3_f32 v61, v61, v100, v101
v_max3_f32 v61, v61, v102, v103
s_add_u32 s56, s56, 8192
s_sub_u32 s54, s54, 1
s_waitcnt vmcnt(0) lgkmcnt(0)
s_nop 15
s_cmp_lg_u32 s54, 0
s_cbranch_scc1 L_redo_p1
v_mov_b32 v13, v56
s_nop 1
v_permlane32_swap_b32 v56, v13
v_max_f32 v56, v56, v13
v_mov_b32 v13, v56
s_nop 1
v_permlane16_swap_b32 v56, v13
v_max_f32 v56, v56, v13
v_sub_f32 v104, 0, v56
v_sub_f32 v105, 0, v56
v_sub_f32 v106, 0, v56
v_sub_f32 v107, 0, v56
v_mov_b32 v13, v57
s_nop 1
v_permlane32_swap_b32 v57, v13
v_max_f32 v57, v57, v13
v_mov_b32 v13, v57
s_nop 1
v_permlane16_swap_b32 v57, v13
v_max_f32 v57, v57, v13
v_sub_f32 v108, 0, v57
v_sub_f32 v109, 0, v57
v_sub_f32 v110, 0, v57
v_sub_f32 v111, 0, v57
v_mov_b32 v13, v58
s_nop 1
v_permlane32_swap_b32 v58, v13
v_max_f32 v58, v58, v13
v_mov_b32 v13, v58
s_nop 1
v_permlane16_swap_b32 v58, v13
v_max_f32 v58, v58, v13
v_sub_f32 v112, 0, v58
v_sub_f32 v113, 0, v58
v_sub_f32 v114, 0, v58
v_sub_f32 v115, 0, v58
v_mov_b32 v13, v59
s_nop 1
v_permlane32_swap_b32 v59, v13
v_max_f32 v59, v59, v13
v_mov_b32 v13, v59
s_nop 1
v_permlane16_swap_b32 v59, v13
v_max_f32 v59, v59, v13
v_sub_f32 v116, 0, v59
v_sub_f32 v117, 0, v59
v_sub_f32 v118, 0, v59
v_sub_f32 v119, 0, v59
v_mov_b32 v13, v60
s_nop 1
v_permlane32_swap_b32 v60, v13
v_max_f32 v60, v60, v13
v_mov_b32 v13, v60
s_nop 1
v_permlane16_swap_b32 v60, v13
v_max_f32 v60, v60, v13
v_sub_f32 v120, 0, v60
v_sub_f32 v121, 0, v60
v_sub_f32 v122, 0, v60
v_sub_f32 v123, 0, v60
v_mov_b32 v13, v61
s_nop 1
v_permlane32_swap_b32 v61, v13
v_max_f32 v61, v61, v13
v_mov_b32 v13, v61
s_nop 1
v_permlane16_swap_b32 v61, v13
v_max_f32 v61, v61, v13
v_sub_f32 v124, 0, v61
v_sub_f32 v125, 0, v61
v_sub_f32 v126, 0, v61
v_sub_f32 v127, 0, v61
s_mov_b32 s56, s52
s_mov_b32 s54, 16
s_waitcnt vmcnt(0) lgkmcnt(0)
s_nop 15
L_redo_p2:
s_add_u32 m0, s55, 0
s_add_u32 s40, s56, 0
buffer_load_dwordx4 v6, s[16:19], s40 offen lds
s_add_u32 m0, s55, 1088
s_add_u32 s40, s56, 1024
buffer_load_dwordx4 v6, s[16:19], s40 offen lds
s_add_u32 m0, s55, 2176
s_add_u32 s40, s56, 2048
buffer_load_dwordx4 v6, s[16:19], s40 offen lds
s_add_u32 m0, s55, 3264
s_add_u32 s40, s56, 3072
buffer_load_dwordx4 v6, s[16:19], s40 offen lds
s_add_u32 m0, s55, 4352
s_add_u32 s40, s56, 4096
buffer_load_dwordx4 v6, s[16:19], s40 offen lds
s_add_u32 m0, s55, 5440
s_add_u32 s40, s56, 5120
buffer_load_dwordx4 v6, s[16:19], s40 offen lds
s_add_u32 m0, s55, 6528
s_add_u32 s40, s56, 6144
buffer_load_dwordx4 v6, s[16:19], s40 offen lds
s_add_u32 m0, s55, 7616
s_add_u32 s40, s56, 7168
buffer_load_dwordx4 v6, s[16:19], s40 offen lds
s_add_u32 m0, s55, 8704
s_add_u32 s40, s56, 0
buffer_load_dwordx4 v7, s[20:23], s40 offen lds
s_add_u32 m0, s55, 9736
s_add_u32 s40, s56, 1024
buffer_load_dwordx4 v7, s[20:23], s40 offen lds
s_add_u32 m0, s55, 10768
s_add_u32 s40, s56, 2048
buffer_load_dwordx4 v7, s[20:23], s40 offen lds
s_add_u32 m0, s55, 11800
s_add_u32 s40, s56, 3072
buffer_load_dwordx4 v7, s[20:23], s40 offen lds
s_add_u32 m0, s55, 12832
s_add_u32 s40, s56, 4096
buffer_load_dwordx4 v7, s[20:23], s40 offen lds
s_add_u32 m0, s55, 13864
s_add_u32 s40, s56, 5120
buffer_load_dwordx4 v7, s[20:23], s40 offen lds
s_add_u32 m0, s55, 14896
s_add_u32 s40, s56, 6144
buffer_load_dwordx4 v7, s[20:23], s40 offen lds
s_add_u32 m0, s55, 15928
s_add_u32 s40, s56, 7168
buffer_load_dwordx4 v7, s[20:23], s40 offen lds
s_waitcnt vmcnt(0)
ds_read_b128 a[0:3], v1 offset:0
ds_read_b128 a[4:7], v1 offset:64
ds_read_b128 a[8:11], v1 offset:128
ds_read_b128 a[12:15], v1 offset:192
ds_read_b128 a[16:19], v1 offset:4352
ds_read_b128 a[20:23], v1 offset:4416
ds_read_b128 a[24:27], v1 offset:4480
ds_read_b128 a[28:31], v1 offset:4544
s_waitcnt lgkmcnt(7)
v_mfma_f32_16x16x32_bf16 v[32:35], a[0:3], a[32:35], v[104:107]
s_waitcnt lgkmcnt(6)
v_mfma_f32_16x16x32_bf16 v[32:35], a[4:7], a[36:39], v[32:35]
s_waitcnt lgkmcnt(5)
v_mfma_f32_16x16x32_bf16 v[32:35], a[8:11], a[40:43], v[32:35]
s_waitcnt lgkmcnt(4)
v_mfma_f32_16x16x32_bf16 v[32:35], a[12:15], a[44:47], v[32:35]
v_mfma_f32_16x16x32_bf16 v[36:39], a[0:3], a[48:51], v[108:111]
v_mfma_f32_16x16x32_bf16 v[36:39], a[4:7], a[52:55], v[36:39]
v_mfma_f32_16x16x32_bf16 v[36:39], a[8:11], a[56:59], v[36:39]
v_mfma_f32_16x16x32_bf16 v[36:39], a[12:15], a[60:63], v[36:39]
v_mfma_f32_16x16x32_bf16 v[40:43], a[0:3], a[64:67], v[112:115]
v_mfma_f32_16x16x32_bf16 v[40:43], a[4:7], a[68:71], v[40:43]
v_mfma_f32_16x16x32_bf16 v[40:43], a[8:11], a[72:75], v[40:43]
v_mfma_f32_16x16x32_bf16 v[40:43], a[12:15], a[76:79], v[40:43]
v_mfma_f32_16x16x32_bf16 v[44:47], a[0:3], a[80:83], v[116:119]
v_mfma_f32_16x16x32_bf16 v[44:47], a[4:7], a[84:87], v[44:47]
v_mfma_f32_16x16x32_bf16 v[44:47], a[8:11], a[88:91], v[44:47]
v_mfma_f32_16x16x32_bf16 v[44:47], a[12:15], a[92:95], v[44:47]
v_mfma_f32_16x16x32_bf16 v[48:51], a[0:3], a[96:99], v[120:123]
v_mfma_f32_16x16x32_bf16 v[48:51], a[4:7], a[100:103], v[48:51]
v_mfma_f32_16x16x32_bf16 v[48:51], a[8:11], a[104:107], v[48:51]
v_mfma_f32_16x16x32_bf16 v[48:51], a[12:15], a[108:111], v[48:51]
v_mfma_f32_16x16x32_bf16 v[52:55], a[0:3], a[112:115], v[124:127]
v_mfma_f32_16x16x32_bf16 v[52:55], a[4:7], a[116:119], v[52:55]
v_mfma_f32_16x16x32_bf16 v[52:55], a[8:11], a[120:123], v[52:55]
v_mfma_f32_16x16x32_bf16 v[52:55], a[12:15], a[124:127], v[52:55]
s_waitcnt lgkmcnt(3)
v_mfma_f32_16x16x32_bf16 v[80:83], a[16:19], a[32:35], v[104:107]
s_waitcnt lgkmcnt(2)
v_mfma_f32_16x16x32_bf16 v[80:83], a[20:23], a[36:39], v[80:83]
s_waitcnt lgkmcnt(1)
v_mfma_f32_16x16x32_bf16 v[80:83], a[24:27], a[40:43], v[80:83]
s_waitcnt lgkmcnt(0)
v_mfma_f32_16x16x32_bf16 v[80:83], a[28:31], a[44:47], v[80:83]
v_mfma_f32_16x16x32_bf16 v[84:87], a[16:19], a[48:51], v[108:111]
v_mfma_f32_16x16x32_bf16 v[84:87], a[20:23], a[52:55], v[84:87]
v_mfma_f32_16x16x32_bf16 v[84:87], a[24:27], a[56:59], v[84:87]
v_mfma_f32_16x16x32_bf16 v[84:87], a[28:31], a[60:63], v[84:87]
v_mfma_f32_16x16x32_bf16 v[88:91], a[16:19], a[64:67], v[112:115]
v_mfma_f32_16x16x32_bf16 v[88:91], a[20:23], a[68:71], v[88:91]
v_mfma_f32_16x16x32_bf16 v[88:91], a[24:27], a[72:75], v[88:91]
v_mfma_f32_16x16x32_bf16 v[88:91], a[28:31], a[76:79], v[88:91]
v_mfma_f32_16x16x32_bf16 v[92:95], a[16:19], a[80:83], v[116:119]
v_mfma_f32_16x16x32_bf16 v[92:95], a[20:23], a[84:87], v[92:95]
v_mfma_f32_16x16x32_bf16 v[92:95], a[24:27], a[88:91], v[92:95]
v_mfma_f32_16x16x32_bf16 v[92:95], a[28:31], a[92:95], v[92:95]
v_mfma_f32_16x16x32_bf16 v[96:99], a[16:19], a[96:99], v[120:123]
v_mfma_f32_16x16x32_bf16 v[96:99], a[20:23], a[100:103], v[96:99]
v_mfma_f32_16x16x32_bf16 v[96:99], a[24:27], a[104:107], v[96:99]
v_mfma_f32_16x16x32_bf16 v[96:99], a[28:31], a[108:111], v[96:99]
v_mfma_f32_16x16x32_bf16 v[100:103], a[16:19], a[112:115], v[124:127]
v_mfma_f32_16x16x32_bf16 v[100:103], a[20:23], a[116:119], v[100:103]
v_mfma_f32_16x16x32_bf16 v[100:103], a[24:27], a[120:123], v[100:103]
v_mfma_f32_16x16x32_bf16 v[100:103], a[28:31], a[124:127], v[100:103]
v_mul_f32 v32, s31, v32
v_mul_f32 v33, s31, v33
v_mul_f32 v34, s31, v34
v_mul_f32 v35, s31, v35
v_exp_f32 v32, v32
v_exp_f32 v33, v33
v_exp_f32 v34, v34
v_exp_f32 v35, v35
v_cvt_pk_bf16_f32 v32, v32, v33
v_cvt_pk_bf16_f32 v33, v34, v35
v_mul_f32 v36, s31, v36
v_mul_f32 v37, s31, v37
v_mul_f32 v38, s31, v38
v_mul_f32 v39, s31, v39
v_exp_f32 v36, v36
v_exp_f32 v37, v37
v_exp_f32 v38, v38
v_exp_f32 v39, v39
v_cvt_pk_bf16_f32 v36, v36, v37
v_cvt_pk_bf16_f32 v37, v38, v39
v_mul_f32 v40, s31, v40
v_mul_f32 v41, s31, v41
v_mul_f32 v42, s31, v42
v_mul_f32 v43, s31, v43
v_exp_f32 v40, v40
v_exp_f32 v41, v41
v_exp_f32 v42, v42
v_exp_f32 v43, v43
v_cvt_pk_bf16_f32 v40, v40, v41
v_cvt_pk_bf16_f32 v41, v42, v43
v_mul_f32 v44, s31, v44
v_mul_f32 v45, s31, v45
v_mul_f32 v46, s31, v46
v_mul_f32 v47, s31, v47
v_exp_f32 v44, v44
v_exp_f32 v45, v45
v_exp_f32 v46, v46
v_exp_f32 v47, v47
v_cvt_pk_bf16_f32 v44, v44, v45
v_cvt_pk_bf16_f32 v45, v46, v47
v_mul_f32 v48, s31, v48
v_mul_f32 v49, s31, v49
v_mul_f32 v50, s31, v50
v_mul_f32 v51, s31, v51
v_exp_f32 v48, v48
v_exp_f32 v49, v49
v_exp_f32 v50, v50
v_exp_f32 v51, v51
v_cvt_pk_bf16_f32 v48, v48, v49
v_cvt_pk_bf16_f32 v49, v50, v51
v_mul_f32 v52, s31, v52
v_mul_f32 v53, s31, v53
v_mul_f32 v54, s31, v54
v_mul_f32 v55, s31, v55
v_exp_f32 v52, v52
v_exp_f32 v53, v53
v_exp_f32 v54, v54
v_exp_f32 v55, v55
v_cvt_pk_bf16_f32 v52, v52, v53
v_cvt_pk_bf16_f32 v53, v54, v55
v_mul_f32 v80, s31, v80
v_mul_f32 v81, s31, v81
v_mul_f32 v82, s31, v82
v_mul_f32 v83, s31, v83
v_exp_f32 v80, v80
v_exp_f32 v81, v81
v_exp_f32 v82, v82
v_exp_f32 v83, v83
v_cvt_pk_bf16_f32 v34, v80, v81
v_cvt_pk_bf16_f32 v35, v82, v83
v_mul_f32 v84, s31, v84
v_mul_f32 v85, s31, v85
v_mul_f32 v86, s31, v86
v_mul_f32 v87, s31, v87
v_exp_f32 v84, v84
v_exp_f32 v85, v85
v_exp_f32 v86, v86
v_exp_f32 v87, v87
v_cvt_pk_bf16_f32 v38, v84, v85
v_cvt_pk_bf16_f32 v39, v86, v87
v_mul_f32 v88, s31, v88
v_mul_f32 v89, s31, v89
v_mul_f32 v90, s31, v90
v_mul_f32 v91, s31, v91
v_exp_f32 v88, v88
v_exp_f32 v89, v89
v_exp_f32 v90, v90
v_exp_f32 v91, v91
v_cvt_pk_bf16_f32 v42, v88, v89
v_cvt_pk_bf16_f32 v43, v90, v91
v_mul_f32 v92, s31, v92
v_mul_f32 v93, s31, v93
v_mul_f32 v94, s31, v94
v_mul_f32 v95, s31, v95
v_exp_f32 v92, v92
v_exp_f32 v93, v93
v_exp_f32 v94, v94
v_exp_f32 v95, v95
v_cvt_pk_bf16_f32 v46, v92, v93
v_cvt_pk_bf16_f32 v47, v94, v95
v_mul_f32 v96, s31, v96
v_mul_f32 v97, s31, v97
v_mul_f32 v98, s31, v98
v_mul_f32 v99, s31, v99
v_exp_f32 v96, v96
v_exp_f32 v97, v97
v_exp_f32 v98, v98
v_exp_f32 v99, v99
v_cvt_pk_bf16_f32 v50, v96, v97
v_cvt_pk_bf16_f32 v51, v98, v99
v_mul_f32 v100, s31, v100
v_mul_f32 v101, s31, v101
v_mul_f32 v102, s31, v102
v_mul_f32 v103, s31, v103
v_exp_f32 v100, v100
v_exp_f32 v101, v101
v_exp_f32 v102, v102
v_exp_f32 v103, v103
v_cvt_pk_bf16_f32 v54, v100, v101
v_cvt_pk_bf16_f32 v55, v102, v103
ds_read_b64_tr_b16 a[0:1], v2 offset:0
ds_read_b64_tr_b16 a[2:3], v2 offset:4128
ds_read_b64_tr_b16 a[4:5], v2 offset:8
ds_read_b64_tr_b16 a[6:7], v2 offset:4136
ds_read_b64_tr_b16 a[8:9], v3 offset:0
ds_read_b64_tr_b16 a[10:11], v3 offset:4128
ds_read_b64_tr_b16 a[12:13], v3 offset:8
ds_read_b64_tr_b16 a[14:15], v3 offset:4136
ds_read_b64_tr_b16 a[16:17], v4 offset:0
ds_read_b64_tr_b16 a[18:19], v4 offset:4128
ds_read_b64_tr_b16 a[20:21], v4 offset:8
ds_read_b64_tr_b16 a[22:23], v4 offset:4136
ds_read_b64_tr_b16 a[24:25], v5 offset:0
ds_read_b64_tr_b16 a[26:27], v5 offset:4128
ds_read_b64_tr_b16 a[28:29], v5 offset:8
ds_read_b64_tr_b16 a[30:31], v5 offset:4136
v_mfma_f32_16x16x32_bf16 a[132:135], a[128:131], v[32:35], a[132:135]
v_mfma_f32_16x16x32_bf16 a[136:139], a[128:131], v[36:39], a[136:139]
v_mfma_f32_16x16x32_bf16 a[140:143], a[128:131], v[40:43], a[140:143]
v_mfma_f32_16x16x32_bf16 a[144:147], a[128:131], v[44:47], a[144:147]
v_mfma_f32_16x16x32_bf16 a[148:151], a[128:131], v[48:51], a[148:151]
v_mfma_f32_16x16x32_bf16 a[152:155], a[128:131], v[52:55], a[152:155]
s_waitcnt lgkmcnt(14)
v_mfma_f32_16x16x32_bf16 v[128:131], a[0:3], v[32:35], v[128:131]
v_mfma_f32_16x16x32_bf16 v[160:163], a[0:3], v[36:39], v[160:163]
v_mfma_f32_16x16x32_bf16 v[192:195], a[0:3], v[40:43], v[192:195]
v_mfma_f32_16x16x32_bf16 v[224:227], a[0:3], v[44:47], v[224:227]
v_mfma_f32_16x16x32_bf16 a[156:159], a[0:3], v[48:51], a[156:159]
v_mfma_f32_16x16x32_bf16 a[188:191], a[0:3], v[52:55], a[188:191]
s_waitcnt lgkmcnt(12)
v_mfma_f32_16x16x32_bf16 v[132:135], a[4:7], v[32:35], v[132:135]
v_mfma_f32_16x16x32_bf16 v[164:167], a[4:7], v[36:39], v[164:167]
v_mfma_f32_16x16x32_bf16 v[196:199], a[4:7], v[40:43], v[196:199]
v_mfma_f32_16x16x32_bf16 v[228:231], a[4:7], v[44:47], v[228:231]
v_mfma_f32_16x16x32_bf16 a[160:163], a[4:7], v[48:51], a[160:163]
v_mfma_f32_16x16x32_bf16 a[192:195], a[4:7], v[52:55], a[192:195]
s_waitcnt lgkmcnt(10)
v_mfma_f32_16x16x32_bf16 v[136:139], a[8:11], v[32:35], v[136:139]
v_mfma_f32_16x16x32_bf16 v[168:171], a[8:11], v[36:39], v[168:171]
v_mfma_f32_16x16x32_bf16 v[200:203], a[8:11], v[40:43], v[200:203]
v_mfma_f32_16x16x32_bf16 v[232:235], a[8:11], v[44:47], v[232:235]
v_mfma_f32_16x16x32_bf16 a[164:167], a[8:11], v[48:51], a[164:167]
v_mfma_f32_16x16x32_bf16 a[196:199], a[8:11], v[52:55], a[196:199]
s_waitcnt lgkmcnt(8)
v_mfma_f32_16x16x32_bf16 v[140:143], a[12:15], v[32:35], v[140:143]
v_mfma_f32_16x16x32_bf16 v[172:175], a[12:15], v[36:39], v[172:175]
v_mfma_f32_16x16x32_bf16 v[204:207], a[12:15], v[40:43], v[204:207]
v_mfma_f32_16x16x32_bf16 v[236:239], a[12:15], v[44:47], v[236:239]
v_mfma_f32_16x16x32_bf16 a[168:171], a[12:15], v[48:51], a[168:171]
v_mfma_f32_16x16x32_bf16 a[200:203], a[12:15], v[52:55], a[200:203]
s_waitcnt lgkmcnt(6)
v_mfma_f32_16x16x32_bf16 v[144:147], a[16:19], v[32:35], v[144:147]
v_mfma_f32_16x16x32_bf16 v[176:179], a[16:19], v[36:39], v[176:179]
v_mfma_f32_16x16x32_bf16 v[208:211], a[16:19], v[40:43], v[208:211]
v_mfma_f32_16x16x32_bf16 v[240:243], a[16:19], v[44:47], v[240:243]
v_mfma_f32_16x16x32_bf16 a[172:175], a[16:19], v[48:51], a[172:175]
v_mfma_f32_16x16x32_bf16 a[204:207], a[16:19], v[52:55], a[204:207]
s_waitcnt lgkmcnt(4)
v_mfma_f32_16x16x32_bf16 v[148:151], a[20:23], v[32:35], v[148:151]
v_mfma_f32_16x16x32_bf16 v[180:183], a[20:23], v[36:39], v[180:183]
v_mfma_f32_16x16x32_bf16 v[212:215], a[20:23], v[40:43], v[212:215]
v_mfma_f32_16x16x32_bf16 v[244:247], a[20:23], v[44:47], v[244:247]
v_mfma_f32_16x16x32_bf16 a[176:179], a[20:23], v[48:51], a[176:179]
v_mfma_f32_16x16x32_bf16 a[208:211], a[20:23], v[52:55], a[208:211]
s_waitcnt lgkmcnt(2)
v_mfma_f32_16x16x32_bf16 v[152:155], a[24:27], v[32:35], v[152:155]
v_mfma_f32_16x16x32_bf16 v[184:187], a[24:27], v[36:39], v[184:187]
v_mfma_f32_16x16x32_bf16 v[216:219], a[24:27], v[40:43], v[216:219]
v_mfma_f32_16x16x32_bf16 v[248:251], a[24:27], v[44:47], v[248:251]
v_mfma_f32_16x16x32_bf16 a[180:183], a[24:27], v[48:51], a[180:183]
v_mfma_f32_16x16x32_bf16 a[212:215], a[24:27], v[52:55], a[212:215]
s_waitcnt lgkmcnt(0)
v_mfma_f32_16x16x32_bf16 v[156:159], a[28:31], v[32:35], v[156:159]
v_mfma_f32_16x16x32_bf16 v[188:191], a[28:31], v[36:39], v[188:191]
v_mfma_f32_16x16x32_bf16 v[220:223], a[28:31], v[40:43], v[220:223]
v_mfma_f32_16x16x32_bf16 v[252:255], a[28:31], v[44:47], v[252:255]
v_mfma_f32_16x16x32_bf16 a[184:187], a[28:31], v[48:51], a[184:187]
v_mfma_f32_16x16x32_bf16 a[216:219], a[28:31], v[52:55], a[216:219]
s_add_u32 s56, s56, 8192
s_sub_u32 s54, s54, 1
s_waitcnt vmcnt(0) lgkmcnt(0)
s_nop 15
s_cmp_lg_u32 s54, 0
s_cbranch_scc1 L_redo_p2
v_accvgpr_read_b32 v10, a132
v_rcp_f32 v10, v10
s_nop 0
v_mul_f32 v128, v128, v10
v_mul_f32 v129, v129, v10
v_mul_f32 v130, v130, v10
v_mul_f32 v131, v131, v10
v_cvt_pk_bf16_f32 v20, v128, v129
v_cvt_pk_bf16_f32 v21, v130, v131
v_mul_f32 v132, v132, v10
v_mul_f32 v133, v133, v10
v_mul_f32 v134, v134, v10
v_mul_f32 v135, v135, v10
v_cvt_pk_bf16_f32 v22, v132, v133
v_cvt_pk_bf16_f32 v23, v134, v135
s_add_u32 s36, s53, 0
buffer_store_dwordx4 v[20:23], v9, s[24:27], s36 offen offset:0
v_mul_f32 v136, v136, v10
v_mul_f32 v137, v137, v10
v_mul_f32 v138, v138, v10
v_mul_f32 v139, v139, v10
v_cvt_pk_bf16_f32 v24, v136, v137
v_cvt_pk_bf16_f32 v25, v138, v139
v_mul_f32 v140, v140, v10
v_mul_f32 v141, v141, v10
v_mul_f32 v142, v142, v10
v_mul_f32 v143, v143, v10
v_cvt_pk_bf16_f32 v26, v140, v141
v_cvt_pk_bf16_f32 v27, v142, v143
s_add_u32 s36, s53, 0
buffer_store_dwordx4 v[24:27], v9, s[24:27], s36 offen offset:64
v_mul_f32 v144, v144, v10
v_mul_f32 v145, v145, v10
v_mul_f32 v146, v146, v10
v_mul_f32 v147, v147, v10
v_cvt_pk_bf16_f32 v20, v144, v145
v_cvt_pk_bf16_f32 v21, v146, v147
v_mul_f32 v148, v148, v10
v_mul_f32 v149, v149, v10
v_mul_f32 v150, v150, v10
v_mul_f32 v151, v151, v10
v_cvt_pk_bf16_f32 v22, v148, v149
v_cvt_pk_bf16_f32 v23, v150, v151
s_add_u32 s36, s53, 0
buffer_store_dwordx4 v[20:23], v9, s[24:27], s36 offen offset:128
v_mul_f32 v152, v152, v10
v_mul_f32 v153, v153, v10
v_mul_f32 v154, v154, v10
v_mul_f32 v155, v155, v10
v_cvt_pk_bf16_f32 v24, v152, v153
v_cvt_pk_bf16_f32 v25, v154, v155
v_mul_f32 v156, v156, v10
v_mul_f32 v157, v157, v10
v_mul_f32 v158, v158, v10
v_mul_f32 v159, v159, v10
v_cvt_pk_bf16_f32 v26, v156, v157
v_cvt_pk_bf16_f32 v27, v158, v159
s_add_u32 s36, s53, 0
buffer_store_dwordx4 v[24:27], v9, s[24:27], s36 offen offset:192
v_accvgpr_read_b32 v11, a136
v_rcp_f32 v11, v11
s_nop 0
v_mul_f32 v160, v160, v11
v_mul_f32 v161, v161, v11
v_mul_f32 v162, v162, v11
v_mul_f32 v163, v163, v11
v_cvt_pk_bf16_f32 v20, v160, v161
v_cvt_pk_bf16_f32 v21, v162, v163
v_mul_f32 v164, v164, v11
v_mul_f32 v165, v165, v11
v_mul_f32 v166, v166, v11
v_mul_f32 v167, v167, v11
v_cvt_pk_bf16_f32 v22, v164, v165
v_cvt_pk_bf16_f32 v23, v166, v167
s_add_u32 s36, s53, 4096
buffer_store_dwordx4 v[20:23], v9, s[24:27], s36 offen offset:0
v_mul_f32 v168, v168, v11
v_mul_f32 v169, v169, v11
v_mul_f32 v170, v170, v11
v_mul_f32 v171, v171, v11
v_cvt_pk_bf16_f32 v24, v168, v169
v_cvt_pk_bf16_f32 v25, v170, v171
v_mul_f32 v172, v172, v11
v_mul_f32 v173, v173, v11
v_mul_f32 v174, v174, v11
v_mul_f32 v175, v175, v11
v_cvt_pk_bf16_f32 v26, v172, v173
v_cvt_pk_bf16_f32 v27, v174, v175
s_add_u32 s36, s53, 4096
buffer_store_dwordx4 v[24:27], v9, s[24:27], s36 offen offset:64
v_mul_f32 v176, v176, v11
v_mul_f32 v177, v177, v11
v_mul_f32 v178, v178, v11
v_mul_f32 v179, v179, v11
v_cvt_pk_bf16_f32 v20, v176, v177
v_cvt_pk_bf16_f32 v21, v178, v179
v_mul_f32 v180, v180, v11
v_mul_f32 v181, v181, v11
v_mul_f32 v182, v182, v11
v_mul_f32 v183, v183, v11
v_cvt_pk_bf16_f32 v22, v180, v181
v_cvt_pk_bf16_f32 v23, v182, v183
s_add_u32 s36, s53, 4096
buffer_store_dwordx4 v[20:23], v9, s[24:27], s36 offen offset:128
v_mul_f32 v184, v184, v11
v_mul_f32 v185, v185, v11
v_mul_f32 v186, v186, v11
v_mul_f32 v187, v187, v11
v_cvt_pk_bf16_f32 v24, v184, v185
v_cvt_pk_bf16_f32 v25, v186, v187
v_mul_f32 v188, v188, v11
v_mul_f32 v189, v189, v11
v_mul_f32 v190, v190, v11
v_mul_f32 v191, v191, v11
v_cvt_pk_bf16_f32 v26, v188, v189
v_cvt_pk_bf16_f32 v27, v190, v191
s_add_u32 s36, s53, 4096
buffer_store_dwordx4 v[24:27], v9, s[24:27], s36 offen offset:192
v_accvgpr_read_b32 v10, a140
v_rcp_f32 v10, v10
s_nop 0
v_mul_f32 v192, v192, v10
v_mul_f32 v193, v193, v10
v_mul_f32 v194, v194, v10
v_mul_f32 v195, v195, v10
v_cvt_pk_bf16_f32 v20, v192, v193
v_cvt_pk_bf16_f32 v21, v194, v195
v_mul_f32 v196, v196, v10
v_mul_f32 v197, v197, v10
v_mul_f32 v198, v198, v10
v_mul_f32 v199, v199, v10
v_cvt_pk_bf16_f32 v22, v196, v197
v_cvt_pk_bf16_f32 v23, v198, v199
s_add_u32 s36, s53, 8192
buffer_store_dwordx4 v[20:23], v9, s[24:27], s36 offen offset:0
v_mul_f32 v200, v200, v10
v_mul_f32 v201, v201, v10
v_mul_f32 v202, v202, v10
v_mul_f32 v203, v203, v10
v_cvt_pk_bf16_f32 v24, v200, v201
v_cvt_pk_bf16_f32 v25, v202, v203
v_mul_f32 v204, v204, v10
v_mul_f32 v205, v205, v10
v_mul_f32 v206, v206, v10
v_mul_f32 v207, v207, v10
v_cvt_pk_bf16_f32 v26, v204, v205
v_cvt_pk_bf16_f32 v27, v206, v207
s_add_u32 s36, s53, 8192
buffer_store_dwordx4 v[24:27], v9, s[24:27], s36 offen offset:64
v_mul_f32 v208, v208, v10
v_mul_f32 v209, v209, v10
v_mul_f32 v210, v210, v10
v_mul_f32 v211, v211, v10
v_cvt_pk_bf16_f32 v20, v208, v209
v_cvt_pk_bf16_f32 v21, v210, v211
v_mul_f32 v212, v212, v10
v_mul_f32 v213, v213, v10
v_mul_f32 v214, v214, v10
v_mul_f32 v215, v215, v10
v_cvt_pk_bf16_f32 v22, v212, v213
v_cvt_pk_bf16_f32 v23, v214, v215
s_add_u32 s36, s53, 8192
buffer_store_dwordx4 v[20:23], v9, s[24:27], s36 offen offset:128
v_mul_f32 v216, v216, v10
v_mul_f32 v217, v217, v10
v_mul_f32 v218, v218, v10
v_mul_f32 v219, v219, v10
v_cvt_pk_bf16_f32 v24, v216, v217
v_cvt_pk_bf16_f32 v25, v218, v219
v_mul_f32 v220, v220, v10
v_mul_f32 v221, v221, v10
v_mul_f32 v222, v222, v10
v_mul_f32 v223, v223, v10
v_cvt_pk_bf16_f32 v26, v220, v221
v_cvt_pk_bf16_f32 v27, v222, v223
s_add_u32 s36, s53, 8192
buffer_store_dwordx4 v[24:27], v9, s[24:27], s36 offen offset:192
v_accvgpr_read_b32 v11, a144
v_rcp_f32 v11, v11
s_nop 0
v_mul_f32 v224, v224, v11
v_mul_f32 v225, v225, v11
v_mul_f32 v226, v226, v11
v_mul_f32 v227, v227, v11
v_cvt_pk_bf16_f32 v20, v224, v225
v_cvt_pk_bf16_f32 v21, v226, v227
v_mul_f32 v228, v228, v11
v_mul_f32 v229, v229, v11
v_mul_f32 v230, v230, v11
v_mul_f32 v231, v231, v11
v_cvt_pk_bf16_f32 v22, v228, v229
v_cvt_pk_bf16_f32 v23, v230, v231
s_add_u32 s36, s53, 12288
buffer_store_dwordx4 v[20:23], v9, s[24:27], s36 offen offset:0
v_mul_f32 v232, v232, v11
v_mul_f32 v233, v233, v11
v_mul_f32 v234, v234, v11
v_mul_f32 v235, v235, v11
v_cvt_pk_bf16_f32 v24, v232, v233
v_cvt_pk_bf16_f32 v25, v234, v235
v_mul_f32 v236, v236, v11
v_mul_f32 v237, v237, v11
v_mul_f32 v238, v238, v11
v_mul_f32 v239, v239, v11
v_cvt_pk_bf16_f32 v26, v236, v237
v_cvt_pk_bf16_f32 v27, v238, v239
s_add_u32 s36, s53, 12288
buffer_store_dwordx4 v[24:27], v9, s[24:27], s36 offen offset:64
v_mul_f32 v240, v240, v11
v_mul_f32 v241, v241, v11
v_mul_f32 v242, v242, v11
v_mul_f32 v243, v243, v11
v_cvt_pk_bf16_f32 v20, v240, v241
v_cvt_pk_bf16_f32 v21, v242, v243
v_mul_f32 v244, v244, v11
v_mul_f32 v245, v245, v11
v_mul_f32 v246, v246, v11
v_mul_f32 v247, v247, v11
v_cvt_pk_bf16_f32 v22, v244, v245
v_cvt_pk_bf16_f32 v23, v246, v247
s_add_u32 s36, s53, 12288
buffer_store_dwordx4 v[20:23], v9, s[24:27], s36 offen offset:128
v_mul_f32 v248, v248, v11
v_mul_f32 v249, v249, v11
v_mul_f32 v250, v250, v11
v_mul_f32 v251, v251, v11
v_cvt_pk_bf16_f32 v24, v248, v249
v_cvt_pk_bf16_f32 v25, v250, v251
v_mul_f32 v252, v252, v11
v_mul_f32 v253, v253, v11
v_mul_f32 v254, v254, v11
v_mul_f32 v255, v255, v11
v_cvt_pk_bf16_f32 v26, v252, v253
v_cvt_pk_bf16_f32 v27, v254, v255
s_add_u32 s36, s53, 12288
buffer_store_dwordx4 v[24:27], v9, s[24:27], s36 offen offset:192
v_accvgpr_read_b32 v10, a148
v_rcp_f32 v10, v10
v_accvgpr_read_b32 v28, a156
v_accvgpr_read_b32 v29, a157
v_accvgpr_read_b32 v30, a158
v_accvgpr_read_b32 v31, a159
v_mul_f32 v28, v28, v10
v_mul_f32 v29, v29, v10
v_mul_f32 v30, v30, v10
v_mul_f32 v31, v31, v10
v_cvt_pk_bf16_f32 v20, v28, v29
v_cvt_pk_bf16_f32 v21, v30, v31
v_accvgpr_read_b32 v28, a160
v_accvgpr_read_b32 v29, a161
v_accvgpr_read_b32 v30, a162
v_accvgpr_read_b32 v31, a163
v_mul_f32 v28, v28, v10
v_mul_f32 v29, v29, v10
v_mul_f32 v30, v30, v10
v_mul_f32 v31, v31, v10
v_cvt_pk_bf16_f32 v22, v28, v29
v_cvt_pk_bf16_f32 v23, v30, v31
s_add_u32 s36, s53, 16384
buffer_store_dwordx4 v[20:23], v9, s[24:27], s36 offen offset:0
v_accvgpr_read_b32 v28, a164
v_accvgpr_read_b32 v29, a165
v_accvgpr_read_b32 v30, a166
v_accvgpr_read_b32 v31, a167
v_mul_f32 v28, v28, v10
v_mul_f32 v29, v29, v10
v_mul_f32 v30, v30, v10
v_mul_f32 v31, v31, v10
v_cvt_pk_bf16_f32 v24, v28, v29
v_cvt_pk_bf16_f32 v25, v30, v31
v_accvgpr_read_b32 v28, a168
v_accvgpr_read_b32 v29, a169
v_accvgpr_read_b32 v30, a170
v_accvgpr_read_b32 v31, a171
v_mul_f32 v28, v28, v10
v_mul_f32 v29, v29, v10
v_mul_f32 v30, v30, v10
v_mul_f32 v31, v31, v10
v_cvt_pk_bf16_f32 v26, v28, v29
v_cvt_pk_bf16_f32 v27, v30, v31
s_add_u32 s36, s53, 16384
buffer_store_dwordx4 v[24:27], v9, s[24:27], s36 offen offset:64
v_accvgpr_read_b32 v28, a172
v_accvgpr_read_b32 v29, a173
v_accvgpr_read_b32 v30, a174
v_accvgpr_read_b32 v31, a175
v_mul_f32 v28, v28, v10
v_mul_f32 v29, v29, v10
v_mul_f32 v30, v30, v10
v_mul_f32 v31, v31, v10
v_cvt_pk_bf16_f32 v20, v28, v29
v_cvt_pk_bf16_f32 v21, v30, v31
v_accvgpr_read_b32 v28, a176
v_accvgpr_read_b32 v29, a177
v_accvgpr_read_b32 v30, a178
v_accvgpr_read_b32 v31, a179
v_mul_f32 v28, v28, v10
v_mul_f32 v29, v29, v10
v_mul_f32 v30, v30, v10
v_mul_f32 v31, v31, v10
v_cvt_pk_bf16_f32 v22, v28, v29
v_cvt_pk_bf16_f32 v23, v30, v31
s_add_u32 s36, s53, 16384
buffer_store_dwordx4 v[20:23], v9, s[24:27], s36 offen offset:128
v_accvgpr_read_b32 v28, a180
v_accvgpr_read_b32 v29, a181
v_accvgpr_read_b32 v30, a182
v_accvgpr_read_b32 v31, a183
v_mul_f32 v28, v28, v10
v_mul_f32 v29, v29, v10
v_mul_f32 v30, v30, v10
v_mul_f32 v31, v31, v10
v_cvt_pk_bf16_f32 v24, v28, v29
v_cvt_pk_bf16_f32 v25, v30, v31
v_accvgpr_read_b32 v28, a184
v_accvgpr_read_b32 v29, a185
v_accvgpr_read_b32 v30, a186
v_accvgpr_read_b32 v31, a187
v_mul_f32 v28, v28, v10
v_mul_f32 v29, v29, v10
v_mul_f32 v30, v30, v10
v_mul_f32 v31, v31, v10
v_cvt_pk_bf16_f32 v26, v28, v29
v_cvt_pk_bf16_f32 v27, v30, v31
s_add_u32 s36, s53, 16384
buffer_store_dwordx4 v[24:27], v9, s[24:27], s36 offen offset:192
v_accvgpr_read_b32 v11, a152
v_rcp_f32 v11, v11
v_accvgpr_read_b32 v28, a188
v_accvgpr_read_b32 v29, a189
v_accvgpr_read_b32 v30, a190
v_accvgpr_read_b32 v31, a191
v_mul_f32 v28, v28, v11
v_mul_f32 v29, v29, v11
v_mul_f32 v30, v30, v11
v_mul_f32 v31, v31, v11
v_cvt_pk_bf16_f32 v20, v28, v29
v_cvt_pk_bf16_f32 v21, v30, v31
v_accvgpr_read_b32 v28, a192
v_accvgpr_read_b32 v29, a193
v_accvgpr_read_b32 v30, a194
v_accvgpr_read_b32 v31, a195
v_mul_f32 v28, v28, v11
v_mul_f32 v29, v29, v11
v_mul_f32 v30, v30, v11
v_mul_f32 v31, v31, v11
v_cvt_pk_bf16_f32 v22, v28, v29
v_cvt_pk_bf16_f32 v23, v30, v31
s_add_u32 s36, s53, 20480
buffer_store_dwordx4 v[20:23], v9, s[24:27], s36 offen offset:0
v_accvgpr_read_b32 v28, a196
v_accvgpr_read_b32 v29, a197
v_accvgpr_read_b32 v30, a198
v_accvgpr_read_b32 v31, a199
v_mul_f32 v28, v28, v11
v_mul_f32 v29, v29, v11
v_mul_f32 v30, v30, v11
v_mul_f32 v31, v31, v11
v_cvt_pk_bf16_f32 v24, v28, v29
v_cvt_pk_bf16_f32 v25, v30, v31
v_accvgpr_read_b32 v28, a200
v_accvgpr_read_b32 v29, a201
v_accvgpr_read_b32 v30, a202
v_accvgpr_read_b32 v31, a203
v_mul_f32 v28, v28, v11
v_mul_f32 v29, v29, v11
v_mul_f32 v30, v30, v11
v_mul_f32 v31, v31, v11
v_cvt_pk_bf16_f32 v26, v28, v29
v_cvt_pk_bf16_f32 v27, v30, v31
s_add_u32 s36, s53, 20480
buffer_store_dwordx4 v[24:27], v9, s[24:27], s36 offen offset:64
v_accvgpr_read_b32 v28, a204
v_accvgpr_read_b32 v29, a205
v_accvgpr_read_b32 v30, a206
v_accvgpr_read_b32 v31, a207
v_mul_f32 v28, v28, v11
v_mul_f32 v29, v29, v11
v_mul_f32 v30, v30, v11
v_mul_f32 v31, v31, v11
v_cvt_pk_bf16_f32 v20, v28, v29
v_cvt_pk_bf16_f32 v21, v30, v31
v_accvgpr_read_b32 v28, a208
v_accvgpr_read_b32 v29, a209
v_accvgpr_read_b32 v30, a210
v_accvgpr_read_b32 v31, a211
v_mul_f32 v28, v28, v11
v_mul_f32 v29, v29, v11
v_mul_f32 v30, v30, v11
v_mul_f32 v31, v31, v11
v_cvt_pk_bf16_f32 v22, v28, v29
v_cvt_pk_bf16_f32 v23, v30, v31
s_add_u32 s36, s53, 20480
buffer_store_dwordx4 v[20:23], v9, s[24:27], s36 offen offset:128
v_accvgpr_read_b32 v28, a212
v_accvgpr_read_b32 v29, a213
v_accvgpr_read_b32 v30, a214
v_accvgpr_read_b32 v31, a215
v_mul_f32 v28, v28, v11
v_mul_f32 v29, v29, v11
v_mul_f32 v30, v30, v11
v_mul_f32 v31, v31, v11
v_cvt_pk_bf16_f32 v24, v28, v29
v_cvt_pk_bf16_f32 v25, v30, v31
v_accvgpr_read_b32 v28, a216
v_accvgpr_read_b32 v29, a217
v_accvgpr_read_b32 v30, a218
v_accvgpr_read_b32 v31, a219
v_mul_f32 v28, v28, v11
v_mul_f32 v29, v29, v11
v_mul_f32 v30, v30, v11
v_mul_f32 v31, v31, v11
v_cvt_pk_bf16_f32 v26, v28, v29
v_cvt_pk_bf16_f32 v27, v30, v31
s_add_u32 s36, s53, 20480
buffer_store_dwordx4 v[24:27], v9, s[24:27], s36 offen offset:192
s_waitcnt vmcnt(0) lgkmcnt(0)
s_nop 15
L_redo_next:
s_add_u32 s52, s52, 2097152
s_add_u32 s53, s53, 3145728
s_lshr_b32 s43, s43, 1
s_cmp_lg_u32 s43, 0
s_cbranch_scc1 L_redo_blk
s_endpgm
.section .rodata,"a"
.p2align 6
.amdhsa_kernel standalone__mha_softmax__near_ridge_kernel
  .amdhsa_next_free_vgpr 512
  .amdhsa_next_free_sgpr 102
  .amdhsa_accum_offset 256
  .amdhsa_group_segment_fixed_size 0
  .amdhsa_kernarg_size 48
  .amdhsa_user_sgpr_count 2
  .amdhsa_user_sgpr_kernarg_segment_ptr 1
  .amdhsa_system_sgpr_workgroup_id_x 1
.end_amdhsa_kernel
```
